```python
import torch

def _softmax(x, axis=-1):
    return torch.softmax(x, dim=axis)
def _gelu(x):
    return torch.nn.functional.gelu(x, approximate="tanh")
def _silu(x):
    return torch.nn.functional.silu(x)
def _sigmoid(x):
    return torch.sigmoid(x)
def _layernorm(x, axis=-1, eps=1e-5):
    m = x.mean(dim=axis, keepdim=True)
    v = x.var(dim=axis, keepdim=True, unbiased=False)
    return (x - m) / torch.sqrt(v + eps)
def _scatter_add(tgt, idx, src, axis=0):
    return tgt.clone().index_add_(axis, idx, src)
def _segment_sum(src, seg, n):
    out = torch.zeros((n,) + src.shape[1:], dtype=src.dtype)
    return out.index_add_(0, seg, src)
def _pad(x, pw):
    flat = tuple(v for pair in reversed(pw) for v in pair)
    return torch.nn.functional.pad(x, flat)

kernel_name = 'recurrent_scan__ssm_conv_h3__glu_gated_glu__prompt'

def setup_inputs():

    _w = (lambda a: (lambda t: t.to(torch.bfloat16) if t.is_floating_point() else t)(torch.as_tensor(a)))
    def _A_setup():
        B, S, D = 1, 2048, 640
        ks = 4
        return {
            "q": _w((lambda *s: torch.randn(*s, dtype=torch.bfloat16) * 0.05)(B, S, D)),
            "k": _w((lambda *s: torch.randn(*s, dtype=torch.bfloat16) * 0.2)(B, S, D)),
            "v": _w((lambda *s: torch.randn(*s, dtype=torch.bfloat16) * 0.2)(B, S, D)),
            "shift_k": _w((lambda *s: torch.randn(*s, dtype=torch.bfloat16) * 0.2)(D, ks) * 0.5),
            "ssm_k": _w((lambda *s: torch.randn(*s, dtype=torch.bfloat16) * 0.2)(D, S) * (1.0 / S ** 0.5)),
            "ssm_D": _w((lambda *s: torch.randn(*s, dtype=torch.bfloat16) * 0.2)(D)),
        }
    _A_in = _A_setup()

    def _B_setup():
        B, S, D, F = 1, 2048, 640, 1728
        return {
            "x": _w((lambda *s: torch.randn(*s, dtype=torch.bfloat16) * 0.05)(B, S, D)),
            "w_gate": _w((lambda *s: torch.randn(*s, dtype=torch.bfloat16) * 0.2)(D, F)),
            "w_up": _w((lambda *s: torch.randn(*s, dtype=torch.bfloat16) * 0.1)(D, F)),
            "w_down": _w((lambda *s: torch.randn(*s, dtype=torch.bfloat16) * 0.1)(F, D)),
        }
    _B_in = _B_setup()

    return {
        "A_q": _A_in["q"],
        "A_k": _A_in["k"],
        "A_v": _A_in["v"],
        "A_shift_k": _A_in["shift_k"],
        "A_ssm_k": _A_in["ssm_k"],
        "A_ssm_D": _A_in["ssm_D"],
        "B_x": _B_in["x"],
        "B_w_gate": _B_in["w_gate"],
        "B_w_up": _B_in["w_up"],
        "B_w_down": _B_in["w_down"],
    }

def reference(A_q, A_k, A_v, A_shift_k, A_ssm_k, A_ssm_D, B_x, B_w_gate, B_w_up, B_w_down):
    def _A_ref(q, k, v, shift_k, ssm_k, ssm_D):
        B, S, D = q.shape
        ks = shift_k.shape[-1]
        k_pad = _pad(k, ((0, 0), (ks - 1, 0), (0, 0)))
        k_shift = torch.zeros_like(k)
        for t in range(ks):
            k_shift = k_shift + k_pad[:, t:t + S, :] * shift_k[:, ks - 1 - t][None, None, :]
        kv = k_shift * v
        L = 2 * S
        kv_pad = _pad(kv, ((0, 0), (0, S), (0, 0)))
        kf_pad = _pad(ssm_k, ((0, 0), (0, S)))
        kv_f = (lambda x, axes=(-2,-1): torch.fft.rfft2(x.float(), dim=axes))(kv_pad[:, None, :, :], axes=(1, 2))
        kf_f = (lambda x, axes=(-2,-1): torch.fft.rfft2(x.float(), dim=axes))(kf_pad[:, None, :], axes=(1, 2))
        kf_f = (lambda x, *d: x.permute(*d))(kf_f, 1, 2, 0)
        y_f = kv_f * kf_f[None, :, :, :]
        y = (lambda x, s, axes=(-2,-1): torch.fft.irfft2(x, s=s, dim=axes).to(torch.bfloat16))(y_f, (1, L), axes=(1, 2))[:, 0, :S, :]
        y = y + kv * ssm_D[None, None, :]
        return q * y

    def _B_ref(x, w_gate, w_up, w_down):
        g = torch.einsum("bsd,df->bsf", x, w_gate)
        u = torch.einsum("bsd,df->bsf", x, w_up)
        h = _sigmoid(g) * u
        return torch.einsum("bsf,fd->bsd", h, w_down)

    x = A_q
    xn = _layernorm(x, axis=-1)
    s = _A_ref(xn, A_k, A_v, A_shift_k, A_ssm_k, A_ssm_D)
    g = _silu(_B_ref(xn, B_w_gate, B_w_up, B_w_down))
    return x + s * g
```

```asm
; @launch grid=(256,1,1) block=(256,1,1) lds=163840
.amdgcn_target "amdgcn-amd-amdhsa--gfx950"
.text
.globl recurrent_scan__ssm_conv_h3__glu_gated_glu__prompt_kernel
.p2align 8
.type recurrent_scan__ssm_conv_h3__glu_gated_glu__prompt_kernel,@function
recurrent_scan__ssm_conv_h3__glu_gated_glu__prompt_kernel:
    s_load_dwordx16 s[4:19], s[0:1], 0
    s_load_dwordx8 s[20:27], s[0:1], 64
    s_load_dwordx2 s[28:29], s[0:1], 96
    s_cmp_ge_u32 s2, 256
    s_cbranch_scc1 recurrent_scan__ssm_conv_h3__glu_gated_glu__prompt_kernel_end
    v_mov_b32 v1, v0
    v_lshrrev_b32 v2, 6, v0
    v_and_b32 v0, 63, v0
    v_readfirstlane_b32 s3, v2
    s_nop 3
    s_getpc_b64 s[88:89]
f_pc:
    s_mov_b32 s90, recurrent_scan__ssm_conv_h3__glu_gated_glu__prompt_kernel_end-f_pc
    s_mov_b32 s91, 0x20000
    s_lshr_b32 s92, s2, 3
    s_lshl_b32 s92, s92, 2
    s_add_u32 s92, s92, s3
    s_lshl_b32 s92, s92, 9
    v_min_u32 v252, 3, v0
    v_lshlrev_b32 v252, 7, v252
    buffer_load_dword v251, v252, s[88:91], s92 offen
    s_waitcnt lgkmcnt(0)
    s_mov_b32 s92, 12615680
    s_load_dword s101, s[28:29], s92
    s_and_b32 s94, s2, 7
    s_lshr_b32 s95, s2, 3
    s_lshl_b32 s95, s95, 2
    s_add_u32 s95, s95, s3
    v_min_u32 v252, 39, v0
    v_lshlrev_b32 v252, 7, v252
    s_mov_b32 s36, s4
    s_mov_b32 s37, s5
    s_mov_b32 s38, 2621440
    s_mov_b32 s39, 0x20000
    s_lshr_b32 s96, s94, 1
    s_mul_i32 s96, s96, 655360
    s_mul_i32 s97, s95, 5120
    s_add_u32 s96, s96, s97
    buffer_load_dword v251, v252, s[36:39], s96 offen
    s_and_b32 s94, s2, 7
    s_lshr_b32 s95, s2, 3
    s_lshl_b32 s30, s94, 3
    s_add_u32 s30, s30, s95
    s_cmp_lt_u32 s95, 8
    s_cbranch_scc1 f_conv
    s_sub_u32 s95, s95, 8
    s_mul_i32 s30, s95, 171
    s_lshr_b32 s30, s30, 10
    s_mul_i32 s31, s30, 6
    s_sub_u32 s31, s95, s31
    s_lshr_b32 s96, s94, 1
    s_mul_i32 s96, s96, 4
    s_add_u32 s30, s30, s96
    s_and_b32 s96, s94, 1
    s_mul_i32 s96, s96, 6
    s_add_u32 s31, s31, s96
    s_mul_i32 s98, s30, 48
    s_lshl_b32 s97, s31, 2
    s_add_u32 s98, s98, s97
    s_add_u32 s98, s98, s3
    s_mov_b32 s99, 0x40000000
    s_mov_b32 s32, s4
    s_mov_b32 s33, s5
    s_mov_b32 s34, 2621440
    s_mov_b32 s35, 0x20000
    s_lshl_b32 s48, s30, 2
    s_add_u32 s48, s48, s3
    s_mul_i32 s49, s48, 40960
    s_mul_i32 s50, s3, 40960
    s_mul_i32 s50, s3, 8192
    s_mov_b32 s64, s6
    s_mov_b32 s65, s7
    s_mov_b32 s66, 2621440
    s_mov_b32 s67, 0x20000
    s_mov_b32 s68, s8
    s_mov_b32 s69, s9
    s_mov_b32 s70, 2621440
    s_mov_b32 s71, 0x20000
    s_mov_b32 s72, s10
    s_mov_b32 s73, s11
    s_mov_b32 s74, 5120
    s_mov_b32 s75, 0x20000
    s_mul_i32 s80, s98, 52429
    s_lshr_b32 s80, s80, 21
    s_mul_i32 s81, s80, 40
    s_sub_u32 s81, s98, s81
    s_mul_i32 s82, s80, 81920
    s_lshl_b32 s83, s81, 5
    s_add_u32 s82, s82, s83
    v_and_b32 v2, 7, v0
    v_lshrrev_b32 v3, 3, v0
    v_mul_u32_u24 v5, 10240, v3
    v_lshl_add_u32 v5, v2, 2, v5
    v_add_u32 v5, s82, v5
    v_subrev_u32 v6, 3840, v5
    v_lshlrev_b32 v7, 4, v2
    s_lshl_b32 s83, s81, 7
    s_movk_i32 s82, 5120
    buffer_load_dwordx4 v[104:107], v7, s[72:75], s83 offen offset:0
    buffer_load_dword v84, v6, s[64:67], 0 offen offset:0
    buffer_load_dword v85, v6, s[64:67], 0 offen offset:1280
    buffer_load_dword v86, v6, s[64:67], 0 offen offset:2560
    buffer_load_dword v87, v5, s[64:67], 0 offen offset:0
    buffer_load_dword v95, v5, s[68:71], 0 offen offset:0
    buffer_load_dword v88, v5, s[64:67], 0 offen offset:1280
    buffer_load_dword v96, v5, s[68:71], 0 offen offset:1280
    buffer_load_dword v89, v5, s[64:67], 0 offen offset:2560
    buffer_load_dword v97, v5, s[68:71], 0 offen offset:2560
    buffer_load_dword v90, v5, s[64:67], 0 offen offset:3840
    buffer_load_dword v98, v5, s[68:71], 0 offen offset:3840
    buffer_load_dword v91, v5, s[64:67], s82 offen offset:0
    buffer_load_dword v99, v5, s[68:71], s82 offen offset:0
    buffer_load_dword v92, v5, s[64:67], s82 offen offset:1280
    buffer_load_dword v100, v5, s[68:71], s82 offen offset:1280
    buffer_load_dword v93, v5, s[64:67], s82 offen offset:2560
    buffer_load_dword v101, v5, s[68:71], s82 offen offset:2560
    buffer_load_dword v94, v5, s[64:67], s82 offen offset:3840
    buffer_load_dword v102, v5, s[68:71], s82 offen offset:3840
    s_mov_b32 s76, s28
    s_mov_b32 s77, s29
    s_mov_b32 s78, 2621440
    s_mov_b32 s79, 0x20000
    v_lshlrev_b32 v162, 13, v3
    v_lshl_add_u32 v162, v2, 4, v162
    v_sub_u32 v4, 7, v2
    v_lshl_add_u32 v4, v4, 3, v3
    v_lshlrev_b32 v165, 2, v4
    v_lshrrev_b32 v3, 2, v0
    v_add_u32 v3, s81, v3
    v_lshlrev_b32 v4, 4, v3
    v_mul_u32_u24 v5, 6554, v4
    v_lshrrev_b32 v5, 16, v5
    v_and_b32 v6, 3, v0
    v_add_u32 v5, v5, v6
    v_mul_u32_u24 v6, 10, v5
    v_add_u32 v4, 15, v4
    v_cmp_le_u32 vcc, v6, v4
    v_cmp_gt_u32 s[92:93], 4, v0
    v_lshrrev_b32 v6, 4, v6
    v_sub_u32 v3, v3, v6
    s_and_b64 vcc, vcc, s[92:93]
    v_lshlrev_b32 v5, 8, v5
    v_lshl_add_u32 v5, v3, 7, v5
    s_lshl_b32 s83, s80, 2
    v_add_u32 v5, s83, v5
    v_mov_b32 v6, 0x40000000
    v_cndmask_b32 v163, v6, v5, vcc
    s_sub_u32 s82, 31, s80
    s_lshl_b32 s82, s82, 7
    s_lshl_b32 s83, s81, 16
    s_add_u32 s82, s82, s83
    v_lshrrev_b32 v2, 4, v0
    v_and_b32 v3, 15, v0
    v_add_u32 v4, 0, v2
    v_xor_b32 v5, v3, v4
    v_mul_u32_u24 v4, 1280, v4
    v_lshl_add_u32 v216, v5, 4, v4
    v_add_u32 v4, 4, v2
    v_xor_b32 v5, v3, v4
    v_mul_u32_u24 v4, 1280, v4
    v_lshl_add_u32 v217, v5, 4, v4
    v_add_u32 v4, 8, v2
    v_xor_b32 v5, v3, v4
    v_mul_u32_u24 v4, 1280, v4
    v_lshl_add_u32 v218, v5, 4, v4
    v_add_u32 v4, 12, v2
    v_xor_b32 v5, v3, v4
    v_mul_u32_u24 v4, 1280, v4
    v_lshl_add_u32 v219, v5, 4, v4
    s_add_u32 s51, s49, 20480
    s_add_u32 m0, s50, 0
    s_nop 0
    buffer_load_dwordx4 v216, s[32:35], s49 offen offset:0 lds
    s_add_u32 m0, s50, 1024
    s_nop 0
    buffer_load_dwordx4 v217, s[32:35], s49 offen offset:0 lds
    s_add_u32 m0, s50, 2048
    s_nop 0
    buffer_load_dwordx4 v218, s[32:35], s49 offen offset:0 lds
    s_add_u32 m0, s50, 3072
    s_nop 0
    buffer_load_dwordx4 v219, s[32:35], s49 offen offset:0 lds
    s_add_u32 m0, s50, 4096
    s_nop 0
    buffer_load_dwordx4 v216, s[32:35], s51 offen offset:0 lds
    s_add_u32 m0, s50, 5120
    s_nop 0
    buffer_load_dwordx4 v217, s[32:35], s51 offen offset:0 lds
    s_add_u32 m0, s50, 6144
    s_nop 0
    buffer_load_dwordx4 v218, s[32:35], s51 offen offset:0 lds
    s_add_u32 m0, s50, 7168
    s_nop 0
    buffer_load_dwordx4 v219, s[32:35], s51 offen offset:0 lds
    s_add_u32 m0, s50, 32512
    s_nop 0
    buffer_load_dwordx4 v216, s[32:35], s49 offen offset:256 lds
    s_add_u32 m0, s50, 33536
    s_nop 0
    buffer_load_dwordx4 v217, s[32:35], s49 offen offset:256 lds
    s_add_u32 m0, s50, 34560
    s_nop 0
    buffer_load_dwordx4 v218, s[32:35], s49 offen offset:256 lds
    s_add_u32 m0, s50, 35584
    s_nop 0
    buffer_load_dwordx4 v219, s[32:35], s49 offen offset:256 lds
    s_add_u32 m0, s50, 36608
    s_nop 0
    buffer_load_dwordx4 v216, s[32:35], s51 offen offset:256 lds
    s_add_u32 m0, s50, 37632
    s_nop 0
    buffer_load_dwordx4 v217, s[32:35], s51 offen offset:256 lds
    s_add_u32 m0, s50, 38656
    s_nop 0
    buffer_load_dwordx4 v218, s[32:35], s51 offen offset:256 lds
    s_add_u32 m0, s50, 39680
    s_nop 0
    buffer_load_dwordx4 v219, s[32:35], s51 offen offset:256 lds
    s_add_u32 m0, s50, 65024
    s_nop 0
    buffer_load_dwordx4 v216, s[32:35], s49 offen offset:512 lds
    s_add_u32 m0, s50, 66048
    s_nop 0
    buffer_load_dwordx4 v217, s[32:35], s49 offen offset:512 lds
    s_add_u32 m0, s50, 67072
    s_nop 0
    buffer_load_dwordx4 v218, s[32:35], s49 offen offset:512 lds
    s_add_u32 m0, s50, 68096
    s_nop 0
    buffer_load_dwordx4 v219, s[32:35], s49 offen offset:512 lds
    s_add_u32 m0, s50, 69120
    s_nop 0
    buffer_load_dwordx4 v216, s[32:35], s51 offen offset:512 lds
    s_add_u32 m0, s50, 70144
    s_nop 0
    buffer_load_dwordx4 v217, s[32:35], s51 offen offset:512 lds
    s_add_u32 m0, s50, 71168
    s_nop 0
    buffer_load_dwordx4 v218, s[32:35], s51 offen offset:512 lds
    s_add_u32 m0, s50, 72192
    s_nop 0
    buffer_load_dwordx4 v219, s[32:35], s51 offen offset:512 lds
    s_cmp_lt_u32 s3, 2
    s_cselect_b32 s36, s18, s20
    s_cselect_b32 s37, s19, s21
    s_mov_b32 s38, 2211840
    s_mov_b32 s39, 0x20000
    s_and_b32 s55, s3, 1
    s_mul_i32 s52, s55, 576
    s_mul_i32 s53, s55, 9216
    s_lshr_b32 s55, s3, 1
    s_mul_i32 s55, s55, 18560
    s_add_u32 s53, s53, s55
    s_mul_i32 s54, s31, 288
    v_add_u32 v2, 0, v0
    v_add_u32 v2, s52, v2
    v_mul_u32_u24 v3, 58255, v2
    v_lshrrev_b32 v3, 20, v3
    v_mul_u32_u24 v4, 18, v3
    v_sub_u32 v4, v2, v4
    v_mul_u32_u24 v3, 3456, v3
    v_lshl_add_u32 v224, v4, 4, v3
    v_add_u32 v224, s54, v224
    v_add_u32 v2, 64, v0
    v_add_u32 v2, s52, v2
    v_mul_u32_u24 v3, 58255, v2
    v_lshrrev_b32 v3, 20, v3
    v_mul_u32_u24 v4, 18, v3
    v_sub_u32 v4, v2, v4
    v_mul_u32_u24 v3, 3456, v3
    v_lshl_add_u32 v225, v4, 4, v3
    v_add_u32 v225, s54, v225
    v_add_u32 v2, 128, v0
    v_add_u32 v2, s52, v2
    v_mul_u32_u24 v3, 58255, v2
    v_lshrrev_b32 v3, 20, v3
    v_mul_u32_u24 v4, 18, v3
    v_sub_u32 v4, v2, v4
    v_mul_u32_u24 v3, 3456, v3
    v_lshl_add_u32 v226, v4, 4, v3
    v_add_u32 v226, s54, v226
    v_add_u32 v2, 192, v0
    v_add_u32 v2, s52, v2
    v_mul_u32_u24 v3, 58255, v2
    v_lshrrev_b32 v3, 20, v3
    v_mul_u32_u24 v4, 18, v3
    v_sub_u32 v4, v2, v4
    v_mul_u32_u24 v3, 3456, v3
    v_lshl_add_u32 v227, v4, 4, v3
    v_add_u32 v227, s54, v227
    v_add_u32 v2, 256, v0
    v_add_u32 v2, s52, v2
    v_mul_u32_u24 v3, 58255, v2
    v_lshrrev_b32 v3, 20, v3
    v_mul_u32_u24 v4, 18, v3
    v_sub_u32 v4, v2, v4
    v_mul_u32_u24 v3, 3456, v3
    v_lshl_add_u32 v228, v4, 4, v3
    v_add_u32 v228, s54, v228
    v_add_u32 v2, 320, v0
    v_add_u32 v2, s52, v2
    v_mul_u32_u24 v3, 58255, v2
    v_lshrrev_b32 v3, 20, v3
    v_mul_u32_u24 v4, 18, v3
    v_sub_u32 v4, v2, v4
    v_mul_u32_u24 v3, 3456, v3
    v_lshl_add_u32 v229, v4, 4, v3
    v_add_u32 v229, s54, v229
    v_add_u32 v2, 384, v0
    v_add_u32 v2, s52, v2
    v_mul_u32_u24 v3, 58255, v2
    v_lshrrev_b32 v3, 20, v3
    v_mul_u32_u24 v4, 18, v3
    v_sub_u32 v4, v2, v4
    v_mul_u32_u24 v3, 3456, v3
    v_lshl_add_u32 v230, v4, 4, v3
    v_add_u32 v230, s54, v230
    v_add_u32 v2, 448, v0
    v_add_u32 v2, s52, v2
    v_mul_u32_u24 v3, 58255, v2
    v_lshrrev_b32 v3, 20, v3
    v_mul_u32_u24 v4, 18, v3
    v_sub_u32 v4, v2, v4
    v_mul_u32_u24 v3, 3456, v3
    v_lshl_add_u32 v231, v4, 4, v3
    v_add_u32 v231, s54, v231
    v_add_u32 v2, 512, v0
    v_add_u32 v2, s52, v2
    v_mul_u32_u24 v3, 58255, v2
    v_lshrrev_b32 v3, 20, v3
    v_mul_u32_u24 v4, 18, v3
    v_sub_u32 v4, v2, v4
    v_mul_u32_u24 v3, 3456, v3
    v_lshl_add_u32 v232, v4, 4, v3
    v_add_u32 v232, s54, v232
    v_and_b32 v2, 31, v0
    v_lshrrev_b32 v3, 5, v0
    v_and_b32 v4, 15, v0
    v_xor_b32 v4, v4, v3
    v_lshlrev_b32 v5, 8, v2
    v_add_u32 v5, s50, v5
    v_xor_b32 v6, 0, v4
    v_lshl_add_u32 v168, v6, 4, v5
    v_xor_b32 v6, 2, v4
    v_lshl_add_u32 v169, v6, 4, v5
    v_xor_b32 v6, 4, v4
    v_lshl_add_u32 v170, v6, 4, v5
    v_xor_b32 v6, 6, v4
    v_lshl_add_u32 v171, v6, 4, v5
    v_xor_b32 v6, 8, v4
    v_lshl_add_u32 v172, v6, 4, v5
    v_xor_b32 v6, 10, v4
    v_lshl_add_u32 v173, v6, 4, v5
    v_xor_b32 v6, 12, v4
    v_lshl_add_u32 v174, v6, 4, v5
    v_xor_b32 v6, 14, v4
    v_lshl_add_u32 v175, v6, 4, v5
    v_bfe_u32 v4, v0, 2, 2
    v_lshl_add_u32 v4, v3, 3, v4
    v_mul_u32_u24 v4, 288, v4
    v_and_b32 v5, 1, v0
    v_lshl_add_u32 v4, v5, 4, v4
    v_bfe_u32 v5, v0, 1, 1
    v_lshl_add_u32 v4, v5, 3, v4
    v_bfe_u32 v5, v0, 4, 1
    v_mul_u32_u24 v5, 18560, v5
    v_add_u32 v233, v4, v5
    v_add_u32 v234, 37120, v233
    v_add_u32 v235, 74240, v233
    v_add_u32 v236, 111360, v233
    v_and_b32 v4, 9, v0
    v_bfe_u32 v5, v0, 1, 1
    v_lshl_add_u32 v4, v5, 2, v4
    v_bfe_u32 v5, v0, 2, 1
    v_lshl_add_u32 v4, v5, 1, v4
    v_lshlrev_b32 v4, 4, v4
    v_lshl_add_u32 v4, v3, 8, v4
    v_bfe_u32 v5, v0, 4, 1
    v_mul_u32_u24 v5, 55296, v5
    v_add_u32 v237, v4, v5
    v_lshlrev_b32 v238, 3, v2
    s_add_u32 s40, s28, 5242880
    s_addc_u32 s41, s29, 0
    s_mov_b32 s42, 7077888
    s_mov_b32 s43, 0x20000
    s_add_u32 s44, s28, 12582912
    s_addc_u32 s45, s29, 0
    s_mov_b32 s46, 16384
    s_mov_b32 s47, 0x20000
    s_mul_i32 s56, s48, 110592
    s_mul_i32 s57, s31, 4608
    s_add_u32 s56, s56, s57
    s_add_u32 s57, s56, 4096
    s_lshl_b32 s58, s48, 8
    v_lshlrev_b32 v244, 4, v0
    v_add_u32 v245, 4096, v244
    v_lshlrev_b32 v254, 2, v0
    s_add_u32 s84, s28, 16777216
    s_addc_u32 s85, s29, 0
    s_mov_b32 s86, 2211840
    s_mov_b32 s87, 0x20000
    s_add_u32 s88, s28, 12648448
    s_addc_u32 s89, s29, 0
    s_mov_b32 s90, 278528
    s_mov_b32 s91, 0x20000
    s_and_b32 s94, s2, 7
    s_lshr_b32 s95, s2, 3
    s_lshr_b32 s63, s95, 3
    s_and_b32 s62, s95, 7
    s_lshr_b32 s96, s94, 0
    s_mul_i32 s96, s96, 4
    s_add_u32 s63, s63, s96
    s_and_b32 s96, s94, 0
    s_lshl_b32 s96, s96, 3
    s_add_u32 s62, s62, s96
    s_lshl_b32 s63, s63, 3
    s_add_u32 s63, s63, s62
    s_lshl_b32 s63, s63, 10
    s_mul_i32 s62, s62, 276480
    s_mul_i32 s94, s3, 5120
    s_add_u32 s62, s62, s94
    s_lshr_b32 s95, s48, 1
    s_lshl_b32 s95, s95, 13
    s_add_u32 s95, s95, 512
    s_lshl_b32 s96, s31, 3
    s_add_u32 s95, s95, s96
    s_and_b32 s96, s3, 1
    s_lshl_b32 s96, s96, 2
    s_add_u32 s95, s95, s96
    v_lshlrev_b32 v2, 10, v0
    v_add_u32 v2, s95, v2
    v_mov_b32 v3, 0x40000000
    v_cmp_gt_u32 vcc, 8, v0
    s_nop 0
    v_cndmask_b32 v249, v3, v2, vcc
    s_waitcnt lgkmcnt(0)
    s_mul_i32 s100, s101, 0x9E3779B1
    s_add_u32 s100, s100, 0x7F4A7C15
    s_mov_b32 s83, 0xffff0000
    s_waitcnt vmcnt(24)
    v_lshlrev_b32 v130, 16, v104
    v_lshlrev_b32 v131, 16, v106
    v_and_b32 v132, s83, v104
    v_and_b32 v133, s83, v106
    v_lshlrev_b32 v134, 16, v105
    v_lshlrev_b32 v135, 16, v107
    v_and_b32 v136, s83, v105
    v_and_b32 v137, s83, v107
    v_lshlrev_b32 v108, 16, v84
    v_and_b32 v109, s83, v84
    v_lshlrev_b32 v110, 16, v85
    v_and_b32 v111, s83, v85
    v_lshlrev_b32 v112, 16, v86
    v_and_b32 v113, s83, v86
    v_lshlrev_b32 v114, 16, v87
    v_and_b32 v115, s83, v87
    v_lshlrev_b32 v116, 16, v88
    v_and_b32 v117, s83, v88
    v_lshlrev_b32 v118, 16, v89
    v_and_b32 v119, s83, v89
    v_lshlrev_b32 v120, 16, v90
    v_and_b32 v121, s83, v90
    v_lshlrev_b32 v122, 16, v91
    v_and_b32 v123, s83, v91
    v_lshlrev_b32 v124, 16, v92
    v_and_b32 v125, s83, v92
    v_lshlrev_b32 v126, 16, v93
    v_and_b32 v127, s83, v93
    v_lshlrev_b32 v128, 16, v94
    v_and_b32 v129, s83, v94
    v_pk_mul_f32 v[138:139], v[136:137], v[108:109]
    v_pk_mul_f32 v[140:141], v[136:137], v[110:111]
    v_pk_mul_f32 v[142:143], v[136:137], v[112:113]
    v_pk_mul_f32 v[144:145], v[136:137], v[114:115]
    v_pk_mul_f32 v[146:147], v[136:137], v[116:117]
    v_pk_mul_f32 v[148:149], v[136:137], v[118:119]
    v_pk_mul_f32 v[150:151], v[136:137], v[120:121]
    v_pk_mul_f32 v[152:153], v[136:137], v[122:123]
    v_pk_fma_f32 v[138:139], v[134:135], v[110:111], v[138:139]
    v_pk_fma_f32 v[140:141], v[134:135], v[112:113], v[140:141]
    v_pk_fma_f32 v[142:143], v[134:135], v[114:115], v[142:143]
    v_pk_fma_f32 v[144:145], v[134:135], v[116:117], v[144:145]
    v_pk_fma_f32 v[146:147], v[134:135], v[118:119], v[146:147]
    v_pk_fma_f32 v[148:149], v[134:135], v[120:121], v[148:149]
    v_pk_fma_f32 v[150:151], v[134:135], v[122:123], v[150:151]
    v_pk_fma_f32 v[152:153], v[134:135], v[124:125], v[152:153]
    v_pk_fma_f32 v[138:139], v[132:133], v[112:113], v[138:139]
    v_pk_fma_f32 v[140:141], v[132:133], v[114:115], v[140:141]
    v_pk_fma_f32 v[142:143], v[132:133], v[116:117], v[142:143]
    v_pk_fma_f32 v[144:145], v[132:133], v[118:119], v[144:145]
    v_pk_fma_f32 v[146:147], v[132:133], v[120:121], v[146:147]
    v_pk_fma_f32 v[148:149], v[132:133], v[122:123], v[148:149]
    v_pk_fma_f32 v[150:151], v[132:133], v[124:125], v[150:151]
    v_pk_fma_f32 v[152:153], v[132:133], v[126:127], v[152:153]
    v_pk_fma_f32 v[138:139], v[130:131], v[114:115], v[138:139]
    v_pk_fma_f32 v[140:141], v[130:131], v[116:117], v[140:141]
    v_pk_fma_f32 v[142:143], v[130:131], v[118:119], v[142:143]
    v_pk_fma_f32 v[144:145], v[130:131], v[120:121], v[144:145]
    v_pk_fma_f32 v[146:147], v[130:131], v[122:123], v[146:147]
    v_pk_fma_f32 v[148:149], v[130:131], v[124:125], v[148:149]
    v_pk_fma_f32 v[150:151], v[130:131], v[126:127], v[150:151]
    v_pk_fma_f32 v[152:153], v[130:131], v[128:129], v[152:153]
    v_lshlrev_b32 v108, 16, v95
    v_and_b32 v109, s83, v95
    v_lshlrev_b32 v110, 16, v96
    v_and_b32 v111, s83, v96
    v_lshlrev_b32 v112, 16, v97
    v_and_b32 v113, s83, v97
    v_lshlrev_b32 v114, 16, v98
    v_and_b32 v115, s83, v98
    v_lshlrev_b32 v116, 16, v99
    v_and_b32 v117, s83, v99
    v_lshlrev_b32 v118, 16, v100
    v_and_b32 v119, s83, v100
    v_lshlrev_b32 v120, 16, v101
    v_and_b32 v121, s83, v101
    v_lshlrev_b32 v122, 16, v102
    v_and_b32 v123, s83, v102
    v_pk_mul_f32 v[138:139], v[138:139], v[108:109]
    v_pk_mul_f32 v[140:141], v[140:141], v[110:111]
    v_pk_mul_f32 v[142:143], v[142:143], v[112:113]
    v_pk_mul_f32 v[144:145], v[144:145], v[114:115]
    v_pk_mul_f32 v[146:147], v[146:147], v[116:117]
    v_pk_mul_f32 v[148:149], v[148:149], v[118:119]
    v_pk_mul_f32 v[150:151], v[150:151], v[120:121]
    v_pk_mul_f32 v[152:153], v[152:153], v[122:123]
    v_cvt_pk_bf16_f32 v154, v152, v150
    v_cvt_pk_bf16_f32 v155, v148, v146
    v_cvt_pk_bf16_f32 v156, v144, v142
    v_cvt_pk_bf16_f32 v157, v140, v138
    ds_bpermute_b32 v154, v165, v154
    ds_bpermute_b32 v155, v165, v155
    ds_bpermute_b32 v156, v165, v156
    ds_bpermute_b32 v157, v165, v157
    v_cvt_pk_bf16_f32 v158, v153, v151
    v_cvt_pk_bf16_f32 v159, v149, v147
    v_cvt_pk_bf16_f32 v160, v145, v143
    v_cvt_pk_bf16_f32 v161, v141, v139
    ds_bpermute_b32 v158, v165, v158
    ds_bpermute_b32 v159, v165, v159
    ds_bpermute_b32 v160, v165, v160
    ds_bpermute_b32 v161, v165, v161
    s_waitcnt lgkmcnt(4)
    buffer_store_dwordx4 v[154:157], v162, s[76:79], s82 offen sc1
    s_add_u32 s82, s82, 4096
    s_waitcnt lgkmcnt(0)
    buffer_store_dwordx4 v[158:161], v162, s[76:79], s82 offen sc1
    v_mov_b32 v220, 0
    v_mov_b32 v221, 0
    v_mov_b32 v222, 0
    v_mov_b32 v223, 0
    s_mov_b32 s60, 0x3f803f80
    s_add_u32 m0, s50, 97536
    s_nop 0
    buffer_load_dwordx4 v216, s[32:35], s49 offen offset:768 lds
    s_add_u32 m0, s50, 98560
    s_nop 0
    buffer_load_dwordx4 v217, s[32:35], s49 offen offset:768 lds
    s_add_u32 m0, s50, 99584
    s_nop 0
    buffer_load_dwordx4 v218, s[32:35], s49 offen offset:768 lds
    s_add_u32 m0, s50, 100608
    s_nop 0
    buffer_load_dwordx4 v219, s[32:35], s49 offen offset:768 lds
    s_add_u32 m0, s50, 101632
    s_nop 0
    buffer_load_dwordx4 v216, s[32:35], s51 offen offset:768 lds
    s_add_u32 m0, s50, 102656
    s_nop 0
    buffer_load_dwordx4 v217, s[32:35], s51 offen offset:768 lds
    s_add_u32 m0, s50, 103680
    s_nop 0
    buffer_load_dwordx4 v218, s[32:35], s51 offen offset:768 lds
    s_add_u32 m0, s50, 104704
    s_nop 0
    buffer_load_dwordx4 v219, s[32:35], s51 offen offset:768 lds
    s_add_u32 s64, s28, 12910592
    s_addc_u32 s65, s29, 0
    s_mov_b32 s66, 16384
    s_mov_b32 s67, 0x20000
    v_mov_b32 v164, s100
    s_waitcnt vmcnt(8)
    buffer_store_dword v164, v163, s[64:67], 0 offen sc1
    ds_read_b128 v[8:11], v168 offset:0
    ds_read_b128 v[12:15], v169 offset:0
    ds_read_b128 v[16:19], v170 offset:0
    ds_read_b128 v[20:23], v171 offset:0
    ds_read_b128 v[24:27], v172 offset:0
    ds_read_b128 v[28:31], v173 offset:0
    ds_read_b128 v[32:35], v174 offset:0
    ds_read_b128 v[36:39], v175 offset:0
    s_waitcnt lgkmcnt(0)
    s_add_u32 m0, s50, 130048
    s_nop 0
    buffer_load_dwordx4 v216, s[32:35], s49 offen offset:1024 lds
    s_add_u32 m0, s50, 131072
    s_nop 0
    buffer_load_dwordx4 v217, s[32:35], s49 offen offset:1024 lds
    s_add_u32 m0, s50, 132096
    s_nop 0
    buffer_load_dwordx4 v218, s[32:35], s49 offen offset:1024 lds
    s_add_u32 m0, s50, 133120
    s_nop 0
    buffer_load_dwordx4 v219, s[32:35], s49 offen offset:1024 lds
    s_add_u32 m0, s50, 134144
    s_nop 0
    buffer_load_dwordx4 v216, s[32:35], s51 offen offset:1024 lds
    s_add_u32 m0, s50, 135168
    s_nop 0
    buffer_load_dwordx4 v217, s[32:35], s51 offen offset:1024 lds
    s_add_u32 m0, s50, 136192
    s_nop 0
    buffer_load_dwordx4 v218, s[32:35], s51 offen offset:1024 lds
    s_add_u32 m0, s50, 137216
    s_nop 0
    buffer_load_dwordx4 v219, s[32:35], s51 offen offset:1024 lds
    ds_read_b128 v[40:43], v168 offset:32768
    ds_read_b128 v[44:47], v169 offset:32768
    ds_read_b128 v[48:51], v170 offset:32768
    ds_read_b128 v[52:55], v171 offset:32768
    ds_read_b128 v[56:59], v172 offset:32768
    ds_read_b128 v[60:63], v173 offset:32768
    ds_read_b128 v[64:67], v174 offset:32768
    ds_read_b128 v[68:71], v175 offset:32768
    v_dot2c_f32_bf16 v220, s60, v8
    v_dot2c_f32_bf16 v222, v8, v8
    v_dot2c_f32_bf16 v221, s60, v9
    v_dot2c_f32_bf16 v223, v9, v9
    v_dot2c_f32_bf16 v220, s60, v10
    v_dot2c_f32_bf16 v222, v10, v10
    v_dot2c_f32_bf16 v221, s60, v11
    v_dot2c_f32_bf16 v223, v11, v11
    v_dot2c_f32_bf16 v220, s60, v12
    v_dot2c_f32_bf16 v222, v12, v12
    v_dot2c_f32_bf16 v221, s60, v13
    v_dot2c_f32_bf16 v223, v13, v13
    v_dot2c_f32_bf16 v220, s60, v14
    v_dot2c_f32_bf16 v222, v14, v14
    v_dot2c_f32_bf16 v221, s60, v15
    v_dot2c_f32_bf16 v223, v15, v15
    v_dot2c_f32_bf16 v220, s60, v16
    v_dot2c_f32_bf16 v222, v16, v16
    v_dot2c_f32_bf16 v221, s60, v17
    v_dot2c_f32_bf16 v223, v17, v17
    v_dot2c_f32_bf16 v220, s60, v18
    v_dot2c_f32_bf16 v222, v18, v18
    v_dot2c_f32_bf16 v221, s60, v19
    v_dot2c_f32_bf16 v223, v19, v19
    v_dot2c_f32_bf16 v220, s60, v20
    v_dot2c_f32_bf16 v222, v20, v20
    v_dot2c_f32_bf16 v221, s60, v21
    v_dot2c_f32_bf16 v223, v21, v21
    v_dot2c_f32_bf16 v220, s60, v22
    v_dot2c_f32_bf16 v222, v22, v22
    v_dot2c_f32_bf16 v221, s60, v23
    v_dot2c_f32_bf16 v223, v23, v23
    s_waitcnt lgkmcnt(0)
    s_barrier
    v_dot2c_f32_bf16 v220, s60, v24
    v_dot2c_f32_bf16 v222, v24, v24
    v_dot2c_f32_bf16 v221, s60, v25
    v_dot2c_f32_bf16 v223, v25, v25
    s_mov_b32 s59, 0
    v_dot2c_f32_bf16 v220, s60, v26
    v_dot2c_f32_bf16 v222, v26, v26
    v_dot2c_f32_bf16 v221, s60, v27
    v_dot2c_f32_bf16 v223, v27, v27
    s_add_u32 m0, s53, 0
    s_nop 0
    buffer_load_dwordx4 v224, s[36:39], s59 offen lds
    v_dot2c_f32_bf16 v220, s60, v28
    v_dot2c_f32_bf16 v222, v28, v28
    s_add_u32 m0, s53, 1024
    s_nop 0
    buffer_load_dwordx4 v225, s[36:39], s59 offen lds
    v_dot2c_f32_bf16 v221, s60, v29
    v_dot2c_f32_bf16 v223, v29, v29
    v_dot2c_f32_bf16 v220, s60, v30
    v_dot2c_f32_bf16 v222, v30, v30
    s_add_u32 m0, s53, 2048
    s_nop 0
    buffer_load_dwordx4 v226, s[36:39], s59 offen lds
    v_dot2c_f32_bf16 v221, s60, v31
    v_dot2c_f32_bf16 v223, v31, v31
    s_add_u32 m0, s53, 3072
    s_nop 0
    buffer_load_dwordx4 v227, s[36:39], s59 offen lds
    v_dot2c_f32_bf16 v220, s60, v32
    v_dot2c_f32_bf16 v222, v32, v32
    v_dot2c_f32_bf16 v221, s60, v33
    v_dot2c_f32_bf16 v223, v33, v33
    s_add_u32 m0, s53, 4096
    s_nop 0
    buffer_load_dwordx4 v228, s[36:39], s59 offen lds
    v_dot2c_f32_bf16 v220, s60, v34
    v_dot2c_f32_bf16 v222, v34, v34
    v_dot2c_f32_bf16 v221, s60, v35
    v_dot2c_f32_bf16 v223, v35, v35
    s_add_u32 m0, s53, 5120
    s_nop 0
    buffer_load_dwordx4 v229, s[36:39], s59 offen lds
    v_dot2c_f32_bf16 v220, s60, v36
    v_dot2c_f32_bf16 v222, v36, v36
    s_add_u32 m0, s53, 6144
    s_nop 0
    buffer_load_dwordx4 v230, s[36:39], s59 offen lds
    v_dot2c_f32_bf16 v221, s60, v37
    v_dot2c_f32_bf16 v223, v37, v37
    v_dot2c_f32_bf16 v220, s60, v38
    v_dot2c_f32_bf16 v222, v38, v38
    s_add_u32 m0, s53, 7168
    s_nop 0
    buffer_load_dwordx4 v231, s[36:39], s59 offen lds
    v_dot2c_f32_bf16 v221, s60, v39
    v_dot2c_f32_bf16 v223, v39, v39
    s_add_u32 m0, s53, 8192
    s_nop 0
    buffer_load_dwordx4 v232, s[36:39], s59 offen lds
    v_add_u32 v168, 65536, v168
    v_add_u32 v169, 65536, v169
    v_add_u32 v170, 65536, v170
    v_add_u32 v171, 65536, v171
    v_add_u32 v172, 65536, v172
    v_add_u32 v173, 65536, v173
    v_add_u32 v174, 65536, v174
    v_add_u32 v175, 65536, v175
    ds_read_b128 v[72:75], v168 offset:0
    ds_read_b128 v[76:79], v169 offset:0
    ds_read_b128 v[80:83], v170 offset:0
    ds_read_b128 v[84:87], v171 offset:0
    ds_read_b128 v[88:91], v172 offset:0
    ds_read_b128 v[92:95], v173 offset:0
    ds_read_b128 v[96:99], v174 offset:0
    ds_read_b128 v[100:103], v175 offset:0
    v_dot2c_f32_bf16 v220, s60, v40
    v_dot2c_f32_bf16 v222, v40, v40
    v_dot2c_f32_bf16 v221, s60, v41
    v_dot2c_f32_bf16 v223, v41, v41
    v_dot2c_f32_bf16 v220, s60, v42
    v_dot2c_f32_bf16 v222, v42, v42
    v_dot2c_f32_bf16 v221, s60, v43
    v_dot2c_f32_bf16 v223, v43, v43
    v_dot2c_f32_bf16 v220, s60, v44
    v_dot2c_f32_bf16 v222, v44, v44
    v_dot2c_f32_bf16 v221, s60, v45
    v_dot2c_f32_bf16 v223, v45, v45
    v_dot2c_f32_bf16 v220, s60, v46
    v_dot2c_f32_bf16 v222, v46, v46
    v_dot2c_f32_bf16 v221, s60, v47
    v_dot2c_f32_bf16 v223, v47, v47
    v_dot2c_f32_bf16 v220, s60, v48
    v_dot2c_f32_bf16 v222, v48, v48
    v_dot2c_f32_bf16 v221, s60, v49
    v_dot2c_f32_bf16 v223, v49, v49
    v_dot2c_f32_bf16 v220, s60, v50
    v_dot2c_f32_bf16 v222, v50, v50
    v_dot2c_f32_bf16 v221, s60, v51
    v_dot2c_f32_bf16 v223, v51, v51
    v_dot2c_f32_bf16 v220, s60, v52
    v_dot2c_f32_bf16 v222, v52, v52
    v_dot2c_f32_bf16 v221, s60, v53
    v_dot2c_f32_bf16 v223, v53, v53
    v_dot2c_f32_bf16 v220, s60, v54
    v_dot2c_f32_bf16 v222, v54, v54
    v_dot2c_f32_bf16 v221, s60, v55
    v_dot2c_f32_bf16 v223, v55, v55
    s_waitcnt lgkmcnt(0)
    s_barrier
    v_dot2c_f32_bf16 v220, s60, v56
    v_dot2c_f32_bf16 v222, v56, v56
    v_dot2c_f32_bf16 v221, s60, v57
    v_dot2c_f32_bf16 v223, v57, v57
    s_mov_b32 s59, 221184
    v_dot2c_f32_bf16 v220, s60, v58
    v_dot2c_f32_bf16 v222, v58, v58
    v_dot2c_f32_bf16 v221, s60, v59
    v_dot2c_f32_bf16 v223, v59, v59
    s_add_u32 m0, s53, 37120
    s_nop 0
    buffer_load_dwordx4 v224, s[36:39], s59 offen lds
    v_dot2c_f32_bf16 v220, s60, v60
    v_dot2c_f32_bf16 v222, v60, v60
    s_add_u32 m0, s53, 38144
    s_nop 0
    buffer_load_dwordx4 v225, s[36:39], s59 offen lds
    v_dot2c_f32_bf16 v221, s60, v61
    v_dot2c_f32_bf16 v223, v61, v61
    v_dot2c_f32_bf16 v220, s60, v62
    v_dot2c_f32_bf16 v222, v62, v62
    s_add_u32 m0, s53, 39168
    s_nop 0
    buffer_load_dwordx4 v226, s[36:39], s59 offen lds
    v_dot2c_f32_bf16 v221, s60, v63
    v_dot2c_f32_bf16 v223, v63, v63
    s_add_u32 m0, s53, 40192
    s_nop 0
    buffer_load_dwordx4 v227, s[36:39], s59 offen lds
    v_dot2c_f32_bf16 v220, s60, v64
    v_dot2c_f32_bf16 v222, v64, v64
    v_dot2c_f32_bf16 v221, s60, v65
    v_dot2c_f32_bf16 v223, v65, v65
    s_add_u32 m0, s53, 41216
    s_nop 0
    buffer_load_dwordx4 v228, s[36:39], s59 offen lds
    v_dot2c_f32_bf16 v220, s60, v66
    v_dot2c_f32_bf16 v222, v66, v66
    v_dot2c_f32_bf16 v221, s60, v67
    v_dot2c_f32_bf16 v223, v67, v67
    s_add_u32 m0, s53, 42240
    s_nop 0
    buffer_load_dwordx4 v229, s[36:39], s59 offen lds
    v_dot2c_f32_bf16 v220, s60, v68
    v_dot2c_f32_bf16 v222, v68, v68
    s_add_u32 m0, s53, 43264
    s_nop 0
    buffer_load_dwordx4 v230, s[36:39], s59 offen lds
    v_dot2c_f32_bf16 v221, s60, v69
    v_dot2c_f32_bf16 v223, v69, v69
    v_dot2c_f32_bf16 v220, s60, v70
    v_dot2c_f32_bf16 v222, v70, v70
    s_add_u32 m0, s53, 44288
    s_nop 0
    buffer_load_dwordx4 v231, s[36:39], s59 offen lds
    v_dot2c_f32_bf16 v221, s60, v71
    v_dot2c_f32_bf16 v223, v71, v71
    s_add_u32 m0, s53, 45312
    s_nop 0
    buffer_load_dwordx4 v232, s[36:39], s59 offen lds
    s_waitcnt vmcnt(27)
    ds_read_b128 v[104:107], v168 offset:32768
    ds_read_b128 v[108:111], v169 offset:32768
    ds_read_b128 v[112:115], v170 offset:32768
    ds_read_b128 v[116:119], v171 offset:32768
    ds_read_b128 v[120:123], v172 offset:32768
    ds_read_b128 v[124:127], v173 offset:32768
    ds_read_b128 v[128:131], v174 offset:32768
    ds_read_b128 v[132:135], v175 offset:32768
    v_dot2c_f32_bf16 v220, s60, v72
    v_dot2c_f32_bf16 v222, v72, v72
    v_dot2c_f32_bf16 v221, s60, v73
    v_dot2c_f32_bf16 v223, v73, v73
    v_dot2c_f32_bf16 v220, s60, v74
    v_dot2c_f32_bf16 v222, v74, v74
    v_dot2c_f32_bf16 v221, s60, v75
    v_dot2c_f32_bf16 v223, v75, v75
    v_dot2c_f32_bf16 v220, s60, v76
    v_dot2c_f32_bf16 v222, v76, v76
    v_dot2c_f32_bf16 v221, s60, v77
    v_dot2c_f32_bf16 v223, v77, v77
    v_dot2c_f32_bf16 v220, s60, v78
    v_dot2c_f32_bf16 v222, v78, v78
    v_dot2c_f32_bf16 v221, s60, v79
    v_dot2c_f32_bf16 v223, v79, v79
    v_dot2c_f32_bf16 v220, s60, v80
    v_dot2c_f32_bf16 v222, v80, v80
    v_dot2c_f32_bf16 v221, s60, v81
    v_dot2c_f32_bf16 v223, v81, v81
    v_dot2c_f32_bf16 v220, s60, v82
    v_dot2c_f32_bf16 v222, v82, v82
    v_dot2c_f32_bf16 v221, s60, v83
    v_dot2c_f32_bf16 v223, v83, v83
    v_dot2c_f32_bf16 v220, s60, v84
    v_dot2c_f32_bf16 v222, v84, v84
    v_dot2c_f32_bf16 v221, s60, v85
    v_dot2c_f32_bf16 v223, v85, v85
    v_dot2c_f32_bf16 v220, s60, v86
    v_dot2c_f32_bf16 v222, v86, v86
    v_dot2c_f32_bf16 v221, s60, v87
    v_dot2c_f32_bf16 v223, v87, v87
    s_waitcnt lgkmcnt(0)
    s_barrier
    v_dot2c_f32_bf16 v220, s60, v88
    v_dot2c_f32_bf16 v222, v88, v88
    v_dot2c_f32_bf16 v221, s60, v89
    v_dot2c_f32_bf16 v223, v89, v89
    v_dot2c_f32_bf16 v220, s60, v90
    v_dot2c_f32_bf16 v222, v90, v90
    v_dot2c_f32_bf16 v221, s60, v91
    v_dot2c_f32_bf16 v223, v91, v91
    v_dot2c_f32_bf16 v220, s60, v92
    v_dot2c_f32_bf16 v222, v92, v92
    v_dot2c_f32_bf16 v221, s60, v93
    v_dot2c_f32_bf16 v223, v93, v93
    v_dot2c_f32_bf16 v220, s60, v94
    v_dot2c_f32_bf16 v222, v94, v94
    v_dot2c_f32_bf16 v221, s60, v95
    v_dot2c_f32_bf16 v223, v95, v95
    v_dot2c_f32_bf16 v220, s60, v96
    v_dot2c_f32_bf16 v222, v96, v96
    v_dot2c_f32_bf16 v221, s60, v97
    v_dot2c_f32_bf16 v223, v97, v97
    v_dot2c_f32_bf16 v220, s60, v98
    v_dot2c_f32_bf16 v222, v98, v98
    v_dot2c_f32_bf16 v221, s60, v99
    v_dot2c_f32_bf16 v223, v99, v99
    v_dot2c_f32_bf16 v220, s60, v100
    v_dot2c_f32_bf16 v222, v100, v100
    v_dot2c_f32_bf16 v221, s60, v101
    v_dot2c_f32_bf16 v223, v101, v101
    v_dot2c_f32_bf16 v220, s60, v102
    v_dot2c_f32_bf16 v222, v102, v102
    v_dot2c_f32_bf16 v221, s60, v103
    v_dot2c_f32_bf16 v223, v103, v103
    s_lshl_b32 s76, s2, 2
    s_add_u32 s76, s76, s3
    s_mov_b32 s72, s18
    s_mov_b32 s73, s19
    s_mov_b32 s77, s76
    s_sub_u32 s78, s76, 270
    s_cmp_ge_u32 s76, 270
    s_cselect_b32 s72, s20, s72
    s_cselect_b32 s73, s21, s73
    s_cselect_b32 s77, s78, s77
    s_mov_b32 s74, 2211840
    s_mov_b32 s75, 0x20000
    s_lshl_b32 s77, s77, 13
    v_lshlrev_b32 v252, 7, v0
    buffer_load_dword v251, v252, s[72:75], s77 offen
    s_waitcnt vmcnt(19)
    v_add_u32 v168, 65536, v168
    v_add_u32 v169, 65536, v169
    v_add_u32 v170, 65536, v170
    v_add_u32 v171, 65536, v171
    v_add_u32 v172, 65536, v172
    v_add_u32 v173, 65536, v173
    v_add_u32 v174, 65536, v174
    v_add_u32 v175, 65536, v175
    ds_read_b128 v[136:139], v168 offset:0
    ds_read_b128 v[140:143], v169 offset:0
    ds_read_b128 v[144:147], v170 offset:0
    ds_read_b128 v[148:151], v171 offset:0
    ds_read_b128 v[152:155], v172 offset:0
    ds_read_b128 v[156:159], v173 offset:0
    ds_read_b128 v[160:163], v174 offset:0
    ds_read_b128 v[164:167], v175 offset:0
    v_dot2c_f32_bf16 v220, s60, v104
    v_dot2c_f32_bf16 v222, v104, v104
    v_dot2c_f32_bf16 v221, s60, v105
    v_dot2c_f32_bf16 v223, v105, v105
    v_dot2c_f32_bf16 v220, s60, v106
    v_dot2c_f32_bf16 v222, v106, v106
    v_dot2c_f32_bf16 v221, s60, v107
    v_dot2c_f32_bf16 v223, v107, v107
    v_dot2c_f32_bf16 v220, s60, v108
    v_dot2c_f32_bf16 v222, v108, v108
    v_dot2c_f32_bf16 v221, s60, v109
    v_dot2c_f32_bf16 v223, v109, v109
    v_dot2c_f32_bf16 v220, s60, v110
    v_dot2c_f32_bf16 v222, v110, v110
    v_dot2c_f32_bf16 v221, s60, v111
    v_dot2c_f32_bf16 v223, v111, v111
    v_dot2c_f32_bf16 v220, s60, v112
    v_dot2c_f32_bf16 v222, v112, v112
    v_dot2c_f32_bf16 v221, s60, v113
    v_dot2c_f32_bf16 v223, v113, v113
    v_dot2c_f32_bf16 v220, s60, v114
    v_dot2c_f32_bf16 v222, v114, v114
    v_dot2c_f32_bf16 v221, s60, v115
    v_dot2c_f32_bf16 v223, v115, v115
    v_dot2c_f32_bf16 v220, s60, v116
    v_dot2c_f32_bf16 v222, v116, v116
    v_dot2c_f32_bf16 v221, s60, v117
    v_dot2c_f32_bf16 v223, v117, v117
    v_dot2c_f32_bf16 v220, s60, v118
    v_dot2c_f32_bf16 v222, v118, v118
    v_dot2c_f32_bf16 v221, s60, v119
    v_dot2c_f32_bf16 v223, v119, v119
    s_waitcnt lgkmcnt(0)
    s_barrier
    v_dot2c_f32_bf16 v220, s60, v120
    v_dot2c_f32_bf16 v222, v120, v120
    v_dot2c_f32_bf16 v221, s60, v121
    v_dot2c_f32_bf16 v223, v121, v121
    v_dot2c_f32_bf16 v220, s60, v122
    v_dot2c_f32_bf16 v222, v122, v122
    v_dot2c_f32_bf16 v221, s60, v123
    v_dot2c_f32_bf16 v223, v123, v123
    v_dot2c_f32_bf16 v220, s60, v124
    v_dot2c_f32_bf16 v222, v124, v124
    v_dot2c_f32_bf16 v221, s60, v125
    v_dot2c_f32_bf16 v223, v125, v125
    v_dot2c_f32_bf16 v220, s60, v126
    v_dot2c_f32_bf16 v222, v126, v126
    v_dot2c_f32_bf16 v221, s60, v127
    v_dot2c_f32_bf16 v223, v127, v127
    v_dot2c_f32_bf16 v220, s60, v128
    v_dot2c_f32_bf16 v222, v128, v128
    v_dot2c_f32_bf16 v221, s60, v129
    v_dot2c_f32_bf16 v223, v129, v129
    v_dot2c_f32_bf16 v220, s60, v130
    v_dot2c_f32_bf16 v222, v130, v130
    v_dot2c_f32_bf16 v221, s60, v131
    v_dot2c_f32_bf16 v223, v131, v131
    v_dot2c_f32_bf16 v220, s60, v132
    v_dot2c_f32_bf16 v222, v132, v132
    v_dot2c_f32_bf16 v221, s60, v133
    v_dot2c_f32_bf16 v223, v133, v133
    v_dot2c_f32_bf16 v220, s60, v134
    v_dot2c_f32_bf16 v222, v134, v134
    v_dot2c_f32_bf16 v221, s60, v135
    v_dot2c_f32_bf16 v223, v135, v135
    v_dot2c_f32_bf16 v220, s60, v136
    v_dot2c_f32_bf16 v222, v136, v136
    v_dot2c_f32_bf16 v221, s60, v137
    v_dot2c_f32_bf16 v223, v137, v137
    v_dot2c_f32_bf16 v220, s60, v138
    v_dot2c_f32_bf16 v222, v138, v138
    v_dot2c_f32_bf16 v221, s60, v139
    v_dot2c_f32_bf16 v223, v139, v139
    v_dot2c_f32_bf16 v220, s60, v140
    v_dot2c_f32_bf16 v222, v140, v140
    v_dot2c_f32_bf16 v221, s60, v141
    v_dot2c_f32_bf16 v223, v141, v141
    v_dot2c_f32_bf16 v220, s60, v142
    v_dot2c_f32_bf16 v222, v142, v142
    v_dot2c_f32_bf16 v221, s60, v143
    v_dot2c_f32_bf16 v223, v143, v143
    v_dot2c_f32_bf16 v220, s60, v144
    v_dot2c_f32_bf16 v222, v144, v144
    v_dot2c_f32_bf16 v221, s60, v145
    v_dot2c_f32_bf16 v223, v145, v145
    v_dot2c_f32_bf16 v220, s60, v146
    v_dot2c_f32_bf16 v222, v146, v146
    v_dot2c_f32_bf16 v221, s60, v147
    v_dot2c_f32_bf16 v223, v147, v147
    v_dot2c_f32_bf16 v220, s60, v148
    v_dot2c_f32_bf16 v222, v148, v148
    v_dot2c_f32_bf16 v221, s60, v149
    v_dot2c_f32_bf16 v223, v149, v149
    v_dot2c_f32_bf16 v220, s60, v150
    v_dot2c_f32_bf16 v222, v150, v150
    v_dot2c_f32_bf16 v221, s60, v151
    v_dot2c_f32_bf16 v223, v151, v151
    v_dot2c_f32_bf16 v220, s60, v152
    v_dot2c_f32_bf16 v222, v152, v152
    v_dot2c_f32_bf16 v221, s60, v153
    v_dot2c_f32_bf16 v223, v153, v153
    v_dot2c_f32_bf16 v220, s60, v154
    v_dot2c_f32_bf16 v222, v154, v154
    v_dot2c_f32_bf16 v221, s60, v155
    v_dot2c_f32_bf16 v223, v155, v155
    v_dot2c_f32_bf16 v220, s60, v156
    v_dot2c_f32_bf16 v222, v156, v156
    v_dot2c_f32_bf16 v221, s60, v157
    v_dot2c_f32_bf16 v223, v157, v157
    v_dot2c_f32_bf16 v220, s60, v158
    v_dot2c_f32_bf16 v222, v158, v158
    v_dot2c_f32_bf16 v221, s60, v159
    v_dot2c_f32_bf16 v223, v159, v159
    v_dot2c_f32_bf16 v220, s60, v160
    v_dot2c_f32_bf16 v222, v160, v160
    v_dot2c_f32_bf16 v221, s60, v161
    v_dot2c_f32_bf16 v223, v161, v161
    v_dot2c_f32_bf16 v220, s60, v162
    v_dot2c_f32_bf16 v222, v162, v162
    v_dot2c_f32_bf16 v221, s60, v163
    v_dot2c_f32_bf16 v223, v163, v163
    v_dot2c_f32_bf16 v220, s60, v164
    v_dot2c_f32_bf16 v222, v164, v164
    v_dot2c_f32_bf16 v221, s60, v165
    v_dot2c_f32_bf16 v223, v165, v165
    v_dot2c_f32_bf16 v220, s60, v166
    v_dot2c_f32_bf16 v222, v166, v166
    v_dot2c_f32_bf16 v221, s60, v167
    v_dot2c_f32_bf16 v223, v167, v167
    s_nop 2
    v_add_f32 v216, v220, v221
    v_add_f32 v218, v222, v223
    s_nop 0
    v_mov_b32 v217, v216
    v_mov_b32 v219, v218
    s_nop 1
    v_permlane32_swap_b32 v216, v217
    v_permlane32_swap_b32 v218, v219
    s_nop 1
    v_add_f32 v216, v216, v217
    v_add_f32 v218, v218, v219
    v_mul_f32 v216, 0x3acccccd, v216
    v_mul_f32 v218, 0x3acccccd, v218
    v_fma_f32 v218, -v216, v216, v218
    v_max_f32 v218, 0, v218
    v_cvt_pk_bf16_f32 v217, v216, v218
    v_lshlrev_b32 v216, 16, v217
    v_and_b32 v218, 0xffff0000, v217
    v_add_f32 v218, 0x3727c5ac, v218
    v_cvt_pk_bf16_f32 v218, v218, v218
    v_lshlrev_b32 v218, 16, v218
    v_sqrt_f32 v218, v218
    s_nop 0
    v_cvt_pk_bf16_f32 v218, v218, v218
    v_lshlrev_b32 v218, 16, v218
    v_rcp_f32 v220, v218
    s_nop 0
    v_mul_f32 v221, v216, v220
    v_sub_f32 v221, 0, v221
    s_cmp_lg_u32 s31, 0
    s_cbranch_scc1 nost_1
    buffer_store_dwordx2 v[220:221], v238, s[44:47], s58 offen sc1
nost_1:
    s_mov_b32 s61, 0xffff0000
    v_mul_f32 v222, 0xbfb8aa3b, v220
    v_lshlrev_b32 v240, 16, v8
    v_and_b32 v241, s61, v8
    v_lshlrev_b32 v242, 16, v9
    v_and_b32 v243, s61, v9
    v_sub_f32 v240, v240, v216
    v_sub_f32 v241, v241, v216
    v_sub_f32 v242, v242, v216
    v_sub_f32 v243, v243, v216
    v_cvt_pk_bf16_f32 v8, v240, v241
    v_cvt_pk_bf16_f32 v9, v242, v243
    v_lshlrev_b32 v240, 16, v10
    v_and_b32 v241, s61, v10
    v_lshlrev_b32 v242, 16, v11
    v_and_b32 v243, s61, v11
    v_sub_f32 v240, v240, v216
    v_sub_f32 v241, v241, v216
    v_sub_f32 v242, v242, v216
    v_sub_f32 v243, v243, v216
    v_cvt_pk_bf16_f32 v10, v240, v241
    v_cvt_pk_bf16_f32 v11, v242, v243
    s_waitcnt vmcnt(10)
    s_barrier
    ds_read_b64_tr_b16 a[96:97], v233 offset:0
    ds_read_b64_tr_b16 a[98:99], v233 offset:1152
    ds_read_b64_tr_b16 a[100:101], v233 offset:32
    ds_read_b64_tr_b16 a[102:103], v233 offset:1184
    ds_read_b64_tr_b16 a[104:105], v233 offset:64
    ds_read_b64_tr_b16 a[106:107], v233 offset:1216
    ds_read_b64_tr_b16 a[108:109], v233 offset:96
    ds_read_b64_tr_b16 a[110:111], v233 offset:1248
    ds_read_b64_tr_b16 a[112:113], v233 offset:128
    ds_read_b64_tr_b16 a[114:115], v233 offset:1280
    ds_read_b64_tr_b16 a[116:117], v233 offset:160
    ds_read_b64_tr_b16 a[118:119], v233 offset:1312
    s_waitcnt lgkmcnt(6)
    v_mfma_f32_32x32x16_bf16 v[168:183], a[96:99], v[8:11], 0
    ds_read_b64_tr_b16 a[120:121], v233 offset:192
    ds_read_b64_tr_b16 a[122:123], v233 offset:1344
    s_mov_b32 s59, 442368
    s_add_u32 m0, s53, 74240
    v_lshlrev_b32 v240, 16, v12
    v_and_b32 v241, s61, v12
    v_lshlrev_b32 v242, 16, v13
    v_mfma_f32_32x32x16_bf16 v[184:199], a[100:103], v[8:11], 0
    ds_read_b64_tr_b16 a[124:125], v233 offset:224
    ds_read_b64_tr_b16 a[126:127], v233 offset:1376
    buffer_load_dwordx4 v224, s[36:39], s59 offen lds
    v_and_b32 v243, s61, v13
    v_sub_f32 v240, v240, v216
    v_mfma_f32_32x32x16_bf16 v[200:215], a[104:107], v[8:11], 0
    ds_read_b64_tr_b16 a[128:129], v233 offset:256
    ds_read_b64_tr_b16 a[130:131], v233 offset:1408
    v_sub_f32 v241, v241, v216
    v_sub_f32 v242, v242, v216
    v_sub_f32 v243, v243, v216
    v_cvt_pk_bf16_f32 v12, v240, v241
    v_cvt_pk_bf16_f32 v13, v242, v243
    s_waitcnt lgkmcnt(6)
    v_mfma_f32_32x32x16_bf16 a[0:15], a[108:111], v[8:11], 0
    ds_read_b64_tr_b16 a[96:97], v233 offset:4608
    ds_read_b64_tr_b16 a[98:99], v233 offset:5760
    s_add_u32 m0, s53, 75264
    v_lshlrev_b32 v240, 16, v14
    v_and_b32 v241, s61, v14
    v_lshlrev_b32 v242, 16, v15
    v_and_b32 v243, s61, v15
    v_mfma_f32_32x32x16_bf16 a[16:31], a[112:115], v[8:11], 0
    ds_read_b64_tr_b16 a[100:101], v233 offset:4640
    ds_read_b64_tr_b16 a[102:103], v233 offset:5792
    buffer_load_dwordx4 v225, s[36:39], s59 offen lds
    v_sub_f32 v240, v240, v216
    v_sub_f32 v241, v241, v216
    v_mfma_f32_32x32x16_bf16 a[32:47], a[116:119], v[8:11], 0
    ds_read_b64_tr_b16 a[104:105], v233 offset:4672
    ds_read_b64_tr_b16 a[106:107], v233 offset:5824
    v_sub_f32 v242, v242, v216
    v_sub_f32 v243, v243, v216
    v_cvt_pk_bf16_f32 v14, v240, v241
    v_cvt_pk_bf16_f32 v15, v242, v243
    v_lshlrev_b32 v240, 16, v16
    s_waitcnt lgkmcnt(6)
    v_mfma_f32_32x32x16_bf16 a[48:63], a[120:123], v[8:11], 0
    ds_read_b64_tr_b16 a[108:109], v233 offset:4704
    ds_read_b64_tr_b16 a[110:111], v233 offset:5856
    s_add_u32 m0, s53, 76288
    v_and_b32 v241, s61, v16
    v_lshlrev_b32 v242, 16, v17
    v_and_b32 v243, s61, v17
    v_sub_f32 v240, v240, v216
    v_mfma_f32_32x32x16_bf16 a[64:79], a[124:127], v[8:11], 0
    ds_read_b64_tr_b16 a[112:113], v233 offset:4736
    ds_read_b64_tr_b16 a[114:115], v233 offset:5888
    buffer_load_dwordx4 v226, s[36:39], s59 offen lds
    v_sub_f32 v241, v241, v216
    v_sub_f32 v242, v242, v216
    v_mfma_f32_32x32x16_bf16 a[80:95], a[128:131], v[8:11], 0
    ds_read_b64_tr_b16 a[116:117], v233 offset:4768
    ds_read_b64_tr_b16 a[118:119], v233 offset:5920
    v_sub_f32 v243, v243, v216
    v_cvt_pk_bf16_f32 v16, v240, v241
    v_cvt_pk_bf16_f32 v17, v242, v243
    v_lshlrev_b32 v240, 16, v18
    v_and_b32 v241, s61, v18
    s_waitcnt lgkmcnt(6)
    v_mfma_f32_32x32x16_bf16 v[168:183], a[96:99], v[12:15], v[168:183]
    ds_read_b64_tr_b16 a[120:121], v233 offset:4800
    ds_read_b64_tr_b16 a[122:123], v233 offset:5952
    s_add_u32 m0, s53, 77312
    v_lshlrev_b32 v242, 16, v19
    v_and_b32 v243, s61, v19
    v_sub_f32 v240, v240, v216
    v_sub_f32 v241, v241, v216
    v_mfma_f32_32x32x16_bf16 v[184:199], a[100:103], v[12:15], v[184:199]
    ds_read_b64_tr_b16 a[124:125], v233 offset:4832
    ds_read_b64_tr_b16 a[126:127], v233 offset:5984
    buffer_load_dwordx4 v227, s[36:39], s59 offen lds
    v_sub_f32 v242, v242, v216
    v_sub_f32 v243, v243, v216
    v_mfma_f32_32x32x16_bf16 v[200:215], a[104:107], v[12:15], v[200:215]
    ds_read_b64_tr_b16 a[128:129], v233 offset:4864
    ds_read_b64_tr_b16 a[130:131], v233 offset:6016
    v_cvt_pk_bf16_f32 v18, v240, v241
    v_cvt_pk_bf16_f32 v19, v242, v243
    v_lshlrev_b32 v240, 16, v20
    v_and_b32 v241, s61, v20
    v_lshlrev_b32 v242, 16, v21
    s_waitcnt lgkmcnt(6)
    v_mfma_f32_32x32x16_bf16 a[0:15], a[108:111], v[12:15], a[0:15]
    ds_read_b64_tr_b16 a[96:97], v233 offset:9216
    ds_read_b64_tr_b16 a[98:99], v233 offset:10368
    s_add_u32 m0, s53, 78336
    v_and_b32 v243, s61, v21
    v_sub_f32 v240, v240, v216
    v_sub_f32 v241, v241, v216
    v_sub_f32 v242, v242, v216
    v_mfma_f32_32x32x16_bf16 a[16:31], a[112:115], v[12:15], a[16:31]
    ds_read_b64_tr_b16 a[100:101], v233 offset:9248
    ds_read_b64_tr_b16 a[102:103], v233 offset:10400
    buffer_load_dwordx4 v228, s[36:39], s59 offen lds
    v_sub_f32 v243, v243, v216
    v_cvt_pk_bf16_f32 v20, v240, v241
    v_mfma_f32_32x32x16_bf16 a[32:47], a[116:119], v[12:15], a[32:47]
    ds_read_b64_tr_b16 a[104:105], v233 offset:9280
    ds_read_b64_tr_b16 a[106:107], v233 offset:10432
    v_cvt_pk_bf16_f32 v21, v242, v243
    v_lshlrev_b32 v240, 16, v22
    v_and_b32 v241, s61, v22
    v_lshlrev_b32 v242, 16, v23
    v_and_b32 v243, s61, v23
    s_waitcnt lgkmcnt(6)
    v_mfma_f32_32x32x16_bf16 a[48:63], a[120:123], v[12:15], a[48:63]
    ds_read_b64_tr_b16 a[108:109], v233 offset:9312
    ds_read_b64_tr_b16 a[110:111], v233 offset:10464
    s_add_u32 m0, s53, 79360
    v_sub_f32 v240, v240, v216
    v_sub_f32 v241, v241, v216
    v_sub_f32 v242, v242, v216
    v_sub_f32 v243, v243, v216
    v_mfma_f32_32x32x16_bf16 a[64:79], a[124:127], v[12:15], a[64:79]
    ds_read_b64_tr_b16 a[112:113], v233 offset:9344
    ds_read_b64_tr_b16 a[114:115], v233 offset:10496
    buffer_load_dwordx4 v229, s[36:39], s59 offen lds
    v_cvt_pk_bf16_f32 v22, v240, v241
    v_cvt_pk_bf16_f32 v23, v242, v243
    v_mfma_f32_32x32x16_bf16 a[80:95], a[128:131], v[12:15], a[80:95]
    ds_read_b64_tr_b16 a[116:117], v233 offset:9376
    ds_read_b64_tr_b16 a[118:119], v233 offset:10528
    v_lshlrev_b32 v240, 16, v24
    v_and_b32 v241, s61, v24
    v_lshlrev_b32 v242, 16, v25
    v_and_b32 v243, s61, v25
    v_sub_f32 v240, v240, v216
    s_waitcnt vmcnt(7)
    s_barrier
    s_waitcnt lgkmcnt(6)
    v_mfma_f32_32x32x16_bf16 v[168:183], a[96:99], v[16:19], v[168:183]
    ds_read_b64_tr_b16 a[120:121], v233 offset:9408
    ds_read_b64_tr_b16 a[122:123], v233 offset:10560
    s_add_u32 m0, s53, 80384
    v_sub_f32 v241, v241, v216
    v_sub_f32 v242, v242, v216
    v_sub_f32 v243, v243, v216
    v_cvt_pk_bf16_f32 v24, v240, v241
    v_mfma_f32_32x32x16_bf16 v[184:199], a[100:103], v[16:19], v[184:199]
    ds_read_b64_tr_b16 a[124:125], v233 offset:9440
    ds_read_b64_tr_b16 a[126:127], v233 offset:10592
    buffer_load_dwordx4 v230, s[36:39], s59 offen lds
    v_cvt_pk_bf16_f32 v25, v242, v243
    v_lshlrev_b32 v240, 16, v26
    v_mfma_f32_32x32x16_bf16 v[200:215], a[104:107], v[16:19], v[200:215]
    ds_read_b64_tr_b16 a[128:129], v233 offset:9472
    ds_read_b64_tr_b16 a[130:131], v233 offset:10624
    v_and_b32 v241, s61, v26
    v_lshlrev_b32 v242, 16, v27
    v_and_b32 v243, s61, v27
    v_sub_f32 v240, v240, v216
    v_sub_f32 v241, v241, v216
    s_waitcnt lgkmcnt(6)
    v_mfma_f32_32x32x16_bf16 a[0:15], a[108:111], v[16:19], a[0:15]
    ds_read_b64_tr_b16 a[96:97], v233 offset:13824
    ds_read_b64_tr_b16 a[98:99], v233 offset:14976
    s_add_u32 m0, s53, 81408
    v_sub_f32 v242, v242, v216
    v_sub_f32 v243, v243, v216
    v_cvt_pk_bf16_f32 v26, v240, v241
    v_cvt_pk_bf16_f32 v27, v242, v243
    v_mfma_f32_32x32x16_bf16 a[16:31], a[112:115], v[16:19], a[16:31]
    ds_read_b64_tr_b16 a[100:101], v233 offset:13856
    ds_read_b64_tr_b16 a[102:103], v233 offset:15008
    buffer_load_dwordx4 v231, s[36:39], s59 offen lds
    v_lshlrev_b32 v240, 16, v28
    v_and_b32 v241, s61, v28
    v_mfma_f32_32x32x16_bf16 a[32:47], a[116:119], v[16:19], a[32:47]
    ds_read_b64_tr_b16 a[104:105], v233 offset:13888
    ds_read_b64_tr_b16 a[106:107], v233 offset:15040
    v_lshlrev_b32 v242, 16, v29
    v_and_b32 v243, s61, v29
    v_sub_f32 v240, v240, v216
    v_sub_f32 v241, v241, v216
    v_sub_f32 v242, v242, v216
    s_waitcnt lgkmcnt(6)
    v_mfma_f32_32x32x16_bf16 a[48:63], a[120:123], v[16:19], a[48:63]
    ds_read_b64_tr_b16 a[108:109], v233 offset:13920
    ds_read_b64_tr_b16 a[110:111], v233 offset:15072
    s_add_u32 m0, s53, 82432
    v_sub_f32 v243, v243, v216
    v_cvt_pk_bf16_f32 v28, v240, v241
    v_cvt_pk_bf16_f32 v29, v242, v243
    v_lshlrev_b32 v240, 16, v30
    v_mfma_f32_32x32x16_bf16 a[64:79], a[124:127], v[16:19], a[64:79]
    ds_read_b64_tr_b16 a[112:113], v233 offset:13952
    ds_read_b64_tr_b16 a[114:115], v233 offset:15104
    buffer_load_dwordx4 v232, s[36:39], s59 offen lds
    v_and_b32 v241, s61, v30
    v_lshlrev_b32 v242, 16, v31
    v_mfma_f32_32x32x16_bf16 a[80:95], a[128:131], v[16:19], a[80:95]
    ds_read_b64_tr_b16 a[116:117], v233 offset:13984
    ds_read_b64_tr_b16 a[118:119], v233 offset:15136
    s_mov_b32 s59, 663552
    s_add_u32 m0, s53, 111360
    v_and_b32 v243, s61, v31
    v_sub_f32 v240, v240, v216
    v_sub_f32 v241, v241, v216
    s_waitcnt lgkmcnt(6)
    v_mfma_f32_32x32x16_bf16 v[168:183], a[96:99], v[20:23], v[168:183]
    ds_read_b64_tr_b16 a[120:121], v233 offset:14016
    ds_read_b64_tr_b16 a[122:123], v233 offset:15168
    buffer_load_dwordx4 v224, s[36:39], s59 offen lds
    v_sub_f32 v242, v242, v216
    v_sub_f32 v243, v243, v216
    v_mfma_f32_32x32x16_bf16 v[184:199], a[100:103], v[20:23], v[184:199]
    ds_read_b64_tr_b16 a[124:125], v233 offset:14048
    ds_read_b64_tr_b16 a[126:127], v233 offset:15200
    v_cvt_pk_bf16_f32 v30, v240, v241
    v_cvt_pk_bf16_f32 v31, v242, v243
    v_lshlrev_b32 v240, 16, v32
    v_and_b32 v241, s61, v32
    v_lshlrev_b32 v242, 16, v33
    v_mfma_f32_32x32x16_bf16 v[200:215], a[104:107], v[20:23], v[200:215]
    ds_read_b64_tr_b16 a[128:129], v233 offset:14080
    ds_read_b64_tr_b16 a[130:131], v233 offset:15232
    s_add_u32 m0, s53, 112384
    v_and_b32 v243, s61, v33
    v_sub_f32 v240, v240, v216
    v_sub_f32 v241, v241, v216
    v_sub_f32 v242, v242, v216
    s_waitcnt lgkmcnt(6)
    v_mfma_f32_32x32x16_bf16 a[0:15], a[108:111], v[20:23], a[0:15]
    ds_read_b64_tr_b16 a[96:97], v234 offset:0
    ds_read_b64_tr_b16 a[98:99], v234 offset:1152
    buffer_load_dwordx4 v225, s[36:39], s59 offen lds
    v_sub_f32 v243, v243, v216
    v_cvt_pk_bf16_f32 v32, v240, v241
    v_mfma_f32_32x32x16_bf16 a[16:31], a[112:115], v[20:23], a[16:31]
    ds_read_b64_tr_b16 a[100:101], v234 offset:32
    ds_read_b64_tr_b16 a[102:103], v234 offset:1184
    v_cvt_pk_bf16_f32 v33, v242, v243
    v_lshlrev_b32 v240, 16, v34
    v_and_b32 v241, s61, v34
    v_lshlrev_b32 v242, 16, v35
    v_and_b32 v243, s61, v35
    v_mfma_f32_32x32x16_bf16 a[32:47], a[116:119], v[20:23], a[32:47]
    ds_read_b64_tr_b16 a[104:105], v234 offset:64
    ds_read_b64_tr_b16 a[106:107], v234 offset:1216
    s_add_u32 m0, s53, 113408
    v_sub_f32 v240, v240, v216
    v_sub_f32 v241, v241, v216
    v_sub_f32 v242, v242, v216
    v_sub_f32 v243, v243, v216
    s_waitcnt lgkmcnt(6)
    v_mfma_f32_32x32x16_bf16 a[48:63], a[120:123], v[20:23], a[48:63]
    ds_read_b64_tr_b16 a[108:109], v234 offset:96
    ds_read_b64_tr_b16 a[110:111], v234 offset:1248
    buffer_load_dwordx4 v226, s[36:39], s59 offen lds
    v_cvt_pk_bf16_f32 v34, v240, v241
    v_cvt_pk_bf16_f32 v35, v242, v243
    v_mfma_f32_32x32x16_bf16 a[64:79], a[124:127], v[20:23], a[64:79]
    ds_read_b64_tr_b16 a[112:113], v234 offset:128
    ds_read_b64_tr_b16 a[114:115], v234 offset:1280
    v_lshlrev_b32 v240, 16, v36
    v_and_b32 v241, s61, v36
    v_lshlrev_b32 v242, 16, v37
    v_and_b32 v243, s61, v37
    v_sub_f32 v240, v240, v216
    v_mfma_f32_32x32x16_bf16 a[80:95], a[128:131], v[20:23], a[80:95]
    ds_read_b64_tr_b16 a[116:117], v234 offset:160
    ds_read_b64_tr_b16 a[118:119], v234 offset:1312
    s_add_u32 m0, s53, 114432
    v_sub_f32 v241, v241, v216
    v_sub_f32 v242, v242, v216
    v_sub_f32 v243, v243, v216
    v_cvt_pk_bf16_f32 v36, v240, v241
    s_waitcnt vmcnt(3)
    s_barrier
    s_waitcnt lgkmcnt(6)
    v_mfma_f32_32x32x16_bf16 v[168:183], a[96:99], v[24:27], v[168:183]
    ds_read_b64_tr_b16 a[120:121], v234 offset:192
    ds_read_b64_tr_b16 a[122:123], v234 offset:1344
    buffer_load_dwordx4 v227, s[36:39], s59 offen lds
    v_cvt_pk_bf16_f32 v37, v242, v243
    v_lshlrev_b32 v240, 16, v38
    v_mfma_f32_32x32x16_bf16 v[184:199], a[100:103], v[24:27], v[184:199]
    ds_read_b64_tr_b16 a[124:125], v234 offset:224
    ds_read_b64_tr_b16 a[126:127], v234 offset:1376
    v_and_b32 v241, s61, v38
    v_lshlrev_b32 v242, 16, v39
    v_and_b32 v243, s61, v39
    v_sub_f32 v240, v240, v216
    v_sub_f32 v241, v241, v216
    v_mfma_f32_32x32x16_bf16 v[200:215], a[104:107], v[24:27], v[200:215]
    ds_read_b64_tr_b16 a[128:129], v234 offset:256
    ds_read_b64_tr_b16 a[130:131], v234 offset:1408
    s_add_u32 m0, s53, 115456
    v_sub_f32 v242, v242, v216
    v_sub_f32 v243, v243, v216
    v_cvt_pk_bf16_f32 v38, v240, v241
    v_cvt_pk_bf16_f32 v39, v242, v243
    s_waitcnt lgkmcnt(6)
    v_mfma_f32_32x32x16_bf16 a[0:15], a[108:111], v[24:27], a[0:15]
    ds_read_b64_tr_b16 a[96:97], v234 offset:4608
    ds_read_b64_tr_b16 a[98:99], v234 offset:5760
    buffer_load_dwordx4 v228, s[36:39], s59 offen lds
    v_lshlrev_b32 v240, 16, v40
    v_and_b32 v241, s61, v40
    v_mfma_f32_32x32x16_bf16 a[16:31], a[112:115], v[24:27], a[16:31]
    ds_read_b64_tr_b16 a[100:101], v234 offset:4640
    ds_read_b64_tr_b16 a[102:103], v234 offset:5792
    v_lshlrev_b32 v242, 16, v41
    v_and_b32 v243, s61, v41
    v_sub_f32 v240, v240, v216
    v_sub_f32 v241, v241, v216
    v_sub_f32 v242, v242, v216
    v_mfma_f32_32x32x16_bf16 a[32:47], a[116:119], v[24:27], a[32:47]
    ds_read_b64_tr_b16 a[104:105], v234 offset:4672
    ds_read_b64_tr_b16 a[106:107], v234 offset:5824
    s_add_u32 m0, s53, 116480
    v_sub_f32 v243, v243, v216
    v_cvt_pk_bf16_f32 v40, v240, v241
    v_cvt_pk_bf16_f32 v41, v242, v243
    v_lshlrev_b32 v240, 16, v42
    s_waitcnt lgkmcnt(6)
    v_mfma_f32_32x32x16_bf16 a[48:63], a[120:123], v[24:27], a[48:63]
    ds_read_b64_tr_b16 a[108:109], v234 offset:4704
    ds_read_b64_tr_b16 a[110:111], v234 offset:5856
    buffer_load_dwordx4 v229, s[36:39], s59 offen lds
    v_and_b32 v241, s61, v42
    v_lshlrev_b32 v242, 16, v43
    v_mfma_f32_32x32x16_bf16 a[64:79], a[124:127], v[24:27], a[64:79]
    ds_read_b64_tr_b16 a[112:113], v234 offset:4736
    ds_read_b64_tr_b16 a[114:115], v234 offset:5888
    v_and_b32 v243, s61, v43
    v_sub_f32 v240, v240, v216
    v_sub_f32 v241, v241, v216
    v_sub_f32 v242, v242, v216
    v_sub_f32 v243, v243, v216
    v_mfma_f32_32x32x16_bf16 a[80:95], a[128:131], v[24:27], a[80:95]
    ds_read_b64_tr_b16 a[116:117], v234 offset:4768
    ds_read_b64_tr_b16 a[118:119], v234 offset:5920
    s_add_u32 m0, s53, 117504
    v_cvt_pk_bf16_f32 v42, v240, v241
    v_cvt_pk_bf16_f32 v43, v242, v243
    v_lshlrev_b32 v240, 16, v44
    v_and_b32 v241, s61, v44
    s_waitcnt lgkmcnt(6)
    v_mfma_f32_32x32x16_bf16 v[168:183], a[96:99], v[28:31], v[168:183]
    ds_read_b64_tr_b16 a[120:121], v234 offset:4800
    ds_read_b64_tr_b16 a[122:123], v234 offset:5952
    buffer_load_dwordx4 v230, s[36:39], s59 offen lds
    v_lshlrev_b32 v242, 16, v45
    v_and_b32 v243, s61, v45
    v_mfma_f32_32x32x16_bf16 v[184:199], a[100:103], v[28:31], v[184:199]
    ds_read_b64_tr_b16 a[124:125], v234 offset:4832
    ds_read_b64_tr_b16 a[126:127], v234 offset:5984
    v_sub_f32 v240, v240, v216
    v_sub_f32 v241, v241, v216
    v_sub_f32 v242, v242, v216
    v_sub_f32 v243, v243, v216
    v_cvt_pk_bf16_f32 v44, v240, v241
    v_mfma_f32_32x32x16_bf16 v[200:215], a[104:107], v[28:31], v[200:215]
    ds_read_b64_tr_b16 a[128:129], v234 offset:4864
    ds_read_b64_tr_b16 a[130:131], v234 offset:6016
    s_add_u32 m0, s53, 118528
    v_cvt_pk_bf16_f32 v45, v242, v243
    v_lshlrev_b32 v240, 16, v46
    v_and_b32 v241, s61, v46
    v_lshlrev_b32 v242, 16, v47
    s_waitcnt lgkmcnt(6)
    v_mfma_f32_32x32x16_bf16 a[0:15], a[108:111], v[28:31], a[0:15]
    ds_read_b64_tr_b16 a[96:97], v234 offset:9216
    ds_read_b64_tr_b16 a[98:99], v234 offset:10368
    buffer_load_dwordx4 v231, s[36:39], s59 offen lds
    v_and_b32 v243, s61, v47
    v_sub_f32 v240, v240, v216
    v_mfma_f32_32x32x16_bf16 a[16:31], a[112:115], v[28:31], a[16:31]
    ds_read_b64_tr_b16 a[100:101], v234 offset:9248
    ds_read_b64_tr_b16 a[102:103], v234 offset:10400
    v_sub_f32 v241, v241, v216
    v_sub_f32 v242, v242, v216
    v_sub_f32 v243, v243, v216
    v_cvt_pk_bf16_f32 v46, v240, v241
    v_cvt_pk_bf16_f32 v47, v242, v243
    v_mfma_f32_32x32x16_bf16 a[32:47], a[116:119], v[28:31], a[32:47]
    ds_read_b64_tr_b16 a[104:105], v234 offset:9280
    ds_read_b64_tr_b16 a[106:107], v234 offset:10432
    s_add_u32 m0, s53, 119552
    v_lshlrev_b32 v240, 16, v48
    v_and_b32 v241, s61, v48
    v_lshlrev_b32 v242, 16, v49
    v_and_b32 v243, s61, v49
    s_waitcnt lgkmcnt(6)
    v_mfma_f32_32x32x16_bf16 a[48:63], a[120:123], v[28:31], a[48:63]
    ds_read_b64_tr_b16 a[108:109], v234 offset:9312
    ds_read_b64_tr_b16 a[110:111], v234 offset:10464
    buffer_load_dwordx4 v232, s[36:39], s59 offen lds
    v_sub_f32 v240, v240, v216
    v_sub_f32 v241, v241, v216
    v_mfma_f32_32x32x16_bf16 a[64:79], a[124:127], v[28:31], a[64:79]
    ds_read_b64_tr_b16 a[112:113], v234 offset:9344
    ds_read_b64_tr_b16 a[114:115], v234 offset:10496
    s_mov_b32 s59, 884736
    s_add_u32 m0, s53, 0
    v_sub_f32 v242, v242, v216
    v_sub_f32 v243, v243, v216
    v_cvt_pk_bf16_f32 v48, v240, v241
    v_mfma_f32_32x32x16_bf16 a[80:95], a[128:131], v[28:31], a[80:95]
    ds_read_b64_tr_b16 a[116:117], v234 offset:9376
    ds_read_b64_tr_b16 a[118:119], v234 offset:10528
    buffer_load_dwordx4 v224, s[36:39], s59 offen lds
    v_cvt_pk_bf16_f32 v49, v242, v243
    v_lshlrev_b32 v240, 16, v50
    s_waitcnt lgkmcnt(6)
    v_mfma_f32_32x32x16_bf16 v[168:183], a[96:99], v[32:35], v[168:183]
    ds_read_b64_tr_b16 a[120:121], v234 offset:9408
    ds_read_b64_tr_b16 a[122:123], v234 offset:10560
    v_and_b32 v241, s61, v50
    v_lshlrev_b32 v242, 16, v51
    v_and_b32 v243, s61, v51
    v_sub_f32 v240, v240, v216
    v_sub_f32 v241, v241, v216
    v_mfma_f32_32x32x16_bf16 v[184:199], a[100:103], v[32:35], v[184:199]
    ds_read_b64_tr_b16 a[124:125], v234 offset:9440
    ds_read_b64_tr_b16 a[126:127], v234 offset:10592
    s_add_u32 m0, s53, 1024
    v_sub_f32 v242, v242, v216
    v_sub_f32 v243, v243, v216
    v_cvt_pk_bf16_f32 v50, v240, v241
    v_cvt_pk_bf16_f32 v51, v242, v243
    v_mfma_f32_32x32x16_bf16 v[200:215], a[104:107], v[32:35], v[200:215]
    ds_read_b64_tr_b16 a[128:129], v234 offset:9472
    ds_read_b64_tr_b16 a[130:131], v234 offset:10624
    buffer_load_dwordx4 v225, s[36:39], s59 offen lds
    v_lshlrev_b32 v240, 16, v52
    v_and_b32 v241, s61, v52
    s_waitcnt lgkmcnt(6)
    v_mfma_f32_32x32x16_bf16 a[0:15], a[108:111], v[32:35], a[0:15]
    ds_read_b64_tr_b16 a[96:97], v234 offset:13824
    ds_read_b64_tr_b16 a[98:99], v234 offset:14976
    v_lshlrev_b32 v242, 16, v53
    v_and_b32 v243, s61, v53
    v_sub_f32 v240, v240, v216
    v_sub_f32 v241, v241, v216
    v_sub_f32 v242, v242, v216
    v_mfma_f32_32x32x16_bf16 a[16:31], a[112:115], v[32:35], a[16:31]
    ds_read_b64_tr_b16 a[100:101], v234 offset:13856
    ds_read_b64_tr_b16 a[102:103], v234 offset:15008
    s_add_u32 m0, s53, 2048
    v_sub_f32 v243, v243, v216
    v_cvt_pk_bf16_f32 v52, v240, v241
    v_cvt_pk_bf16_f32 v53, v242, v243
    v_lshlrev_b32 v240, 16, v54
    v_mfma_f32_32x32x16_bf16 a[32:47], a[116:119], v[32:35], a[32:47]
    ds_read_b64_tr_b16 a[104:105], v234 offset:13888
    ds_read_b64_tr_b16 a[106:107], v234 offset:15040
    buffer_load_dwordx4 v226, s[36:39], s59 offen lds
    v_and_b32 v241, s61, v54
    v_lshlrev_b32 v242, 16, v55
    s_waitcnt lgkmcnt(6)
    v_mfma_f32_32x32x16_bf16 a[48:63], a[120:123], v[32:35], a[48:63]
    ds_read_b64_tr_b16 a[108:109], v234 offset:13920
    ds_read_b64_tr_b16 a[110:111], v234 offset:15072
    v_and_b32 v243, s61, v55
    v_sub_f32 v240, v240, v216
    v_sub_f32 v241, v241, v216
    v_sub_f32 v242, v242, v216
    v_sub_f32 v243, v243, v216
    v_mfma_f32_32x32x16_bf16 a[64:79], a[124:127], v[32:35], a[64:79]
    ds_read_b64_tr_b16 a[112:113], v234 offset:13952
    ds_read_b64_tr_b16 a[114:115], v234 offset:15104
    s_add_u32 m0, s53, 3072
    v_cvt_pk_bf16_f32 v54, v240, v241
    v_cvt_pk_bf16_f32 v55, v242, v243
    v_lshlrev_b32 v240, 16, v56
    v_and_b32 v241, s61, v56
    v_mfma_f32_32x32x16_bf16 a[80:95], a[128:131], v[32:35], a[80:95]
    ds_read_b64_tr_b16 a[116:117], v234 offset:13984
    ds_read_b64_tr_b16 a[118:119], v234 offset:15136
    buffer_load_dwordx4 v227, s[36:39], s59 offen lds
    v_lshlrev_b32 v242, 16, v57
    v_and_b32 v243, s61, v57
    s_waitcnt lgkmcnt(6)
    v_mfma_f32_32x32x16_bf16 v[168:183], a[96:99], v[36:39], v[168:183]
    ds_read_b64_tr_b16 a[120:121], v234 offset:14016
    ds_read_b64_tr_b16 a[122:123], v234 offset:15168
    v_sub_f32 v240, v240, v216
    v_sub_f32 v241, v241, v216
    v_sub_f32 v242, v242, v216
    v_sub_f32 v243, v243, v216
    v_cvt_pk_bf16_f32 v56, v240, v241
    v_mfma_f32_32x32x16_bf16 v[184:199], a[100:103], v[36:39], v[184:199]
    ds_read_b64_tr_b16 a[124:125], v234 offset:14048
    ds_read_b64_tr_b16 a[126:127], v234 offset:15200
    s_add_u32 m0, s53, 4096
    v_cvt_pk_bf16_f32 v57, v242, v243
    v_lshlrev_b32 v240, 16, v58
    v_and_b32 v241, s61, v58
    v_lshlrev_b32 v242, 16, v59
    v_mfma_f32_32x32x16_bf16 v[200:215], a[104:107], v[36:39], v[200:215]
    ds_read_b64_tr_b16 a[128:129], v234 offset:14080
    ds_read_b64_tr_b16 a[130:131], v234 offset:15232
    buffer_load_dwordx4 v228, s[36:39], s59 offen lds
    v_and_b32 v243, s61, v59
    v_sub_f32 v240, v240, v216
    s_waitcnt lgkmcnt(6)
    v_mfma_f32_32x32x16_bf16 a[0:15], a[108:111], v[36:39], a[0:15]
    ds_read_b64_tr_b16 a[96:97], v235 offset:0
    ds_read_b64_tr_b16 a[98:99], v235 offset:1152
    v_sub_f32 v241, v241, v216
    v_sub_f32 v242, v242, v216
    v_sub_f32 v243, v243, v216
    v_cvt_pk_bf16_f32 v58, v240, v241
    v_cvt_pk_bf16_f32 v59, v242, v243
    v_mfma_f32_32x32x16_bf16 a[16:31], a[112:115], v[36:39], a[16:31]
    ds_read_b64_tr_b16 a[100:101], v235 offset:32
    ds_read_b64_tr_b16 a[102:103], v235 offset:1184
    s_add_u32 m0, s53, 5120
    v_lshlrev_b32 v240, 16, v60
    v_and_b32 v241, s61, v60
    v_lshlrev_b32 v242, 16, v61
    v_and_b32 v243, s61, v61
    v_mfma_f32_32x32x16_bf16 a[32:47], a[116:119], v[36:39], a[32:47]
    ds_read_b64_tr_b16 a[104:105], v235 offset:64
    ds_read_b64_tr_b16 a[106:107], v235 offset:1216
    buffer_load_dwordx4 v229, s[36:39], s59 offen lds
    v_sub_f32 v240, v240, v216
    v_sub_f32 v241, v241, v216
    s_waitcnt lgkmcnt(6)
    v_mfma_f32_32x32x16_bf16 a[48:63], a[120:123], v[36:39], a[48:63]
    ds_read_b64_tr_b16 a[108:109], v235 offset:96
    ds_read_b64_tr_b16 a[110:111], v235 offset:1248
    v_sub_f32 v242, v242, v216
    v_sub_f32 v243, v243, v216
    v_cvt_pk_bf16_f32 v60, v240, v241
    v_cvt_pk_bf16_f32 v61, v242, v243
    v_lshlrev_b32 v240, 16, v62
    v_mfma_f32_32x32x16_bf16 a[64:79], a[124:127], v[36:39], a[64:79]
    ds_read_b64_tr_b16 a[112:113], v235 offset:128
    ds_read_b64_tr_b16 a[114:115], v235 offset:1280
    s_add_u32 m0, s53, 6144
    v_and_b32 v241, s61, v62
    v_lshlrev_b32 v242, 16, v63
    v_and_b32 v243, s61, v63
    v_sub_f32 v240, v240, v216
    v_mfma_f32_32x32x16_bf16 a[80:95], a[128:131], v[36:39], a[80:95]
    ds_read_b64_tr_b16 a[116:117], v235 offset:160
    ds_read_b64_tr_b16 a[118:119], v235 offset:1312
    buffer_load_dwordx4 v230, s[36:39], s59 offen lds
    v_sub_f32 v241, v241, v216
    v_sub_f32 v242, v242, v216
    s_waitcnt vmcnt(7)
    s_barrier
    s_waitcnt lgkmcnt(6)
    v_mfma_f32_32x32x16_bf16 v[168:183], a[96:99], v[40:43], v[168:183]
    ds_read_b64_tr_b16 a[120:121], v235 offset:192
    ds_read_b64_tr_b16 a[122:123], v235 offset:1344
    v_sub_f32 v243, v243, v216
    v_cvt_pk_bf16_f32 v62, v240, v241
    v_cvt_pk_bf16_f32 v63, v242, v243
    v_lshlrev_b32 v240, 16, v64
    v_and_b32 v241, s61, v64
    v_mfma_f32_32x32x16_bf16 v[184:199], a[100:103], v[40:43], v[184:199]
    ds_read_b64_tr_b16 a[124:125], v235 offset:224
    ds_read_b64_tr_b16 a[126:127], v235 offset:1376
    s_add_u32 m0, s53, 7168
    v_lshlrev_b32 v242, 16, v65
    v_and_b32 v243, s61, v65
    v_sub_f32 v240, v240, v216
    v_sub_f32 v241, v241, v216
    v_mfma_f32_32x32x16_bf16 v[200:215], a[104:107], v[40:43], v[200:215]
    ds_read_b64_tr_b16 a[128:129], v235 offset:256
    ds_read_b64_tr_b16 a[130:131], v235 offset:1408
    buffer_load_dwordx4 v231, s[36:39], s59 offen lds
    v_sub_f32 v242, v242, v216
    v_sub_f32 v243, v243, v216
    s_waitcnt lgkmcnt(6)
    v_mfma_f32_32x32x16_bf16 a[0:15], a[108:111], v[40:43], a[0:15]
    ds_read_b64_tr_b16 a[96:97], v235 offset:4608
    ds_read_b64_tr_b16 a[98:99], v235 offset:5760
    v_cvt_pk_bf16_f32 v64, v240, v241
    v_cvt_pk_bf16_f32 v65, v242, v243
    v_lshlrev_b32 v240, 16, v66
    v_and_b32 v241, s61, v66
    v_lshlrev_b32 v242, 16, v67
    v_mfma_f32_32x32x16_bf16 a[16:31], a[112:115], v[40:43], a[16:31]
    ds_read_b64_tr_b16 a[100:101], v235 offset:4640
    ds_read_b64_tr_b16 a[102:103], v235 offset:5792
    s_add_u32 m0, s53, 8192
    v_and_b32 v243, s61, v67
    v_sub_f32 v240, v240, v216
    v_sub_f32 v241, v241, v216
    v_sub_f32 v242, v242, v216
    v_mfma_f32_32x32x16_bf16 a[32:47], a[116:119], v[40:43], a[32:47]
    ds_read_b64_tr_b16 a[104:105], v235 offset:4672
    ds_read_b64_tr_b16 a[106:107], v235 offset:5824
    buffer_load_dwordx4 v232, s[36:39], s59 offen lds
    v_sub_f32 v243, v243, v216
    v_cvt_pk_bf16_f32 v66, v240, v241
    s_waitcnt lgkmcnt(6)
    v_mfma_f32_32x32x16_bf16 a[48:63], a[120:123], v[40:43], a[48:63]
    ds_read_b64_tr_b16 a[108:109], v235 offset:4704
    ds_read_b64_tr_b16 a[110:111], v235 offset:5856
    s_mov_b32 s59, 1105920
    s_add_u32 m0, s53, 37120
    v_cvt_pk_bf16_f32 v67, v242, v243
    v_lshlrev_b32 v240, 16, v68
    v_and_b32 v241, s61, v68
    v_mfma_f32_32x32x16_bf16 a[64:79], a[124:127], v[40:43], a[64:79]
    ds_read_b64_tr_b16 a[112:113], v235 offset:4736
    ds_read_b64_tr_b16 a[114:115], v235 offset:5888
    buffer_load_dwordx4 v224, s[36:39], s59 offen lds
    v_lshlrev_b32 v242, 16, v69
    v_and_b32 v243, s61, v69
    v_mfma_f32_32x32x16_bf16 a[80:95], a[128:131], v[40:43], a[80:95]
    ds_read_b64_tr_b16 a[116:117], v235 offset:4768
    ds_read_b64_tr_b16 a[118:119], v235 offset:5920
    v_sub_f32 v240, v240, v216
    v_sub_f32 v241, v241, v216
    v_sub_f32 v242, v242, v216
    v_sub_f32 v243, v243, v216
    v_cvt_pk_bf16_f32 v68, v240, v241
    s_waitcnt lgkmcnt(6)
    v_mfma_f32_32x32x16_bf16 v[168:183], a[96:99], v[44:47], v[168:183]
    ds_read_b64_tr_b16 a[120:121], v235 offset:4800
    ds_read_b64_tr_b16 a[122:123], v235 offset:5952
    s_add_u32 m0, s53, 38144
    v_cvt_pk_bf16_f32 v69, v242, v243
    v_lshlrev_b32 v240, 16, v70
    v_and_b32 v241, s61, v70
    v_lshlrev_b32 v242, 16, v71
    v_mfma_f32_32x32x16_bf16 v[184:199], a[100:103], v[44:47], v[184:199]
    ds_read_b64_tr_b16 a[124:125], v235 offset:4832
    ds_read_b64_tr_b16 a[126:127], v235 offset:5984
    buffer_load_dwordx4 v225, s[36:39], s59 offen lds
    v_and_b32 v243, s61, v71
    v_sub_f32 v240, v240, v216
    v_mfma_f32_32x32x16_bf16 v[200:215], a[104:107], v[44:47], v[200:215]
    ds_read_b64_tr_b16 a[128:129], v235 offset:4864
    ds_read_b64_tr_b16 a[130:131], v235 offset:6016
    v_sub_f32 v241, v241, v216
    v_sub_f32 v242, v242, v216
    v_sub_f32 v243, v243, v216
    v_cvt_pk_bf16_f32 v70, v240, v241
    v_cvt_pk_bf16_f32 v71, v242, v243
    s_waitcnt lgkmcnt(6)
    v_mfma_f32_32x32x16_bf16 a[0:15], a[108:111], v[44:47], a[0:15]
    ds_read_b64_tr_b16 a[96:97], v235 offset:9216
    ds_read_b64_tr_b16 a[98:99], v235 offset:10368
    s_add_u32 m0, s53, 39168
    v_lshlrev_b32 v240, 16, v72
    v_and_b32 v241, s61, v72
    v_lshlrev_b32 v242, 16, v73
    v_and_b32 v243, s61, v73
    v_mfma_f32_32x32x16_bf16 a[16:31], a[112:115], v[44:47], a[16:31]
    ds_read_b64_tr_b16 a[100:101], v235 offset:9248
    ds_read_b64_tr_b16 a[102:103], v235 offset:10400
    buffer_load_dwordx4 v226, s[36:39], s59 offen lds
    v_sub_f32 v240, v240, v216
    v_sub_f32 v241, v241, v216
    v_mfma_f32_32x32x16_bf16 a[32:47], a[116:119], v[44:47], a[32:47]
    ds_read_b64_tr_b16 a[104:105], v235 offset:9280
    ds_read_b64_tr_b16 a[106:107], v235 offset:10432
    v_sub_f32 v242, v242, v216
    v_sub_f32 v243, v243, v216
    v_cvt_pk_bf16_f32 v72, v240, v241
    v_cvt_pk_bf16_f32 v73, v242, v243
    v_lshlrev_b32 v240, 16, v74
    s_waitcnt lgkmcnt(6)
    v_mfma_f32_32x32x16_bf16 a[48:63], a[120:123], v[44:47], a[48:63]
    ds_read_b64_tr_b16 a[108:109], v235 offset:9312
    ds_read_b64_tr_b16 a[110:111], v235 offset:10464
    s_add_u32 m0, s53, 40192
    v_and_b32 v241, s61, v74
    v_lshlrev_b32 v242, 16, v75
    v_and_b32 v243, s61, v75
    v_sub_f32 v240, v240, v216
    v_mfma_f32_32x32x16_bf16 a[64:79], a[124:127], v[44:47], a[64:79]
    ds_read_b64_tr_b16 a[112:113], v235 offset:9344
    ds_read_b64_tr_b16 a[114:115], v235 offset:10496
    buffer_load_dwordx4 v227, s[36:39], s59 offen lds
    v_sub_f32 v241, v241, v216
    v_sub_f32 v242, v242, v216
    v_mfma_f32_32x32x16_bf16 a[80:95], a[128:131], v[44:47], a[80:95]
    ds_read_b64_tr_b16 a[116:117], v235 offset:9376
    ds_read_b64_tr_b16 a[118:119], v235 offset:10528
    v_sub_f32 v243, v243, v216
    v_cvt_pk_bf16_f32 v74, v240, v241
    v_cvt_pk_bf16_f32 v75, v242, v243
    v_lshlrev_b32 v240, 16, v76
    v_and_b32 v241, s61, v76
    s_waitcnt lgkmcnt(6)
    v_mfma_f32_32x32x16_bf16 v[168:183], a[96:99], v[48:51], v[168:183]
    ds_read_b64_tr_b16 a[120:121], v235 offset:9408
    ds_read_b64_tr_b16 a[122:123], v235 offset:10560
    s_add_u32 m0, s53, 41216
    v_lshlrev_b32 v242, 16, v77
    v_and_b32 v243, s61, v77
    v_sub_f32 v240, v240, v216
    v_sub_f32 v241, v241, v216
    v_mfma_f32_32x32x16_bf16 v[184:199], a[100:103], v[48:51], v[184:199]
    ds_read_b64_tr_b16 a[124:125], v235 offset:9440
    ds_read_b64_tr_b16 a[126:127], v235 offset:10592
    buffer_load_dwordx4 v228, s[36:39], s59 offen lds
    v_sub_f32 v242, v242, v216
    v_sub_f32 v243, v243, v216
    v_mfma_f32_32x32x16_bf16 v[200:215], a[104:107], v[48:51], v[200:215]
    ds_read_b64_tr_b16 a[128:129], v235 offset:9472
    ds_read_b64_tr_b16 a[130:131], v235 offset:10624
    v_cvt_pk_bf16_f32 v76, v240, v241
    v_cvt_pk_bf16_f32 v77, v242, v243
    v_lshlrev_b32 v240, 16, v78
    v_and_b32 v241, s61, v78
    v_lshlrev_b32 v242, 16, v79
    s_waitcnt lgkmcnt(6)
    v_mfma_f32_32x32x16_bf16 a[0:15], a[108:111], v[48:51], a[0:15]
    ds_read_b64_tr_b16 a[96:97], v235 offset:13824
    ds_read_b64_tr_b16 a[98:99], v235 offset:14976
    s_add_u32 m0, s53, 42240
    v_and_b32 v243, s61, v79
    v_sub_f32 v240, v240, v216
    v_sub_f32 v241, v241, v216
    v_sub_f32 v242, v242, v216
    v_mfma_f32_32x32x16_bf16 a[16:31], a[112:115], v[48:51], a[16:31]
    ds_read_b64_tr_b16 a[100:101], v235 offset:13856
    ds_read_b64_tr_b16 a[102:103], v235 offset:15008
    buffer_load_dwordx4 v229, s[36:39], s59 offen lds
    v_sub_f32 v243, v243, v216
    v_cvt_pk_bf16_f32 v78, v240, v241
    v_mfma_f32_32x32x16_bf16 a[32:47], a[116:119], v[48:51], a[32:47]
    ds_read_b64_tr_b16 a[104:105], v235 offset:13888
    ds_read_b64_tr_b16 a[106:107], v235 offset:15040
    v_cvt_pk_bf16_f32 v79, v242, v243
    v_lshlrev_b32 v240, 16, v80
    v_and_b32 v241, s61, v80
    v_lshlrev_b32 v242, 16, v81
    v_and_b32 v243, s61, v81
    s_waitcnt lgkmcnt(6)
    v_mfma_f32_32x32x16_bf16 a[48:63], a[120:123], v[48:51], a[48:63]
    ds_read_b64_tr_b16 a[108:109], v235 offset:13920
    ds_read_b64_tr_b16 a[110:111], v235 offset:15072
    s_add_u32 m0, s53, 43264
    v_sub_f32 v240, v240, v216
    v_sub_f32 v241, v241, v216
    v_sub_f32 v242, v242, v216
    v_sub_f32 v243, v243, v216
    v_mfma_f32_32x32x16_bf16 a[64:79], a[124:127], v[48:51], a[64:79]
    ds_read_b64_tr_b16 a[112:113], v235 offset:13952
    ds_read_b64_tr_b16 a[114:115], v235 offset:15104
    buffer_load_dwordx4 v230, s[36:39], s59 offen lds
    v_cvt_pk_bf16_f32 v80, v240, v241
    v_cvt_pk_bf16_f32 v81, v242, v243
    v_mfma_f32_32x32x16_bf16 a[80:95], a[128:131], v[48:51], a[80:95]
    ds_read_b64_tr_b16 a[116:117], v235 offset:13984
    ds_read_b64_tr_b16 a[118:119], v235 offset:15136
    v_lshlrev_b32 v240, 16, v82
    v_and_b32 v241, s61, v82
    v_lshlrev_b32 v242, 16, v83
    v_and_b32 v243, s61, v83
    v_sub_f32 v240, v240, v216
    s_waitcnt lgkmcnt(6)
    v_mfma_f32_32x32x16_bf16 v[168:183], a[96:99], v[52:55], v[168:183]
    ds_read_b64_tr_b16 a[120:121], v235 offset:14016
    ds_read_b64_tr_b16 a[122:123], v235 offset:15168
    s_add_u32 m0, s53, 44288
    v_sub_f32 v241, v241, v216
    v_sub_f32 v242, v242, v216
    v_sub_f32 v243, v243, v216
    v_cvt_pk_bf16_f32 v82, v240, v241
    v_mfma_f32_32x32x16_bf16 v[184:199], a[100:103], v[52:55], v[184:199]
    ds_read_b64_tr_b16 a[124:125], v235 offset:14048
    ds_read_b64_tr_b16 a[126:127], v235 offset:15200
    buffer_load_dwordx4 v231, s[36:39], s59 offen lds
    v_cvt_pk_bf16_f32 v83, v242, v243
    v_lshlrev_b32 v240, 16, v84
    v_mfma_f32_32x32x16_bf16 v[200:215], a[104:107], v[52:55], v[200:215]
    ds_read_b64_tr_b16 a[128:129], v235 offset:14080
    ds_read_b64_tr_b16 a[130:131], v235 offset:15232
    v_and_b32 v241, s61, v84
    v_lshlrev_b32 v242, 16, v85
    v_and_b32 v243, s61, v85
    v_sub_f32 v240, v240, v216
    v_sub_f32 v241, v241, v216
    s_waitcnt lgkmcnt(6)
    v_mfma_f32_32x32x16_bf16 a[0:15], a[108:111], v[52:55], a[0:15]
    ds_read_b64_tr_b16 a[96:97], v236 offset:0
    ds_read_b64_tr_b16 a[98:99], v236 offset:1152
    s_add_u32 m0, s53, 45312
    v_sub_f32 v242, v242, v216
    v_sub_f32 v243, v243, v216
    v_cvt_pk_bf16_f32 v84, v240, v241
    v_cvt_pk_bf16_f32 v85, v242, v243
    v_mfma_f32_32x32x16_bf16 a[16:31], a[112:115], v[52:55], a[16:31]
    ds_read_b64_tr_b16 a[100:101], v236 offset:32
    ds_read_b64_tr_b16 a[102:103], v236 offset:1184
    buffer_load_dwordx4 v232, s[36:39], s59 offen lds
    v_lshlrev_b32 v240, 16, v86
    v_and_b32 v241, s61, v86
    v_mfma_f32_32x32x16_bf16 a[32:47], a[116:119], v[52:55], a[32:47]
    ds_read_b64_tr_b16 a[104:105], v236 offset:64
    ds_read_b64_tr_b16 a[106:107], v236 offset:1216
    v_lshlrev_b32 v242, 16, v87
    v_and_b32 v243, s61, v87
    v_sub_f32 v240, v240, v216
    v_sub_f32 v241, v241, v216
    v_sub_f32 v242, v242, v216
    s_waitcnt lgkmcnt(6)
    v_mfma_f32_32x32x16_bf16 a[48:63], a[120:123], v[52:55], a[48:63]
    ds_read_b64_tr_b16 a[108:109], v236 offset:96
    ds_read_b64_tr_b16 a[110:111], v236 offset:1248
    v_sub_f32 v243, v243, v216
    v_cvt_pk_bf16_f32 v86, v240, v241
    v_cvt_pk_bf16_f32 v87, v242, v243
    v_lshlrev_b32 v240, 16, v88
    v_and_b32 v241, s61, v88
    v_mfma_f32_32x32x16_bf16 a[64:79], a[124:127], v[52:55], a[64:79]
    ds_read_b64_tr_b16 a[112:113], v236 offset:128
    ds_read_b64_tr_b16 a[114:115], v236 offset:1280
    v_lshlrev_b32 v242, 16, v89
    v_and_b32 v243, s61, v89
    v_sub_f32 v240, v240, v216
    v_sub_f32 v241, v241, v216
    v_sub_f32 v242, v242, v216
    v_mfma_f32_32x32x16_bf16 a[80:95], a[128:131], v[52:55], a[80:95]
    ds_read_b64_tr_b16 a[116:117], v236 offset:160
    ds_read_b64_tr_b16 a[118:119], v236 offset:1312
    v_sub_f32 v243, v243, v216
    v_cvt_pk_bf16_f32 v88, v240, v241
    v_cvt_pk_bf16_f32 v89, v242, v243
    v_lshlrev_b32 v240, 16, v90
    v_and_b32 v241, s61, v90
    s_waitcnt vmcnt(9)
    s_barrier
    s_waitcnt lgkmcnt(6)
    v_mfma_f32_32x32x16_bf16 v[168:183], a[96:99], v[56:59], v[168:183]
    ds_read_b64_tr_b16 a[120:121], v236 offset:192
    ds_read_b64_tr_b16 a[122:123], v236 offset:1344
    s_mov_b32 s59, 1327104
    s_add_u32 m0, s53, 74240
    v_lshlrev_b32 v242, 16, v91
    v_and_b32 v243, s61, v91
    v_sub_f32 v240, v240, v216
    v_mfma_f32_32x32x16_bf16 v[184:199], a[100:103], v[56:59], v[184:199]
    ds_read_b64_tr_b16 a[124:125], v236 offset:224
    ds_read_b64_tr_b16 a[126:127], v236 offset:1376
    buffer_load_dwordx4 v224, s[36:39], s59 offen lds
    v_sub_f32 v241, v241, v216
    v_sub_f32 v242, v242, v216
    v_mfma_f32_32x32x16_bf16 v[200:215], a[104:107], v[56:59], v[200:215]
    ds_read_b64_tr_b16 a[128:129], v236 offset:256
    ds_read_b64_tr_b16 a[130:131], v236 offset:1408
    v_sub_f32 v243, v243, v216
    v_cvt_pk_bf16_f32 v90, v240, v241
    v_cvt_pk_bf16_f32 v91, v242, v243
    v_lshlrev_b32 v240, 16, v92
    v_and_b32 v241, s61, v92
    s_waitcnt lgkmcnt(6)
    v_mfma_f32_32x32x16_bf16 a[0:15], a[108:111], v[56:59], a[0:15]
    ds_read_b64_tr_b16 a[96:97], v236 offset:4608
    ds_read_b64_tr_b16 a[98:99], v236 offset:5760
    s_add_u32 m0, s53, 75264
    v_lshlrev_b32 v242, 16, v93
    v_and_b32 v243, s61, v93
    v_sub_f32 v240, v240, v216
    v_sub_f32 v241, v241, v216
    v_mfma_f32_32x32x16_bf16 a[16:31], a[112:115], v[56:59], a[16:31]
    ds_read_b64_tr_b16 a[100:101], v236 offset:4640
    ds_read_b64_tr_b16 a[102:103], v236 offset:5792
    buffer_load_dwordx4 v225, s[36:39], s59 offen lds
    v_sub_f32 v242, v242, v216
    v_sub_f32 v243, v243, v216
    v_mfma_f32_32x32x16_bf16 a[32:47], a[116:119], v[56:59], a[32:47]
    ds_read_b64_tr_b16 a[104:105], v236 offset:4672
    ds_read_b64_tr_b16 a[106:107], v236 offset:5824
    v_cvt_pk_bf16_f32 v92, v240, v241
    v_cvt_pk_bf16_f32 v93, v242, v243
    v_lshlrev_b32 v240, 16, v94
    v_and_b32 v241, s61, v94
    v_lshlrev_b32 v242, 16, v95
    s_waitcnt lgkmcnt(6)
    v_mfma_f32_32x32x16_bf16 a[48:63], a[120:123], v[56:59], a[48:63]
    ds_read_b64_tr_b16 a[108:109], v236 offset:4704
    ds_read_b64_tr_b16 a[110:111], v236 offset:5856
    s_add_u32 m0, s53, 76288
    v_and_b32 v243, s61, v95
    v_sub_f32 v240, v240, v216
    v_sub_f32 v241, v241, v216
    v_sub_f32 v242, v242, v216
    v_mfma_f32_32x32x16_bf16 a[64:79], a[124:127], v[56:59], a[64:79]
    ds_read_b64_tr_b16 a[112:113], v236 offset:4736
    ds_read_b64_tr_b16 a[114:115], v236 offset:5888
    buffer_load_dwordx4 v226, s[36:39], s59 offen lds
    v_sub_f32 v243, v243, v216
    v_cvt_pk_bf16_f32 v94, v240, v241
    v_mfma_f32_32x32x16_bf16 a[80:95], a[128:131], v[56:59], a[80:95]
    ds_read_b64_tr_b16 a[116:117], v236 offset:4768
    ds_read_b64_tr_b16 a[118:119], v236 offset:5920
    v_cvt_pk_bf16_f32 v95, v242, v243
    v_lshlrev_b32 v240, 16, v96
    v_and_b32 v241, s61, v96
    v_lshlrev_b32 v242, 16, v97
    v_and_b32 v243, s61, v97
    s_waitcnt lgkmcnt(6)
    v_mfma_f32_32x32x16_bf16 v[168:183], a[96:99], v[60:63], v[168:183]
    ds_read_b64_tr_b16 a[120:121], v236 offset:4800
    ds_read_b64_tr_b16 a[122:123], v236 offset:5952
    s_add_u32 m0, s53, 77312
    v_sub_f32 v240, v240, v216
    v_sub_f32 v241, v241, v216
    v_sub_f32 v242, v242, v216
    v_sub_f32 v243, v243, v216
    v_mfma_f32_32x32x16_bf16 v[184:199], a[100:103], v[60:63], v[184:199]
    ds_read_b64_tr_b16 a[124:125], v236 offset:4832
    ds_read_b64_tr_b16 a[126:127], v236 offset:5984
    buffer_load_dwordx4 v227, s[36:39], s59 offen lds
    v_cvt_pk_bf16_f32 v96, v240, v241
    v_cvt_pk_bf16_f32 v97, v242, v243
    v_mfma_f32_32x32x16_bf16 v[200:215], a[104:107], v[60:63], v[200:215]
    ds_read_b64_tr_b16 a[128:129], v236 offset:4864
    ds_read_b64_tr_b16 a[130:131], v236 offset:6016
    v_lshlrev_b32 v240, 16, v98
    v_and_b32 v241, s61, v98
    v_lshlrev_b32 v242, 16, v99
    v_and_b32 v243, s61, v99
    v_sub_f32 v240, v240, v216
    s_waitcnt lgkmcnt(6)
    v_mfma_f32_32x32x16_bf16 a[0:15], a[108:111], v[60:63], a[0:15]
    ds_read_b64_tr_b16 a[96:97], v236 offset:9216
    ds_read_b64_tr_b16 a[98:99], v236 offset:10368
    s_add_u32 m0, s53, 78336
    v_sub_f32 v241, v241, v216
    v_sub_f32 v242, v242, v216
    v_sub_f32 v243, v243, v216
    v_cvt_pk_bf16_f32 v98, v240, v241
    v_mfma_f32_32x32x16_bf16 a[16:31], a[112:115], v[60:63], a[16:31]
    ds_read_b64_tr_b16 a[100:101], v236 offset:9248
    ds_read_b64_tr_b16 a[102:103], v236 offset:10400
    buffer_load_dwordx4 v228, s[36:39], s59 offen lds
    v_cvt_pk_bf16_f32 v99, v242, v243
    v_lshlrev_b32 v240, 16, v100
    v_mfma_f32_32x32x16_bf16 a[32:47], a[116:119], v[60:63], a[32:47]
    ds_read_b64_tr_b16 a[104:105], v236 offset:9280
    ds_read_b64_tr_b16 a[106:107], v236 offset:10432
    v_and_b32 v241, s61, v100
    v_lshlrev_b32 v242, 16, v101
    v_and_b32 v243, s61, v101
    v_sub_f32 v240, v240, v216
    v_sub_f32 v241, v241, v216
    s_waitcnt lgkmcnt(6)
    v_mfma_f32_32x32x16_bf16 a[48:63], a[120:123], v[60:63], a[48:63]
    ds_read_b64_tr_b16 a[108:109], v236 offset:9312
    ds_read_b64_tr_b16 a[110:111], v236 offset:10464
    s_add_u32 m0, s53, 79360
    v_sub_f32 v242, v242, v216
    v_sub_f32 v243, v243, v216
    v_cvt_pk_bf16_f32 v100, v240, v241
    v_cvt_pk_bf16_f32 v101, v242, v243
    v_mfma_f32_32x32x16_bf16 a[64:79], a[124:127], v[60:63], a[64:79]
    ds_read_b64_tr_b16 a[112:113], v236 offset:9344
    ds_read_b64_tr_b16 a[114:115], v236 offset:10496
    buffer_load_dwordx4 v229, s[36:39], s59 offen lds
    v_lshlrev_b32 v240, 16, v102
    v_and_b32 v241, s61, v102
    v_mfma_f32_32x32x16_bf16 a[80:95], a[128:131], v[60:63], a[80:95]
    ds_read_b64_tr_b16 a[116:117], v236 offset:9376
    ds_read_b64_tr_b16 a[118:119], v236 offset:10528
    v_lshlrev_b32 v242, 16, v103
    v_and_b32 v243, s61, v103
    v_sub_f32 v240, v240, v216
    v_sub_f32 v241, v241, v216
    v_sub_f32 v242, v242, v216
    s_waitcnt lgkmcnt(6)
    v_mfma_f32_32x32x16_bf16 v[168:183], a[96:99], v[64:67], v[168:183]
    ds_read_b64_tr_b16 a[120:121], v236 offset:9408
    ds_read_b64_tr_b16 a[122:123], v236 offset:10560
    s_add_u32 m0, s53, 80384
    v_sub_f32 v243, v243, v216
    v_cvt_pk_bf16_f32 v102, v240, v241
    v_cvt_pk_bf16_f32 v103, v242, v243
    v_lshlrev_b32 v240, 16, v104
    v_mfma_f32_32x32x16_bf16 v[184:199], a[100:103], v[64:67], v[184:199]
    ds_read_b64_tr_b16 a[124:125], v236 offset:9440
    ds_read_b64_tr_b16 a[126:127], v236 offset:10592
    buffer_load_dwordx4 v230, s[36:39], s59 offen lds
    v_and_b32 v241, s61, v104
    v_lshlrev_b32 v242, 16, v105
    v_mfma_f32_32x32x16_bf16 v[200:215], a[104:107], v[64:67], v[200:215]
    ds_read_b64_tr_b16 a[128:129], v236 offset:9472
    ds_read_b64_tr_b16 a[130:131], v236 offset:10624
    v_and_b32 v243, s61, v105
    v_sub_f32 v240, v240, v216
    v_sub_f32 v241, v241, v216
    v_sub_f32 v242, v242, v216
    v_sub_f32 v243, v243, v216
    s_waitcnt lgkmcnt(6)
    v_mfma_f32_32x32x16_bf16 a[0:15], a[108:111], v[64:67], a[0:15]
    ds_read_b64_tr_b16 a[96:97], v236 offset:13824
    ds_read_b64_tr_b16 a[98:99], v236 offset:14976
    s_add_u32 m0, s53, 81408
    v_cvt_pk_bf16_f32 v104, v240, v241
    v_cvt_pk_bf16_f32 v105, v242, v243
    v_lshlrev_b32 v240, 16, v106
    v_and_b32 v241, s61, v106
    v_mfma_f32_32x32x16_bf16 a[16:31], a[112:115], v[64:67], a[16:31]
    ds_read_b64_tr_b16 a[100:101], v236 offset:13856
    ds_read_b64_tr_b16 a[102:103], v236 offset:15008
    buffer_load_dwordx4 v231, s[36:39], s59 offen lds
    v_lshlrev_b32 v242, 16, v107
    v_and_b32 v243, s61, v107
    v_mfma_f32_32x32x16_bf16 a[32:47], a[116:119], v[64:67], a[32:47]
    ds_read_b64_tr_b16 a[104:105], v236 offset:13888
    ds_read_b64_tr_b16 a[106:107], v236 offset:15040
    v_sub_f32 v240, v240, v216
    v_sub_f32 v241, v241, v216
    v_sub_f32 v242, v242, v216
    v_sub_f32 v243, v243, v216
    v_cvt_pk_bf16_f32 v106, v240, v241
    s_waitcnt lgkmcnt(6)
    v_mfma_f32_32x32x16_bf16 a[48:63], a[120:123], v[64:67], a[48:63]
    ds_read_b64_tr_b16 a[108:109], v236 offset:13920
    ds_read_b64_tr_b16 a[110:111], v236 offset:15072
    s_add_u32 m0, s53, 82432
    v_cvt_pk_bf16_f32 v107, v242, v243
    v_lshlrev_b32 v240, 16, v108
    v_and_b32 v241, s61, v108
    v_lshlrev_b32 v242, 16, v109
    v_mfma_f32_32x32x16_bf16 a[64:79], a[124:127], v[64:67], a[64:79]
    ds_read_b64_tr_b16 a[112:113], v236 offset:13952
    ds_read_b64_tr_b16 a[114:115], v236 offset:15104
    buffer_load_dwordx4 v232, s[36:39], s59 offen lds
    v_and_b32 v243, s61, v109
    v_sub_f32 v240, v240, v216
    v_mfma_f32_32x32x16_bf16 a[80:95], a[128:131], v[64:67], a[80:95]
    ds_read_b64_tr_b16 a[116:117], v236 offset:13984
    ds_read_b64_tr_b16 a[118:119], v236 offset:15136
    v_sub_f32 v241, v241, v216
    v_sub_f32 v242, v242, v216
    v_sub_f32 v243, v243, v216
    v_cvt_pk_bf16_f32 v108, v240, v241
    v_cvt_pk_bf16_f32 v109, v242, v243
    s_waitcnt lgkmcnt(6)
    v_mfma_f32_32x32x16_bf16 v[168:183], a[96:99], v[68:71], v[168:183]
    ds_read_b64_tr_b16 a[120:121], v236 offset:14016
    ds_read_b64_tr_b16 a[122:123], v236 offset:15168
    v_lshlrev_b32 v240, 16, v110
    v_and_b32 v241, s61, v110
    v_lshlrev_b32 v242, 16, v111
    v_and_b32 v243, s61, v111
    v_sub_f32 v240, v240, v216
    v_mfma_f32_32x32x16_bf16 v[184:199], a[100:103], v[68:71], v[184:199]
    ds_read_b64_tr_b16 a[124:125], v236 offset:14048
    ds_read_b64_tr_b16 a[126:127], v236 offset:15200
    v_sub_f32 v241, v241, v216
    v_sub_f32 v242, v242, v216
    v_sub_f32 v243, v243, v216
    v_cvt_pk_bf16_f32 v110, v240, v241
    v_mfma_f32_32x32x16_bf16 v[200:215], a[104:107], v[68:71], v[200:215]
    ds_read_b64_tr_b16 a[128:129], v236 offset:14080
    ds_read_b64_tr_b16 a[130:131], v236 offset:15232
    v_cvt_pk_bf16_f32 v111, v242, v243
    v_lshlrev_b32 v240, 16, v112
    v_and_b32 v241, s61, v112
    v_lshlrev_b32 v242, 16, v113
    s_waitcnt lgkmcnt(6)
    v_mfma_f32_32x32x16_bf16 a[0:15], a[108:111], v[68:71], a[0:15]
    ds_read_b64_tr_b16 a[96:97], v233 offset:0
    ds_read_b64_tr_b16 a[98:99], v233 offset:1152
    v_and_b32 v243, s61, v113
    v_sub_f32 v240, v240, v216
    v_sub_f32 v241, v241, v216
    v_mfma_f32_32x32x16_bf16 a[16:31], a[112:115], v[68:71], a[16:31]
    ds_read_b64_tr_b16 a[100:101], v233 offset:32
    ds_read_b64_tr_b16 a[102:103], v233 offset:1184
    v_sub_f32 v242, v242, v216
    v_sub_f32 v243, v243, v216
    v_cvt_pk_bf16_f32 v112, v240, v241
    v_cvt_pk_bf16_f32 v113, v242, v243
    v_mfma_f32_32x32x16_bf16 a[32:47], a[116:119], v[68:71], a[32:47]
    ds_read_b64_tr_b16 a[104:105], v233 offset:64
    ds_read_b64_tr_b16 a[106:107], v233 offset:1216
    v_lshlrev_b32 v240, 16, v114
    v_and_b32 v241, s61, v114
    v_lshlrev_b32 v242, 16, v115
    s_waitcnt lgkmcnt(6)
    v_mfma_f32_32x32x16_bf16 a[48:63], a[120:123], v[68:71], a[48:63]
    ds_read_b64_tr_b16 a[108:109], v233 offset:96
    ds_read_b64_tr_b16 a[110:111], v233 offset:1248
    v_and_b32 v243, s61, v115
    v_sub_f32 v240, v240, v216
    v_sub_f32 v241, v241, v216
    v_sub_f32 v242, v242, v216
    v_mfma_f32_32x32x16_bf16 a[64:79], a[124:127], v[68:71], a[64:79]
    ds_read_b64_tr_b16 a[112:113], v233 offset:128
    ds_read_b64_tr_b16 a[114:115], v233 offset:1280
    v_sub_f32 v243, v243, v216
    v_cvt_pk_bf16_f32 v114, v240, v241
    v_cvt_pk_bf16_f32 v115, v242, v243
    v_lshlrev_b32 v240, 16, v116
    v_mfma_f32_32x32x16_bf16 a[80:95], a[128:131], v[68:71], a[80:95]
    ds_read_b64_tr_b16 a[116:117], v233 offset:160
    ds_read_b64_tr_b16 a[118:119], v233 offset:1312
    v_and_b32 v241, s61, v116
    v_lshlrev_b32 v242, 16, v117
    v_and_b32 v243, s61, v117
    s_waitcnt vmcnt(9)
    s_barrier
    s_waitcnt lgkmcnt(6)
    v_mfma_f32_32x32x16_bf16 v[168:183], a[96:99], v[72:75], v[168:183]
    ds_read_b64_tr_b16 a[120:121], v233 offset:192
    ds_read_b64_tr_b16 a[122:123], v233 offset:1344
    s_mov_b32 s59, 1548288
    s_add_u32 m0, s53, 111360
    v_sub_f32 v240, v240, v216
    v_sub_f32 v241, v241, v216
    v_sub_f32 v242, v242, v216
    v_mfma_f32_32x32x16_bf16 v[184:199], a[100:103], v[72:75], v[184:199]
    ds_read_b64_tr_b16 a[124:125], v233 offset:224
    ds_read_b64_tr_b16 a[126:127], v233 offset:1376
    buffer_load_dwordx4 v224, s[36:39], s59 offen lds
    v_sub_f32 v243, v243, v216
    v_cvt_pk_bf16_f32 v116, v240, v241
    v_mfma_f32_32x32x16_bf16 v[200:215], a[104:107], v[72:75], v[200:215]
    ds_read_b64_tr_b16 a[128:129], v233 offset:256
    ds_read_b64_tr_b16 a[130:131], v233 offset:1408
    v_cvt_pk_bf16_f32 v117, v242, v243
    v_lshlrev_b32 v240, 16, v118
    v_and_b32 v241, s61, v118
    v_lshlrev_b32 v242, 16, v119
    v_and_b32 v243, s61, v119
    s_waitcnt lgkmcnt(6)
    v_mfma_f32_32x32x16_bf16 a[0:15], a[108:111], v[72:75], a[0:15]
    ds_read_b64_tr_b16 a[96:97], v233 offset:4608
    ds_read_b64_tr_b16 a[98:99], v233 offset:5760
    s_add_u32 m0, s53, 112384
    v_sub_f32 v240, v240, v216
    v_sub_f32 v241, v241, v216
    v_sub_f32 v242, v242, v216
    v_sub_f32 v243, v243, v216
    v_mfma_f32_32x32x16_bf16 a[16:31], a[112:115], v[72:75], a[16:31]
    ds_read_b64_tr_b16 a[100:101], v233 offset:4640
    ds_read_b64_tr_b16 a[102:103], v233 offset:5792
    buffer_load_dwordx4 v225, s[36:39], s59 offen lds
    v_cvt_pk_bf16_f32 v118, v240, v241
    v_cvt_pk_bf16_f32 v119, v242, v243
    v_mfma_f32_32x32x16_bf16 a[32:47], a[116:119], v[72:75], a[32:47]
    ds_read_b64_tr_b16 a[104:105], v233 offset:4672
    ds_read_b64_tr_b16 a[106:107], v233 offset:5824
    v_lshlrev_b32 v240, 16, v120
    v_and_b32 v241, s61, v120
    v_lshlrev_b32 v242, 16, v121
    v_and_b32 v243, s61, v121
    v_sub_f32 v240, v240, v216
    s_waitcnt lgkmcnt(6)
    v_mfma_f32_32x32x16_bf16 a[48:63], a[120:123], v[72:75], a[48:63]
    ds_read_b64_tr_b16 a[108:109], v233 offset:4704
    ds_read_b64_tr_b16 a[110:111], v233 offset:5856
    s_add_u32 m0, s53, 113408
    v_sub_f32 v241, v241, v216
    v_sub_f32 v242, v242, v216
    v_sub_f32 v243, v243, v216
    v_cvt_pk_bf16_f32 v120, v240, v241
    v_mfma_f32_32x32x16_bf16 a[64:79], a[124:127], v[72:75], a[64:79]
    ds_read_b64_tr_b16 a[112:113], v233 offset:4736
    ds_read_b64_tr_b16 a[114:115], v233 offset:5888
    buffer_load_dwordx4 v226, s[36:39], s59 offen lds
    v_cvt_pk_bf16_f32 v121, v242, v243
    v_lshlrev_b32 v240, 16, v122
    v_mfma_f32_32x32x16_bf16 a[80:95], a[128:131], v[72:75], a[80:95]
    ds_read_b64_tr_b16 a[116:117], v233 offset:4768
    ds_read_b64_tr_b16 a[118:119], v233 offset:5920
    v_and_b32 v241, s61, v122
    v_lshlrev_b32 v242, 16, v123
    v_and_b32 v243, s61, v123
    v_sub_f32 v240, v240, v216
    v_sub_f32 v241, v241, v216
    s_waitcnt lgkmcnt(6)
    v_mfma_f32_32x32x16_bf16 v[168:183], a[96:99], v[76:79], v[168:183]
    ds_read_b64_tr_b16 a[120:121], v233 offset:4800
    ds_read_b64_tr_b16 a[122:123], v233 offset:5952
    s_add_u32 m0, s53, 114432
    v_sub_f32 v242, v242, v216
    v_sub_f32 v243, v243, v216
    v_cvt_pk_bf16_f32 v122, v240, v241
    v_cvt_pk_bf16_f32 v123, v242, v243
    v_mfma_f32_32x32x16_bf16 v[184:199], a[100:103], v[76:79], v[184:199]
    ds_read_b64_tr_b16 a[124:125], v233 offset:4832
    ds_read_b64_tr_b16 a[126:127], v233 offset:5984
    buffer_load_dwordx4 v227, s[36:39], s59 offen lds
    v_lshlrev_b32 v240, 16, v124
    v_and_b32 v241, s61, v124
    v_mfma_f32_32x32x16_bf16 v[200:215], a[104:107], v[76:79], v[200:215]
    ds_read_b64_tr_b16 a[128:129], v233 offset:4864
    ds_read_b64_tr_b16 a[130:131], v233 offset:6016
    v_lshlrev_b32 v242, 16, v125
    v_and_b32 v243, s61, v125
    v_sub_f32 v240, v240, v216
    v_sub_f32 v241, v241, v216
    v_sub_f32 v242, v242, v216
    s_waitcnt lgkmcnt(6)
    v_mfma_f32_32x32x16_bf16 a[0:15], a[108:111], v[76:79], a[0:15]
    ds_read_b64_tr_b16 a[96:97], v233 offset:9216
    ds_read_b64_tr_b16 a[98:99], v233 offset:10368
    s_add_u32 m0, s53, 115456
    v_sub_f32 v243, v243, v216
    v_cvt_pk_bf16_f32 v124, v240, v241
    v_cvt_pk_bf16_f32 v125, v242, v243
    v_lshlrev_b32 v240, 16, v126
    v_mfma_f32_32x32x16_bf16 a[16:31], a[112:115], v[76:79], a[16:31]
    ds_read_b64_tr_b16 a[100:101], v233 offset:9248
    ds_read_b64_tr_b16 a[102:103], v233 offset:10400
    buffer_load_dwordx4 v228, s[36:39], s59 offen lds
    v_and_b32 v241, s61, v126
    v_lshlrev_b32 v242, 16, v127
    v_mfma_f32_32x32x16_bf16 a[32:47], a[116:119], v[76:79], a[32:47]
    ds_read_b64_tr_b16 a[104:105], v233 offset:9280
    ds_read_b64_tr_b16 a[106:107], v233 offset:10432
    v_and_b32 v243, s61, v127
    v_sub_f32 v240, v240, v216
    v_sub_f32 v241, v241, v216
    v_sub_f32 v242, v242, v216
    v_sub_f32 v243, v243, v216
    s_waitcnt lgkmcnt(6)
    v_mfma_f32_32x32x16_bf16 a[48:63], a[120:123], v[76:79], a[48:63]
    ds_read_b64_tr_b16 a[108:109], v233 offset:9312
    ds_read_b64_tr_b16 a[110:111], v233 offset:10464
    s_add_u32 m0, s53, 116480
    v_cvt_pk_bf16_f32 v126, v240, v241
    v_cvt_pk_bf16_f32 v127, v242, v243
    v_lshlrev_b32 v240, 16, v128
    v_and_b32 v241, s61, v128
    v_mfma_f32_32x32x16_bf16 a[64:79], a[124:127], v[76:79], a[64:79]
    ds_read_b64_tr_b16 a[112:113], v233 offset:9344
    ds_read_b64_tr_b16 a[114:115], v233 offset:10496
    buffer_load_dwordx4 v229, s[36:39], s59 offen lds
    v_lshlrev_b32 v242, 16, v129
    v_and_b32 v243, s61, v129
    v_mfma_f32_32x32x16_bf16 a[80:95], a[128:131], v[76:79], a[80:95]
    ds_read_b64_tr_b16 a[116:117], v233 offset:9376
    ds_read_b64_tr_b16 a[118:119], v233 offset:10528
    v_sub_f32 v240, v240, v216
    v_sub_f32 v241, v241, v216
    v_sub_f32 v242, v242, v216
    v_sub_f32 v243, v243, v216
    v_cvt_pk_bf16_f32 v128, v240, v241
    s_waitcnt lgkmcnt(6)
    v_mfma_f32_32x32x16_bf16 v[168:183], a[96:99], v[80:83], v[168:183]
    ds_read_b64_tr_b16 a[120:121], v233 offset:9408
    ds_read_b64_tr_b16 a[122:123], v233 offset:10560
    s_add_u32 m0, s53, 117504
    v_cvt_pk_bf16_f32 v129, v242, v243
    v_lshlrev_b32 v240, 16, v130
    v_and_b32 v241, s61, v130
    v_lshlrev_b32 v242, 16, v131
    v_mfma_f32_32x32x16_bf16 v[184:199], a[100:103], v[80:83], v[184:199]
    ds_read_b64_tr_b16 a[124:125], v233 offset:9440
    ds_read_b64_tr_b16 a[126:127], v233 offset:10592
    buffer_load_dwordx4 v230, s[36:39], s59 offen lds
    v_and_b32 v243, s61, v131
    v_sub_f32 v240, v240, v216
    v_mfma_f32_32x32x16_bf16 v[200:215], a[104:107], v[80:83], v[200:215]
    ds_read_b64_tr_b16 a[128:129], v233 offset:9472
    ds_read_b64_tr_b16 a[130:131], v233 offset:10624
    v_sub_f32 v241, v241, v216
    v_sub_f32 v242, v242, v216
    v_sub_f32 v243, v243, v216
    v_cvt_pk_bf16_f32 v130, v240, v241
    v_cvt_pk_bf16_f32 v131, v242, v243
    s_waitcnt lgkmcnt(6)
    v_mfma_f32_32x32x16_bf16 a[0:15], a[108:111], v[80:83], a[0:15]
    ds_read_b64_tr_b16 a[96:97], v233 offset:13824
    ds_read_b64_tr_b16 a[98:99], v233 offset:14976
    s_add_u32 m0, s53, 118528
    v_lshlrev_b32 v240, 16, v132
    v_and_b32 v241, s61, v132
    v_lshlrev_b32 v242, 16, v133
    v_and_b32 v243, s61, v133
    v_mfma_f32_32x32x16_bf16 a[16:31], a[112:115], v[80:83], a[16:31]
    ds_read_b64_tr_b16 a[100:101], v233 offset:13856
    ds_read_b64_tr_b16 a[102:103], v233 offset:15008
    buffer_load_dwordx4 v231, s[36:39], s59 offen lds
    v_sub_f32 v240, v240, v216
    v_sub_f32 v241, v241, v216
    v_mfma_f32_32x32x16_bf16 a[32:47], a[116:119], v[80:83], a[32:47]
    ds_read_b64_tr_b16 a[104:105], v233 offset:13888
    ds_read_b64_tr_b16 a[106:107], v233 offset:15040
    v_sub_f32 v242, v242, v216
    v_sub_f32 v243, v243, v216
    v_cvt_pk_bf16_f32 v132, v240, v241
    v_cvt_pk_bf16_f32 v133, v242, v243
    v_lshlrev_b32 v240, 16, v134
    s_waitcnt lgkmcnt(6)
    v_mfma_f32_32x32x16_bf16 a[48:63], a[120:123], v[80:83], a[48:63]
    ds_read_b64_tr_b16 a[108:109], v233 offset:13920
    ds_read_b64_tr_b16 a[110:111], v233 offset:15072
    s_add_u32 m0, s53, 119552
    v_and_b32 v241, s61, v134
    v_lshlrev_b32 v242, 16, v135
    v_and_b32 v243, s61, v135
    v_sub_f32 v240, v240, v216
    v_mfma_f32_32x32x16_bf16 a[64:79], a[124:127], v[80:83], a[64:79]
    ds_read_b64_tr_b16 a[112:113], v233 offset:13952
    ds_read_b64_tr_b16 a[114:115], v233 offset:15104
    buffer_load_dwordx4 v232, s[36:39], s59 offen lds
    v_sub_f32 v241, v241, v216
    v_sub_f32 v242, v242, v216
    v_mfma_f32_32x32x16_bf16 a[80:95], a[128:131], v[80:83], a[80:95]
    ds_read_b64_tr_b16 a[116:117], v233 offset:13984
    ds_read_b64_tr_b16 a[118:119], v233 offset:15136
    v_sub_f32 v243, v243, v216
    v_cvt_pk_bf16_f32 v134, v240, v241
    v_cvt_pk_bf16_f32 v135, v242, v243
    v_lshlrev_b32 v240, 16, v136
    v_and_b32 v241, s61, v136
    s_waitcnt lgkmcnt(6)
    v_mfma_f32_32x32x16_bf16 v[168:183], a[96:99], v[84:87], v[168:183]
    ds_read_b64_tr_b16 a[120:121], v233 offset:14016
    ds_read_b64_tr_b16 a[122:123], v233 offset:15168
    v_lshlrev_b32 v242, 16, v137
    v_and_b32 v243, s61, v137
    v_sub_f32 v240, v240, v216
    v_sub_f32 v241, v241, v216
    v_mfma_f32_32x32x16_bf16 v[184:199], a[100:103], v[84:87], v[184:199]
    ds_read_b64_tr_b16 a[124:125], v233 offset:14048
    ds_read_b64_tr_b16 a[126:127], v233 offset:15200
    v_sub_f32 v242, v242, v216
    v_sub_f32 v243, v243, v216
    v_cvt_pk_bf16_f32 v136, v240, v241
    v_mfma_f32_32x32x16_bf16 v[200:215], a[104:107], v[84:87], v[200:215]
    ds_read_b64_tr_b16 a[128:129], v233 offset:14080
    ds_read_b64_tr_b16 a[130:131], v233 offset:15232
    v_cvt_pk_bf16_f32 v137, v242, v243
    v_lshlrev_b32 v240, 16, v138
    v_and_b32 v241, s61, v138
    v_lshlrev_b32 v242, 16, v139
    s_waitcnt lgkmcnt(6)
    v_mfma_f32_32x32x16_bf16 a[0:15], a[108:111], v[84:87], a[0:15]
    ds_read_b64_tr_b16 a[96:97], v234 offset:0
    ds_read_b64_tr_b16 a[98:99], v234 offset:1152
    v_and_b32 v243, s61, v139
    v_sub_f32 v240, v240, v216
    v_sub_f32 v241, v241, v216
    v_mfma_f32_32x32x16_bf16 a[16:31], a[112:115], v[84:87], a[16:31]
    ds_read_b64_tr_b16 a[100:101], v234 offset:32
    ds_read_b64_tr_b16 a[102:103], v234 offset:1184
    v_sub_f32 v242, v242, v216
    v_sub_f32 v243, v243, v216
    v_cvt_pk_bf16_f32 v138, v240, v241
    v_cvt_pk_bf16_f32 v139, v242, v243
    v_mfma_f32_32x32x16_bf16 a[32:47], a[116:119], v[84:87], a[32:47]
    ds_read_b64_tr_b16 a[104:105], v234 offset:64
    ds_read_b64_tr_b16 a[106:107], v234 offset:1216
    v_lshlrev_b32 v240, 16, v140
    v_and_b32 v241, s61, v140
    v_lshlrev_b32 v242, 16, v141
    v_and_b32 v243, s61, v141
    s_waitcnt lgkmcnt(6)
    v_mfma_f32_32x32x16_bf16 a[48:63], a[120:123], v[84:87], a[48:63]
    ds_read_b64_tr_b16 a[108:109], v234 offset:96
    ds_read_b64_tr_b16 a[110:111], v234 offset:1248
    v_sub_f32 v240, v240, v216
    v_sub_f32 v241, v241, v216
    v_sub_f32 v242, v242, v216
    v_mfma_f32_32x32x16_bf16 a[64:79], a[124:127], v[84:87], a[64:79]
    ds_read_b64_tr_b16 a[112:113], v234 offset:128
    ds_read_b64_tr_b16 a[114:115], v234 offset:1280
    v_sub_f32 v243, v243, v216
    v_cvt_pk_bf16_f32 v140, v240, v241
    v_cvt_pk_bf16_f32 v141, v242, v243
    v_lshlrev_b32 v240, 16, v142
    v_mfma_f32_32x32x16_bf16 a[80:95], a[128:131], v[84:87], a[80:95]
    ds_read_b64_tr_b16 a[116:117], v234 offset:160
    ds_read_b64_tr_b16 a[118:119], v234 offset:1312
    v_and_b32 v241, s61, v142
    v_lshlrev_b32 v242, 16, v143
    v_and_b32 v243, s61, v143
    v_sub_f32 v240, v240, v216
    s_waitcnt vmcnt(9)
    s_barrier
    s_waitcnt lgkmcnt(6)
    v_mfma_f32_32x32x16_bf16 v[168:183], a[96:99], v[88:91], v[168:183]
    ds_read_b64_tr_b16 a[120:121], v234 offset:192
    ds_read_b64_tr_b16 a[122:123], v234 offset:1344
    s_mov_b32 s59, 1769472
    s_add_u32 m0, s53, 0
    v_sub_f32 v241, v241, v216
    v_sub_f32 v242, v242, v216
    v_sub_f32 v243, v243, v216
    v_mfma_f32_32x32x16_bf16 v[184:199], a[100:103], v[88:91], v[184:199]
    ds_read_b64_tr_b16 a[124:125], v234 offset:224
    ds_read_b64_tr_b16 a[126:127], v234 offset:1376
    buffer_load_dwordx4 v224, s[36:39], s59 offen lds
    v_cvt_pk_bf16_f32 v142, v240, v241
    v_cvt_pk_bf16_f32 v143, v242, v243
    v_mfma_f32_32x32x16_bf16 v[200:215], a[104:107], v[88:91], v[200:215]
    ds_read_b64_tr_b16 a[128:129], v234 offset:256
    ds_read_b64_tr_b16 a[130:131], v234 offset:1408
    v_lshlrev_b32 v240, 16, v144
    v_and_b32 v241, s61, v144
    v_lshlrev_b32 v242, 16, v145
    v_and_b32 v243, s61, v145
    v_sub_f32 v240, v240, v216
    s_waitcnt lgkmcnt(6)
    v_mfma_f32_32x32x16_bf16 a[0:15], a[108:111], v[88:91], a[0:15]
    ds_read_b64_tr_b16 a[96:97], v234 offset:4608
    ds_read_b64_tr_b16 a[98:99], v234 offset:5760
    s_add_u32 m0, s53, 1024
    v_sub_f32 v241, v241, v216
    v_sub_f32 v242, v242, v216
    v_sub_f32 v243, v243, v216
    v_cvt_pk_bf16_f32 v144, v240, v241
    v_mfma_f32_32x32x16_bf16 a[16:31], a[112:115], v[88:91], a[16:31]
    ds_read_b64_tr_b16 a[100:101], v234 offset:4640
    ds_read_b64_tr_b16 a[102:103], v234 offset:5792
    buffer_load_dwordx4 v225, s[36:39], s59 offen lds
    v_cvt_pk_bf16_f32 v145, v242, v243
    v_lshlrev_b32 v240, 16, v146
    v_mfma_f32_32x32x16_bf16 a[32:47], a[116:119], v[88:91], a[32:47]
    ds_read_b64_tr_b16 a[104:105], v234 offset:4672
    ds_read_b64_tr_b16 a[106:107], v234 offset:5824
    v_and_b32 v241, s61, v146
    v_lshlrev_b32 v242, 16, v147
    v_and_b32 v243, s61, v147
    v_sub_f32 v240, v240, v216
    v_sub_f32 v241, v241, v216
    s_waitcnt lgkmcnt(6)
    v_mfma_f32_32x32x16_bf16 a[48:63], a[120:123], v[88:91], a[48:63]
    ds_read_b64_tr_b16 a[108:109], v234 offset:4704
    ds_read_b64_tr_b16 a[110:111], v234 offset:5856
    s_add_u32 m0, s53, 2048
    v_sub_f32 v242, v242, v216
    v_sub_f32 v243, v243, v216
    v_cvt_pk_bf16_f32 v146, v240, v241
    v_cvt_pk_bf16_f32 v147, v242, v243
    v_mfma_f32_32x32x16_bf16 a[64:79], a[124:127], v[88:91], a[64:79]
    ds_read_b64_tr_b16 a[112:113], v234 offset:4736
    ds_read_b64_tr_b16 a[114:115], v234 offset:5888
    buffer_load_dwordx4 v226, s[36:39], s59 offen lds
    v_lshlrev_b32 v240, 16, v148
    v_and_b32 v241, s61, v148
    v_mfma_f32_32x32x16_bf16 a[80:95], a[128:131], v[88:91], a[80:95]
    ds_read_b64_tr_b16 a[116:117], v234 offset:4768
    ds_read_b64_tr_b16 a[118:119], v234 offset:5920
    v_lshlrev_b32 v242, 16, v149
    v_and_b32 v243, s61, v149
    v_sub_f32 v240, v240, v216
    v_sub_f32 v241, v241, v216
    v_sub_f32 v242, v242, v216
    s_waitcnt lgkmcnt(6)
    v_mfma_f32_32x32x16_bf16 v[168:183], a[96:99], v[92:95], v[168:183]
    ds_read_b64_tr_b16 a[120:121], v234 offset:4800
    ds_read_b64_tr_b16 a[122:123], v234 offset:5952
    s_add_u32 m0, s53, 3072
    v_sub_f32 v243, v243, v216
    v_cvt_pk_bf16_f32 v148, v240, v241
    v_cvt_pk_bf16_f32 v149, v242, v243
    v_lshlrev_b32 v240, 16, v150
    v_mfma_f32_32x32x16_bf16 v[184:199], a[100:103], v[92:95], v[184:199]
    ds_read_b64_tr_b16 a[124:125], v234 offset:4832
    ds_read_b64_tr_b16 a[126:127], v234 offset:5984
    buffer_load_dwordx4 v227, s[36:39], s59 offen lds
    v_and_b32 v241, s61, v150
    v_lshlrev_b32 v242, 16, v151
    v_mfma_f32_32x32x16_bf16 v[200:215], a[104:107], v[92:95], v[200:215]
    ds_read_b64_tr_b16 a[128:129], v234 offset:4864
    ds_read_b64_tr_b16 a[130:131], v234 offset:6016
    v_and_b32 v243, s61, v151
    v_sub_f32 v240, v240, v216
    v_sub_f32 v241, v241, v216
    v_sub_f32 v242, v242, v216
    v_sub_f32 v243, v243, v216
    s_waitcnt lgkmcnt(6)
    v_mfma_f32_32x32x16_bf16 a[0:15], a[108:111], v[92:95], a[0:15]
    ds_read_b64_tr_b16 a[96:97], v234 offset:9216
    ds_read_b64_tr_b16 a[98:99], v234 offset:10368
    s_add_u32 m0, s53, 4096
    v_cvt_pk_bf16_f32 v150, v240, v241
    v_cvt_pk_bf16_f32 v151, v242, v243
    v_lshlrev_b32 v240, 16, v152
    v_and_b32 v241, s61, v152
    v_mfma_f32_32x32x16_bf16 a[16:31], a[112:115], v[92:95], a[16:31]
    ds_read_b64_tr_b16 a[100:101], v234 offset:9248
    ds_read_b64_tr_b16 a[102:103], v234 offset:10400
    buffer_load_dwordx4 v228, s[36:39], s59 offen lds
    v_lshlrev_b32 v242, 16, v153
    v_and_b32 v243, s61, v153
    v_mfma_f32_32x32x16_bf16 a[32:47], a[116:119], v[92:95], a[32:47]
    ds_read_b64_tr_b16 a[104:105], v234 offset:9280
    ds_read_b64_tr_b16 a[106:107], v234 offset:10432
    v_sub_f32 v240, v240, v216
    v_sub_f32 v241, v241, v216
    v_sub_f32 v242, v242, v216
    v_sub_f32 v243, v243, v216
    v_cvt_pk_bf16_f32 v152, v240, v241
    s_waitcnt lgkmcnt(6)
    v_mfma_f32_32x32x16_bf16 a[48:63], a[120:123], v[92:95], a[48:63]
    ds_read_b64_tr_b16 a[108:109], v234 offset:9312
    ds_read_b64_tr_b16 a[110:111], v234 offset:10464
    s_add_u32 m0, s53, 5120
    v_cvt_pk_bf16_f32 v153, v242, v243
    v_lshlrev_b32 v240, 16, v154
    v_and_b32 v241, s61, v154
    v_mfma_f32_32x32x16_bf16 a[64:79], a[124:127], v[92:95], a[64:79]
    ds_read_b64_tr_b16 a[112:113], v234 offset:9344
    ds_read_b64_tr_b16 a[114:115], v234 offset:10496
    buffer_load_dwordx4 v229, s[36:39], s59 offen lds
    v_lshlrev_b32 v242, 16, v155
    v_and_b32 v243, s61, v155
    v_mfma_f32_32x32x16_bf16 a[80:95], a[128:131], v[92:95], a[80:95]
    ds_read_b64_tr_b16 a[116:117], v234 offset:9376
    ds_read_b64_tr_b16 a[118:119], v234 offset:10528
    v_sub_f32 v240, v240, v216
    v_sub_f32 v241, v241, v216
    v_sub_f32 v242, v242, v216
    v_sub_f32 v243, v243, v216
    v_cvt_pk_bf16_f32 v154, v240, v241
    s_waitcnt lgkmcnt(6)
    v_mfma_f32_32x32x16_bf16 v[168:183], a[96:99], v[96:99], v[168:183]
    ds_read_b64_tr_b16 a[120:121], v234 offset:9408
    ds_read_b64_tr_b16 a[122:123], v234 offset:10560
    s_add_u32 m0, s53, 6144
    v_cvt_pk_bf16_f32 v155, v242, v243
    v_lshlrev_b32 v240, 16, v156
    v_and_b32 v241, s61, v156
    v_lshlrev_b32 v242, 16, v157
    v_mfma_f32_32x32x16_bf16 v[184:199], a[100:103], v[96:99], v[184:199]
    ds_read_b64_tr_b16 a[124:125], v234 offset:9440
    ds_read_b64_tr_b16 a[126:127], v234 offset:10592
    buffer_load_dwordx4 v230, s[36:39], s59 offen lds
    v_and_b32 v243, s61, v157
    v_sub_f32 v240, v240, v216
    v_mfma_f32_32x32x16_bf16 v[200:215], a[104:107], v[96:99], v[200:215]
    ds_read_b64_tr_b16 a[128:129], v234 offset:9472
    ds_read_b64_tr_b16 a[130:131], v234 offset:10624
    v_sub_f32 v241, v241, v216
    v_sub_f32 v242, v242, v216
    v_sub_f32 v243, v243, v216
    v_cvt_pk_bf16_f32 v156, v240, v241
    v_cvt_pk_bf16_f32 v157, v242, v243
    s_waitcnt lgkmcnt(6)
    v_mfma_f32_32x32x16_bf16 a[0:15], a[108:111], v[96:99], a[0:15]
    ds_read_b64_tr_b16 a[96:97], v234 offset:13824
    ds_read_b64_tr_b16 a[98:99], v234 offset:14976
    s_add_u32 m0, s53, 7168
    v_lshlrev_b32 v240, 16, v158
    v_and_b32 v241, s61, v158
    v_lshlrev_b32 v242, 16, v159
    v_and_b32 v243, s61, v159
    v_mfma_f32_32x32x16_bf16 a[16:31], a[112:115], v[96:99], a[16:31]
    ds_read_b64_tr_b16 a[100:101], v234 offset:13856
    ds_read_b64_tr_b16 a[102:103], v234 offset:15008
    buffer_load_dwordx4 v231, s[36:39], s59 offen lds
    v_sub_f32 v240, v240, v216
    v_sub_f32 v241, v241, v216
    v_mfma_f32_32x32x16_bf16 a[32:47], a[116:119], v[96:99], a[32:47]
    ds_read_b64_tr_b16 a[104:105], v234 offset:13888
    ds_read_b64_tr_b16 a[106:107], v234 offset:15040
    v_sub_f32 v242, v242, v216
    v_sub_f32 v243, v243, v216
    v_cvt_pk_bf16_f32 v158, v240, v241
    v_cvt_pk_bf16_f32 v159, v242, v243
    v_lshlrev_b32 v240, 16, v160
    s_waitcnt lgkmcnt(6)
    v_mfma_f32_32x32x16_bf16 a[48:63], a[120:123], v[96:99], a[48:63]
    ds_read_b64_tr_b16 a[108:109], v234 offset:13920
    ds_read_b64_tr_b16 a[110:111], v234 offset:15072
    s_add_u32 m0, s53, 8192
    v_and_b32 v241, s61, v160
    v_lshlrev_b32 v242, 16, v161
    v_and_b32 v243, s61, v161
    v_sub_f32 v240, v240, v216
    v_mfma_f32_32x32x16_bf16 a[64:79], a[124:127], v[96:99], a[64:79]
    ds_read_b64_tr_b16 a[112:113], v234 offset:13952
    ds_read_b64_tr_b16 a[114:115], v234 offset:15104
    buffer_load_dwordx4 v232, s[36:39], s59 offen lds
    v_sub_f32 v241, v241, v216
    v_sub_f32 v242, v242, v216
    v_mfma_f32_32x32x16_bf16 a[80:95], a[128:131], v[96:99], a[80:95]
    ds_read_b64_tr_b16 a[116:117], v234 offset:13984
    ds_read_b64_tr_b16 a[118:119], v234 offset:15136
    v_sub_f32 v243, v243, v216
    v_cvt_pk_bf16_f32 v160, v240, v241
    v_cvt_pk_bf16_f32 v161, v242, v243
    v_lshlrev_b32 v240, 16, v162
    v_and_b32 v241, s61, v162
    s_waitcnt lgkmcnt(6)
    v_mfma_f32_32x32x16_bf16 v[168:183], a[96:99], v[100:103], v[168:183]
    ds_read_b64_tr_b16 a[120:121], v234 offset:14016
    ds_read_b64_tr_b16 a[122:123], v234 offset:15168
    v_lshlrev_b32 v242, 16, v163
    v_and_b32 v243, s61, v163
    v_sub_f32 v240, v240, v216
    v_sub_f32 v241, v241, v216
    v_mfma_f32_32x32x16_bf16 v[184:199], a[100:103], v[100:103], v[184:199]
    ds_read_b64_tr_b16 a[124:125], v234 offset:14048
    ds_read_b64_tr_b16 a[126:127], v234 offset:15200
    v_sub_f32 v242, v242, v216
    v_sub_f32 v243, v243, v216
    v_cvt_pk_bf16_f32 v162, v240, v241
    v_mfma_f32_32x32x16_bf16 v[200:215], a[104:107], v[100:103], v[200:215]
    ds_read_b64_tr_b16 a[128:129], v234 offset:14080
    ds_read_b64_tr_b16 a[130:131], v234 offset:15232
    v_cvt_pk_bf16_f32 v163, v242, v243
    v_lshlrev_b32 v240, 16, v164
    v_and_b32 v241, s61, v164
    v_lshlrev_b32 v242, 16, v165
    s_waitcnt lgkmcnt(6)
    v_mfma_f32_32x32x16_bf16 a[0:15], a[108:111], v[100:103], a[0:15]
    ds_read_b64_tr_b16 a[96:97], v235 offset:0
    ds_read_b64_tr_b16 a[98:99], v235 offset:1152
    v_and_b32 v243, s61, v165
    v_sub_f32 v240, v240, v216
    v_sub_f32 v241, v241, v216
    v_sub_f32 v242, v242, v216
    v_mfma_f32_32x32x16_bf16 a[16:31], a[112:115], v[100:103], a[16:31]
    ds_read_b64_tr_b16 a[100:101], v235 offset:32
    ds_read_b64_tr_b16 a[102:103], v235 offset:1184
    v_sub_f32 v243, v243, v216
    v_cvt_pk_bf16_f32 v164, v240, v241
    v_cvt_pk_bf16_f32 v165, v242, v243
    v_mfma_f32_32x32x16_bf16 a[32:47], a[116:119], v[100:103], a[32:47]
    ds_read_b64_tr_b16 a[104:105], v235 offset:64
    ds_read_b64_tr_b16 a[106:107], v235 offset:1216
    v_lshlrev_b32 v240, 16, v166
    v_and_b32 v241, s61, v166
    v_lshlrev_b32 v242, 16, v167
    v_and_b32 v243, s61, v167
    s_waitcnt lgkmcnt(6)
    v_mfma_f32_32x32x16_bf16 a[48:63], a[120:123], v[100:103], a[48:63]
    ds_read_b64_tr_b16 a[108:109], v235 offset:96
    ds_read_b64_tr_b16 a[110:111], v235 offset:1248
    v_sub_f32 v240, v240, v216
    v_sub_f32 v241, v241, v216
    v_sub_f32 v242, v242, v216
    v_sub_f32 v243, v243, v216
    v_mfma_f32_32x32x16_bf16 a[64:79], a[124:127], v[100:103], a[64:79]
    ds_read_b64_tr_b16 a[112:113], v235 offset:128
    ds_read_b64_tr_b16 a[114:115], v235 offset:1280
    v_cvt_pk_bf16_f32 v166, v240, v241
    v_cvt_pk_bf16_f32 v167, v242, v243
    v_mfma_f32_32x32x16_bf16 a[80:95], a[128:131], v[100:103], a[80:95]
    ds_read_b64_tr_b16 a[116:117], v235 offset:160
    ds_read_b64_tr_b16 a[118:119], v235 offset:1312
    s_waitcnt vmcnt(9)
    s_barrier
    s_waitcnt lgkmcnt(6)
    v_mfma_f32_32x32x16_bf16 v[168:183], a[96:99], v[104:107], v[168:183]
    ds_read_b64_tr_b16 a[120:121], v235 offset:192
    ds_read_b64_tr_b16 a[122:123], v235 offset:1344
    s_mov_b32 s59, 1990656
    s_add_u32 m0, s53, 37120
    v_mfma_f32_32x32x16_bf16 v[184:199], a[100:103], v[104:107], v[184:199]
    ds_read_b64_tr_b16 a[124:125], v235 offset:224
    ds_read_b64_tr_b16 a[126:127], v235 offset:1376
    buffer_load_dwordx4 v224, s[36:39], s59 offen lds
    v_mfma_f32_32x32x16_bf16 v[200:215], a[104:107], v[104:107], v[200:215]
    ds_read_b64_tr_b16 a[128:129], v235 offset:256
    ds_read_b64_tr_b16 a[130:131], v235 offset:1408
    s_add_u32 m0, s53, 38144
    s_waitcnt lgkmcnt(6)
    v_mfma_f32_32x32x16_bf16 a[0:15], a[108:111], v[104:107], a[0:15]
    ds_read_b64_tr_b16 a[96:97], v235 offset:4608
    ds_read_b64_tr_b16 a[98:99], v235 offset:5760
    buffer_load_dwordx4 v225, s[36:39], s59 offen lds
    v_mfma_f32_32x32x16_bf16 a[16:31], a[112:115], v[104:107], a[16:31]
    ds_read_b64_tr_b16 a[100:101], v235 offset:4640
    ds_read_b64_tr_b16 a[102:103], v235 offset:5792
    s_add_u32 m0, s53, 39168
    v_mfma_f32_32x32x16_bf16 a[32:47], a[116:119], v[104:107], a[32:47]
    ds_read_b64_tr_b16 a[104:105], v235 offset:4672
    ds_read_b64_tr_b16 a[106:107], v235 offset:5824
    buffer_load_dwordx4 v226, s[36:39], s59 offen lds
    s_waitcnt lgkmcnt(6)
    v_mfma_f32_32x32x16_bf16 a[48:63], a[120:123], v[104:107], a[48:63]
    ds_read_b64_tr_b16 a[108:109], v235 offset:4704
    ds_read_b64_tr_b16 a[110:111], v235 offset:5856
    s_add_u32 m0, s53, 40192
    v_mfma_f32_32x32x16_bf16 a[64:79], a[124:127], v[104:107], a[64:79]
    ds_read_b64_tr_b16 a[112:113], v235 offset:4736
    ds_read_b64_tr_b16 a[114:115], v235 offset:5888
    buffer_load_dwordx4 v227, s[36:39], s59 offen lds
    v_mfma_f32_32x32x16_bf16 a[80:95], a[128:131], v[104:107], a[80:95]
    ds_read_b64_tr_b16 a[116:117], v235 offset:4768
    ds_read_b64_tr_b16 a[118:119], v235 offset:5920
    s_add_u32 m0, s53, 41216
    s_waitcnt lgkmcnt(6)
    v_mfma_f32_32x32x16_bf16 v[168:183], a[96:99], v[108:111], v[168:183]
    ds_read_b64_tr_b16 a[120:121], v235 offset:4800
    ds_read_b64_tr_b16 a[122:123], v235 offset:5952
    buffer_load_dwordx4 v228, s[36:39], s59 offen lds
    v_mfma_f32_32x32x16_bf16 v[184:199], a[100:103], v[108:111], v[184:199]
    ds_read_b64_tr_b16 a[124:125], v235 offset:4832
    ds_read_b64_tr_b16 a[126:127], v235 offset:5984
    s_add_u32 m0, s53, 42240
    v_mfma_f32_32x32x16_bf16 v[200:215], a[104:107], v[108:111], v[200:215]
    ds_read_b64_tr_b16 a[128:129], v235 offset:4864
    ds_read_b64_tr_b16 a[130:131], v235 offset:6016
    buffer_load_dwordx4 v229, s[36:39], s59 offen lds
    s_waitcnt lgkmcnt(6)
    v_mfma_f32_32x32x16_bf16 a[0:15], a[108:111], v[108:111], a[0:15]
    ds_read_b64_tr_b16 a[96:97], v235 offset:9216
    ds_read_b64_tr_b16 a[98:99], v235 offset:10368
    s_add_u32 m0, s53, 43264
    v_mfma_f32_32x32x16_bf16 a[16:31], a[112:115], v[108:111], a[16:31]
    ds_read_b64_tr_b16 a[100:101], v235 offset:9248
    ds_read_b64_tr_b16 a[102:103], v235 offset:10400
    buffer_load_dwordx4 v230, s[36:39], s59 offen lds
    v_mfma_f32_32x32x16_bf16 a[32:47], a[116:119], v[108:111], a[32:47]
    ds_read_b64_tr_b16 a[104:105], v235 offset:9280
    ds_read_b64_tr_b16 a[106:107], v235 offset:10432
    s_add_u32 m0, s53, 44288
    s_waitcnt lgkmcnt(6)
    v_mfma_f32_32x32x16_bf16 a[48:63], a[120:123], v[108:111], a[48:63]
    ds_read_b64_tr_b16 a[108:109], v235 offset:9312
    ds_read_b64_tr_b16 a[110:111], v235 offset:10464
    buffer_load_dwordx4 v231, s[36:39], s59 offen lds
    v_mfma_f32_32x32x16_bf16 a[64:79], a[124:127], v[108:111], a[64:79]
    ds_read_b64_tr_b16 a[112:113], v235 offset:9344
    ds_read_b64_tr_b16 a[114:115], v235 offset:10496
    s_add_u32 m0, s53, 45312
    v_mfma_f32_32x32x16_bf16 a[80:95], a[128:131], v[108:111], a[80:95]
    ds_read_b64_tr_b16 a[116:117], v235 offset:9376
    ds_read_b64_tr_b16 a[118:119], v235 offset:10528
    buffer_load_dwordx4 v232, s[36:39], s59 offen lds
    s_waitcnt lgkmcnt(6)
    v_mfma_f32_32x32x16_bf16 v[168:183], a[96:99], v[112:115], v[168:183]
    ds_read_b64_tr_b16 a[120:121], v235 offset:9408
    ds_read_b64_tr_b16 a[122:123], v235 offset:10560
    v_mfma_f32_32x32x16_bf16 v[184:199], a[100:103], v[112:115], v[184:199]
    ds_read_b64_tr_b16 a[124:125], v235 offset:9440
    ds_read_b64_tr_b16 a[126:127], v235 offset:10592
    v_mfma_f32_32x32x16_bf16 v[200:215], a[104:107], v[112:115], v[200:215]
    ds_read_b64_tr_b16 a[128:129], v235 offset:9472
    ds_read_b64_tr_b16 a[130:131], v235 offset:10624
    s_waitcnt lgkmcnt(6)
    v_mfma_f32_32x32x16_bf16 a[0:15], a[108:111], v[112:115], a[0:15]
    ds_read_b64_tr_b16 a[96:97], v235 offset:13824
    ds_read_b64_tr_b16 a[98:99], v235 offset:14976
    v_mfma_f32_32x32x16_bf16 a[16:31], a[112:115], v[112:115], a[16:31]
    ds_read_b64_tr_b16 a[100:101], v235 offset:13856
    ds_read_b64_tr_b16 a[102:103], v235 offset:15008
    v_mfma_f32_32x32x16_bf16 a[32:47], a[116:119], v[112:115], a[32:47]
    ds_read_b64_tr_b16 a[104:105], v235 offset:13888
    ds_read_b64_tr_b16 a[106:107], v235 offset:15040
    s_waitcnt lgkmcnt(6)
    v_mfma_f32_32x32x16_bf16 a[48:63], a[120:123], v[112:115], a[48:63]
    ds_read_b64_tr_b16 a[108:109], v235 offset:13920
    ds_read_b64_tr_b16 a[110:111], v235 offset:15072
    buffer_load_dword v251, v254, s[88:91], s63 offen offset:256 sc1
    v_mfma_f32_32x32x16_bf16 a[64:79], a[124:127], v[112:115], a[64:79]
    ds_read_b64_tr_b16 a[112:113], v235 offset:13952
    ds_read_b64_tr_b16 a[114:115], v235 offset:15104
    v_mfma_f32_32x32x16_bf16 a[80:95], a[128:131], v[112:115], a[80:95]
    ds_read_b64_tr_b16 a[116:117], v235 offset:13984
    ds_read_b64_tr_b16 a[118:119], v235 offset:15136
    s_waitcnt lgkmcnt(6)
    v_mfma_f32_32x32x16_bf16 v[168:183], a[96:99], v[116:119], v[168:183]
    ds_read_b64_tr_b16 a[120:121], v235 offset:14016
    ds_read_b64_tr_b16 a[122:123], v235 offset:15168
    v_mfma_f32_32x32x16_bf16 v[184:199], a[100:103], v[116:119], v[184:199]
    ds_read_b64_tr_b16 a[124:125], v235 offset:14048
    ds_read_b64_tr_b16 a[126:127], v235 offset:15200
    v_mfma_f32_32x32x16_bf16 v[200:215], a[104:107], v[116:119], v[200:215]
    ds_read_b64_tr_b16 a[128:129], v235 offset:14080
    ds_read_b64_tr_b16 a[130:131], v235 offset:15232
    s_waitcnt lgkmcnt(6)
    v_mfma_f32_32x32x16_bf16 a[0:15], a[108:111], v[116:119], a[0:15]
    ds_read_b64_tr_b16 a[96:97], v236 offset:0
    ds_read_b64_tr_b16 a[98:99], v236 offset:1152
    v_mfma_f32_32x32x16_bf16 a[16:31], a[112:115], v[116:119], a[16:31]
    ds_read_b64_tr_b16 a[100:101], v236 offset:4608
    ds_read_b64_tr_b16 a[102:103], v236 offset:5760
    v_mfma_f32_32x32x16_bf16 a[32:47], a[116:119], v[116:119], a[32:47]
    ds_read_b64_tr_b16 a[104:105], v236 offset:9216
    ds_read_b64_tr_b16 a[106:107], v236 offset:10368
    s_waitcnt vmcnt(10)
    s_barrier
    s_waitcnt lgkmcnt(6)
    v_mfma_f32_32x32x16_bf16 a[48:63], a[120:123], v[116:119], a[48:63]
    ds_read_b64_tr_b16 a[108:109], v236 offset:13824
    ds_read_b64_tr_b16 a[110:111], v236 offset:14976
    v_mfma_f32_32x32x16_bf16 a[64:79], a[124:127], v[116:119], a[64:79]
    ds_read_b64_tr_b16 a[112:113], v233 offset:0
    ds_read_b64_tr_b16 a[114:115], v233 offset:1152
    v_mfma_f32_32x32x16_bf16 a[80:95], a[128:131], v[116:119], a[80:95]
    ds_read_b64_tr_b16 a[116:117], v233 offset:4608
    ds_read_b64_tr_b16 a[118:119], v233 offset:5760
    s_waitcnt vmcnt(1)
    s_barrier
    s_waitcnt lgkmcnt(6)
    v_mfma_f32_32x32x16_bf16 v[168:183], a[96:99], v[120:123], v[168:183]
    ds_read_b64_tr_b16 a[120:121], v233 offset:9216
    ds_read_b64_tr_b16 a[122:123], v233 offset:10368
    s_waitcnt vmcnt(0)
    s_cmp_lg_u32 s3, 3
    s_cbranch_scc1 wok_2
    s_mov_b32 s94, -1
    s_mov_b32 s95, 0
    v_cmp_ne_u32 vcc, s100, v251
    s_and_b64 vcc, vcc, s[94:95]
    s_cbranch_vccz wok_2
    s_add_u32 s97, s63, 256
    s_mov_b32 s96, 30000
poll_3:
    buffer_load_dword v251, v254, s[88:91], s97 offen sc1
    s_waitcnt vmcnt(0)
    v_cmp_ne_u32 vcc, s100, v251
    s_and_b64 vcc, vcc, s[94:95]
    s_cbranch_vccz polld_4
    s_sub_u32 s96, s96, 1
    s_cbranch_scc0 poll_3
polld_4:
wok_2:
    s_barrier
    v_mfma_f32_32x32x16_bf16 v[168:183], a[100:103], v[124:127], v[168:183]
    ds_read_b64_tr_b16 a[124:125], v233 offset:13824
    ds_read_b64_tr_b16 a[126:127], v233 offset:14976
    buffer_load_dwordx4 a[132:135], v244, s[84:87], s62 offen offset:0 sc1
    v_mfma_f32_32x32x16_bf16 v[168:183], a[104:107], v[128:131], v[168:183]
    ds_read_b64_tr_b16 a[128:129], v234 offset:0
    ds_read_b64_tr_b16 a[130:131], v234 offset:1152
    s_waitcnt lgkmcnt(6)
    v_mfma_f32_32x32x16_bf16 v[168:183], a[108:111], v[132:135], v[168:183]
    ds_read_b64_tr_b16 a[96:97], v234 offset:4608
    ds_read_b64_tr_b16 a[98:99], v234 offset:5760
    buffer_load_dwordx4 a[136:139], v244, s[84:87], s62 offen offset:1024 sc1
    v_mfma_f32_32x32x16_bf16 v[168:183], a[112:115], v[136:139], v[168:183]
    ds_read_b64_tr_b16 a[100:101], v234 offset:9216
    ds_read_b64_tr_b16 a[102:103], v234 offset:10368
    v_mfma_f32_32x32x16_bf16 v[168:183], a[116:119], v[140:143], v[168:183]
    ds_read_b64_tr_b16 a[104:105], v234 offset:13824
    ds_read_b64_tr_b16 a[106:107], v234 offset:14976
    buffer_load_dwordx4 a[140:143], v244, s[84:87], s62 offen offset:2048 sc1
    s_waitcnt lgkmcnt(6)
    v_mfma_f32_32x32x16_bf16 v[168:183], a[120:123], v[144:147], v[168:183]
    ds_read_b64_tr_b16 a[108:109], v236 offset:32
    ds_read_b64_tr_b16 a[110:111], v236 offset:1184
    v_mfma_f32_32x32x16_bf16 v[168:183], a[124:127], v[148:151], v[168:183]
    ds_read_b64_tr_b16 a[112:113], v236 offset:4640
    ds_read_b64_tr_b16 a[114:115], v236 offset:5792
    buffer_load_dwordx4 a[144:147], v244, s[84:87], s62 offen offset:3072 sc1
    v_mfma_f32_32x32x16_bf16 v[168:183], a[128:131], v[152:155], v[168:183]
    ds_read_b64_tr_b16 a[116:117], v236 offset:9248
    ds_read_b64_tr_b16 a[118:119], v236 offset:10400
    s_waitcnt lgkmcnt(6)
    v_mfma_f32_32x32x16_bf16 v[168:183], a[96:99], v[156:159], v[168:183]
    ds_read_b64_tr_b16 a[120:121], v236 offset:13856
    ds_read_b64_tr_b16 a[122:123], v236 offset:15008
    buffer_load_dwordx4 a[148:151], v245, s[84:87], s62 offen offset:0 sc1
    s_add_u32 s62, s62, 20480
    v_mfma_f32_32x32x16_bf16 v[168:183], a[100:103], v[160:163], v[168:183]
    ds_read_b64_tr_b16 a[124:125], v233 offset:32
    ds_read_b64_tr_b16 a[126:127], v233 offset:1184
    v_mfma_f32_32x32x16_bf16 v[168:183], a[104:107], v[164:167], v[168:183]
    ds_read_b64_tr_b16 a[128:129], v233 offset:4640
    ds_read_b64_tr_b16 a[130:131], v233 offset:5792
    buffer_load_dwordx4 a[152:155], v244, s[84:87], s62 offen offset:0 sc1
    s_waitcnt lgkmcnt(6)
    v_mfma_f32_32x32x16_bf16 v[184:199], a[108:111], v[120:123], v[184:199]
    ds_read_b64_tr_b16 a[96:97], v233 offset:9248
    ds_read_b64_tr_b16 a[98:99], v233 offset:10400
    v_mfma_f32_32x32x16_bf16 v[184:199], a[112:115], v[124:127], v[184:199]
    ds_read_b64_tr_b16 a[100:101], v233 offset:13856
    ds_read_b64_tr_b16 a[102:103], v233 offset:15008
    buffer_load_dwordx4 a[156:159], v244, s[84:87], s62 offen offset:1024 sc1
    v_mfma_f32_32x32x16_bf16 v[184:199], a[116:119], v[128:131], v[184:199]
    ds_read_b64_tr_b16 a[104:105], v234 offset:32
    ds_read_b64_tr_b16 a[106:107], v234 offset:1184
    v_mul_f32 v8, v222, v168
    v_exp_f32 v8, v8
    v_mul_f32 v9, v222, v169
    v_exp_f32 v9, v9
    s_waitcnt lgkmcnt(6)
    v_mfma_f32_32x32x16_bf16 v[184:199], a[120:123], v[132:135], v[184:199]
    ds_read_b64_tr_b16 a[108:109], v234 offset:4640
    ds_read_b64_tr_b16 a[110:111], v234 offset:5792
    buffer_load_dwordx4 a[160:163], v244, s[84:87], s62 offen offset:2048 sc1
    v_mul_f32 v10, v222, v170
    v_fma_f32 v8, v8, v218, v218
    v_exp_f32 v10, v10
    v_mul_f32 v11, v222, v171
    v_rcp_f32 v8, v8
    v_mfma_f32_32x32x16_bf16 v[184:199], a[124:127], v[136:139], v[184:199]
    ds_read_b64_tr_b16 a[112:113], v234 offset:9248
    ds_read_b64_tr_b16 a[114:115], v234 offset:10400
    v_fma_f32 v9, v9, v218, v218
    v_exp_f32 v11, v11
    v_mul_f32 v12, v222, v172
    v_rcp_f32 v9, v9
    v_fma_f32 v10, v10, v218, v218
    v_mfma_f32_32x32x16_bf16 v[184:199], a[128:131], v[140:143], v[184:199]
    ds_read_b64_tr_b16 a[116:117], v234 offset:13856
    ds_read_b64_tr_b16 a[118:119], v234 offset:15008
    buffer_load_dwordx4 a[164:167], v244, s[84:87], s62 offen offset:3072 sc1
    v_exp_f32 v12, v12
    v_mul_f32 v13, v222, v173
    v_mul_f32 v8, v8, v176
    v_rcp_f32 v10, v10
    v_fma_f32 v11, v11, v218, v218
    s_waitcnt lgkmcnt(6)
    v_mfma_f32_32x32x16_bf16 v[184:199], a[96:99], v[144:147], v[184:199]
    ds_read_b64_tr_b16 a[120:121], v236 offset:64
    ds_read_b64_tr_b16 a[122:123], v236 offset:1216
    v_exp_f32 v13, v13
    v_mul_f32 v14, v222, v174
    v_mul_f32 v9, v9, v177
    v_rcp_f32 v11, v11
    v_fma_f32 v12, v12, v218, v218
    v_mfma_f32_32x32x16_bf16 v[184:199], a[100:103], v[148:151], v[184:199]
    ds_read_b64_tr_b16 a[124:125], v236 offset:4672
    ds_read_b64_tr_b16 a[126:127], v236 offset:5824
    buffer_load_dwordx4 a[168:171], v245, s[84:87], s62 offen offset:0 sc1
    s_add_u32 s62, s62, 20480
    v_exp_f32 v14, v14
    v_mul_f32 v15, v222, v175
    v_cvt_pk_bf16_f32 v24, v8, v9
    v_mul_f32 v10, v10, v178
    v_rcp_f32 v12, v12
    v_mfma_f32_32x32x16_bf16 v[184:199], a[104:107], v[152:155], v[184:199]
    ds_read_b64_tr_b16 a[128:129], v236 offset:9280
    ds_read_b64_tr_b16 a[130:131], v236 offset:10432
    v_fma_f32 v13, v13, v218, v218
    v_exp_f32 v15, v15
    v_mul_f32 v11, v11, v179
    v_rcp_f32 v13, v13
    v_fma_f32 v14, v14, v218, v218
    s_waitcnt lgkmcnt(6)
    v_mfma_f32_32x32x16_bf16 v[184:199], a[108:111], v[156:159], v[184:199]
    ds_read_b64_tr_b16 a[96:97], v236 offset:13888
    ds_read_b64_tr_b16 a[98:99], v236 offset:15040
    buffer_load_dwordx4 a[172:175], v244, s[84:87], s62 offen offset:0 sc1
    v_cvt_pk_bf16_f32 v25, v10, v11
    v_mul_f32 v12, v12, v180
    v_rcp_f32 v14, v14
    v_fma_f32 v15, v15, v218, v218
    v_mul_f32 v13, v13, v181
    v_mfma_f32_32x32x16_bf16 v[184:199], a[112:115], v[160:163], v[184:199]
    ds_read_b64_tr_b16 a[100:101], v233 offset:64
    ds_read_b64_tr_b16 a[102:103], v233 offset:1216
    v_rcp_f32 v15, v15
    s_nop 0
    v_cvt_pk_bf16_f32 v26, v12, v13
    v_mul_f32 v14, v14, v182
    s_nop 0
    v_mfma_f32_32x32x16_bf16 v[184:199], a[116:119], v[164:167], v[184:199]
    ds_read_b64_tr_b16 a[104:105], v233 offset:4672
    ds_read_b64_tr_b16 a[106:107], v233 offset:5824
    buffer_load_dwordx4 a[176:179], v244, s[84:87], s62 offen offset:1024 sc1
    v_mul_f32 v15, v15, v183
    s_nop 0
    v_cvt_pk_bf16_f32 v27, v14, v15
    s_nop 0
    buffer_store_dwordx4 v[24:27], v237, s[40:43], s56 offen offset:0 sc1
    s_waitcnt lgkmcnt(6)
    v_mfma_f32_32x32x16_bf16 v[200:215], a[120:123], v[120:123], v[200:215]
    ds_read_b64_tr_b16 a[108:109], v233 offset:9280
    ds_read_b64_tr_b16 a[110:111], v233 offset:10432
    v_mfma_f32_32x32x16_bf16 v[200:215], a[124:127], v[124:127], v[200:215]
    ds_read_b64_tr_b16 a[112:113], v233 offset:13888
    ds_read_b64_tr_b16 a[114:115], v233 offset:15040
    buffer_load_dwordx4 a[180:183], v244, s[84:87], s62 offen offset:2048 sc1
    v_mfma_f32_32x32x16_bf16 v[200:215], a[128:131], v[128:131], v[200:215]
    ds_read_b64_tr_b16 a[116:117], v234 offset:64
    ds_read_b64_tr_b16 a[118:119], v234 offset:1216
    v_mul_f32 v48, v222, v184
    v_exp_f32 v48, v48
    v_mul_f32 v49, v222, v185
    v_exp_f32 v49, v49
    s_waitcnt lgkmcnt(6)
    v_mfma_f32_32x32x16_bf16 v[200:215], a[96:99], v[132:135], v[200:215]
    ds_read_b64_tr_b16 a[120:121], v234 offset:4672
    ds_read_b64_tr_b16 a[122:123], v234 offset:5824
    buffer_load_dwordx4 a[184:187], v244, s[84:87], s62 offen offset:3072 sc1
    v_mul_f32 v50, v222, v186
    v_fma_f32 v48, v48, v218, v218
    v_exp_f32 v50, v50
    v_mul_f32 v51, v222, v187
    v_rcp_f32 v48, v48
    v_mfma_f32_32x32x16_bf16 v[200:215], a[100:103], v[136:139], v[200:215]
    ds_read_b64_tr_b16 a[124:125], v234 offset:9280
    ds_read_b64_tr_b16 a[126:127], v234 offset:10432
    v_fma_f32 v49, v49, v218, v218
    v_exp_f32 v51, v51
    v_mul_f32 v52, v222, v188
    v_rcp_f32 v49, v49
    v_fma_f32 v50, v50, v218, v218
    v_mfma_f32_32x32x16_bf16 v[200:215], a[104:107], v[140:143], v[200:215]
    ds_read_b64_tr_b16 a[128:129], v234 offset:13888
    ds_read_b64_tr_b16 a[130:131], v234 offset:15040
    buffer_load_dwordx4 a[188:191], v245, s[84:87], s62 offen offset:0 sc1
    s_add_u32 s62, s62, 20480
    v_exp_f32 v52, v52
    v_mul_f32 v53, v222, v189
    v_mul_f32 v48, v48, v192
    v_rcp_f32 v50, v50
    v_fma_f32 v51, v51, v218, v218
    s_waitcnt lgkmcnt(6)
    v_mfma_f32_32x32x16_bf16 v[200:215], a[108:111], v[144:147], v[200:215]
    ds_read_b64_tr_b16 a[96:97], v236 offset:96
    ds_read_b64_tr_b16 a[98:99], v236 offset:1248
    v_exp_f32 v53, v53
    v_mul_f32 v54, v222, v190
    v_mul_f32 v49, v49, v193
    v_rcp_f32 v51, v51
    v_fma_f32 v52, v52, v218, v218
    v_mfma_f32_32x32x16_bf16 v[200:215], a[112:115], v[148:151], v[200:215]
    ds_read_b64_tr_b16 a[100:101], v236 offset:4704
    ds_read_b64_tr_b16 a[102:103], v236 offset:5856
    buffer_load_dwordx4 a[192:195], v244, s[84:87], s62 offen offset:0 sc1
    v_exp_f32 v54, v54
    v_mul_f32 v55, v222, v191
    v_cvt_pk_bf16_f32 v64, v48, v49
    v_mul_f32 v50, v50, v194
    v_rcp_f32 v52, v52
    v_mfma_f32_32x32x16_bf16 v[200:215], a[116:119], v[152:155], v[200:215]
    ds_read_b64_tr_b16 a[104:105], v236 offset:9312
    ds_read_b64_tr_b16 a[106:107], v236 offset:10464
    v_fma_f32 v53, v53, v218, v218
    v_exp_f32 v55, v55
    v_mul_f32 v51, v51, v195
    v_rcp_f32 v53, v53
    v_fma_f32 v54, v54, v218, v218
    s_waitcnt lgkmcnt(6)
    v_mfma_f32_32x32x16_bf16 v[200:215], a[120:123], v[156:159], v[200:215]
    ds_read_b64_tr_b16 a[108:109], v236 offset:13920
    ds_read_b64_tr_b16 a[110:111], v236 offset:15072
    buffer_load_dwordx4 a[196:199], v244, s[84:87], s62 offen offset:1024 sc1
    v_cvt_pk_bf16_f32 v65, v50, v51
    v_mul_f32 v52, v52, v196
    v_rcp_f32 v54, v54
    v_fma_f32 v55, v55, v218, v218
    v_mul_f32 v53, v53, v197
    v_mfma_f32_32x32x16_bf16 v[200:215], a[124:127], v[160:163], v[200:215]
    ds_read_b64_tr_b16 a[112:113], v233 offset:96
    ds_read_b64_tr_b16 a[114:115], v233 offset:1248
    v_rcp_f32 v55, v55
    s_nop 0
    v_cvt_pk_bf16_f32 v66, v52, v53
    v_mul_f32 v54, v54, v198
    s_nop 0
    v_mfma_f32_32x32x16_bf16 v[200:215], a[128:131], v[164:167], v[200:215]
    ds_read_b64_tr_b16 a[116:117], v233 offset:4704
    ds_read_b64_tr_b16 a[118:119], v233 offset:5856
    buffer_load_dwordx4 a[200:203], v244, s[84:87], s62 offen offset:2048 sc1
    v_mul_f32 v55, v55, v199
    s_nop 0
    v_cvt_pk_bf16_f32 v67, v54, v55
    s_nop 0
    buffer_store_dwordx4 v[64:67], v237, s[40:43], s56 offen offset:512 sc1
    s_waitcnt lgkmcnt(6)
    v_mfma_f32_32x32x16_bf16 a[0:15], a[96:99], v[120:123], a[0:15]
    ds_read_b64_tr_b16 a[120:121], v233 offset:9312
    ds_read_b64_tr_b16 a[122:123], v233 offset:10464
    v_mfma_f32_32x32x16_bf16 a[0:15], a[100:103], v[124:127], a[0:15]
    ds_read_b64_tr_b16 a[124:125], v233 offset:13920
    ds_read_b64_tr_b16 a[126:127], v233 offset:15072
    buffer_load_dwordx4 a[204:207], v244, s[84:87], s62 offen offset:3072 sc1
    v_mfma_f32_32x32x16_bf16 a[0:15], a[104:107], v[128:131], a[0:15]
    ds_read_b64_tr_b16 a[128:129], v234 offset:96
    ds_read_b64_tr_b16 a[130:131], v234 offset:1248
    v_mul_f32 v8, v222, v200
    v_exp_f32 v8, v8
    v_mul_f32 v9, v222, v201
    v_exp_f32 v9, v9
    s_waitcnt lgkmcnt(6)
    v_mfma_f32_32x32x16_bf16 a[0:15], a[108:111], v[132:135], a[0:15]
    ds_read_b64_tr_b16 a[96:97], v234 offset:4704
    ds_read_b64_tr_b16 a[98:99], v234 offset:5856
    buffer_load_dwordx4 a[208:211], v245, s[84:87], s62 offen offset:0 sc1
    s_add_u32 s62, s62, 20480
    v_mul_f32 v10, v222, v202
    v_fma_f32 v8, v8, v218, v218
    v_exp_f32 v10, v10
    v_mul_f32 v11, v222, v203
    v_rcp_f32 v8, v8
    v_mfma_f32_32x32x16_bf16 a[0:15], a[112:115], v[136:139], a[0:15]
    ds_read_b64_tr_b16 a[100:101], v234 offset:9312
    ds_read_b64_tr_b16 a[102:103], v234 offset:10464
    v_fma_f32 v9, v9, v218, v218
    v_exp_f32 v11, v11
    v_mul_f32 v12, v222, v204
    v_rcp_f32 v9, v9
    v_fma_f32 v10, v10, v218, v218
    v_mfma_f32_32x32x16_bf16 a[0:15], a[116:119], v[140:143], a[0:15]
    ds_read_b64_tr_b16 a[104:105], v234 offset:13920
    ds_read_b64_tr_b16 a[106:107], v234 offset:15072
    buffer_load_dwordx4 a[212:215], v244, s[84:87], s62 offen offset:0 sc1
    v_exp_f32 v12, v12
    v_mul_f32 v13, v222, v205
    v_mul_f32 v8, v8, v208
    v_rcp_f32 v10, v10
    v_fma_f32 v11, v11, v218, v218
    s_waitcnt lgkmcnt(6)
    v_mfma_f32_32x32x16_bf16 a[0:15], a[120:123], v[144:147], a[0:15]
    ds_read_b64_tr_b16 a[108:109], v236 offset:128
    ds_read_b64_tr_b16 a[110:111], v236 offset:1280
    v_exp_f32 v13, v13
    v_mul_f32 v14, v222, v206
    v_mul_f32 v9, v9, v209
    v_rcp_f32 v11, v11
    v_fma_f32 v12, v12, v218, v218
    v_mfma_f32_32x32x16_bf16 a[0:15], a[124:127], v[148:151], a[0:15]
    ds_read_b64_tr_b16 a[112:113], v236 offset:4736
    ds_read_b64_tr_b16 a[114:115], v236 offset:5888
    buffer_load_dwordx4 a[216:219], v244, s[84:87], s62 offen offset:1024 sc1
    v_exp_f32 v14, v14
    v_mul_f32 v15, v222, v207
    v_cvt_pk_bf16_f32 v24, v8, v9
    v_mul_f32 v10, v10, v210
    v_rcp_f32 v12, v12
    v_mfma_f32_32x32x16_bf16 a[0:15], a[128:131], v[152:155], a[0:15]
    ds_read_b64_tr_b16 a[116:117], v236 offset:9344
    ds_read_b64_tr_b16 a[118:119], v236 offset:10496
    v_fma_f32 v13, v13, v218, v218
    v_exp_f32 v15, v15
    v_mul_f32 v11, v11, v211
    v_rcp_f32 v13, v13
    v_fma_f32 v14, v14, v218, v218
    s_waitcnt lgkmcnt(6)
    v_mfma_f32_32x32x16_bf16 a[0:15], a[96:99], v[156:159], a[0:15]
    ds_read_b64_tr_b16 a[120:121], v236 offset:13952
    ds_read_b64_tr_b16 a[122:123], v236 offset:15104
    buffer_load_dwordx4 a[220:223], v244, s[84:87], s62 offen offset:2048 sc1
    v_cvt_pk_bf16_f32 v25, v10, v11
    v_mul_f32 v12, v12, v212
    v_rcp_f32 v14, v14
    v_fma_f32 v15, v15, v218, v218
    v_mul_f32 v13, v13, v213
    v_mfma_f32_32x32x16_bf16 a[0:15], a[100:103], v[160:163], a[0:15]
    ds_read_b64_tr_b16 a[124:125], v233 offset:128
    ds_read_b64_tr_b16 a[126:127], v233 offset:1280
    v_rcp_f32 v15, v15
    s_nop 0
    v_cvt_pk_bf16_f32 v26, v12, v13
    v_mul_f32 v14, v14, v214
    s_nop 0
    v_mfma_f32_32x32x16_bf16 a[0:15], a[104:107], v[164:167], a[0:15]
    ds_read_b64_tr_b16 a[128:129], v233 offset:4736
    ds_read_b64_tr_b16 a[130:131], v233 offset:5888
    buffer_load_dwordx4 a[224:227], v244, s[84:87], s62 offen offset:3072 sc1
    v_mul_f32 v15, v15, v215
    s_nop 0
    v_cvt_pk_bf16_f32 v27, v14, v15
    s_nop 0
    buffer_store_dwordx4 v[24:27], v237, s[40:43], s56 offen offset:1024 sc1
    s_waitcnt lgkmcnt(6)
    v_mfma_f32_32x32x16_bf16 a[16:31], a[108:111], v[120:123], a[16:31]
    ds_read_b64_tr_b16 a[96:97], v233 offset:9344
    ds_read_b64_tr_b16 a[98:99], v233 offset:10496
    v_mfma_f32_32x32x16_bf16 a[16:31], a[112:115], v[124:127], a[16:31]
    ds_read_b64_tr_b16 a[100:101], v233 offset:13952
    ds_read_b64_tr_b16 a[102:103], v233 offset:15104
    buffer_load_dwordx4 a[228:231], v245, s[84:87], s62 offen offset:0 sc1
    s_add_u32 s62, s62, 20480
    v_mfma_f32_32x32x16_bf16 a[16:31], a[116:119], v[128:131], a[16:31]
    ds_read_b64_tr_b16 a[104:105], v234 offset:128
    ds_read_b64_tr_b16 a[106:107], v234 offset:1280
    v_accvgpr_read_b32 v48, a0
    v_mul_f32 v48, v222, v48
    v_accvgpr_read_b32 v49, a1
    v_exp_f32 v48, v48
    v_mul_f32 v49, v222, v49
    v_accvgpr_read_b32 v50, a2
    s_waitcnt lgkmcnt(6)
    v_mfma_f32_32x32x16_bf16 a[16:31], a[120:123], v[132:135], a[16:31]
    ds_read_b64_tr_b16 a[108:109], v234 offset:4736
    ds_read_b64_tr_b16 a[110:111], v234 offset:5888
    buffer_load_dwordx4 a[232:235], v244, s[84:87], s62 offen offset:0 sc1
    v_accvgpr_read_b32 v56, a8
    v_exp_f32 v49, v49
    v_mul_f32 v50, v222, v50
    v_accvgpr_read_b32 v51, a3
    v_fma_f32 v48, v48, v218, v218
    v_accvgpr_read_b32 v57, a9
    v_exp_f32 v50, v50
    v_mfma_f32_32x32x16_bf16 a[16:31], a[124:127], v[136:139], a[16:31]
    ds_read_b64_tr_b16 a[112:113], v234 offset:9344
    ds_read_b64_tr_b16 a[114:115], v234 offset:10496
    v_mul_f32 v51, v222, v51
    v_accvgpr_read_b32 v52, a4
    v_rcp_f32 v48, v48
    v_fma_f32 v49, v49, v218, v218
    v_accvgpr_read_b32 v58, a10
    v_exp_f32 v51, v51
    v_mfma_f32_32x32x16_bf16 a[16:31], a[128:131], v[140:143], a[16:31]
    ds_read_b64_tr_b16 a[116:117], v234 offset:13952
    ds_read_b64_tr_b16 a[118:119], v234 offset:15104
    buffer_load_dwordx4 a[236:239], v244, s[84:87], s62 offen offset:1024 sc1
    v_mul_f32 v52, v222, v52
    v_accvgpr_read_b32 v53, a5
    v_rcp_f32 v49, v49
    v_fma_f32 v50, v50, v218, v218
    v_accvgpr_read_b32 v59, a11
    v_exp_f32 v52, v52
    v_mul_f32 v53, v222, v53
    s_waitcnt lgkmcnt(6)
    v_mfma_f32_32x32x16_bf16 a[16:31], a[96:99], v[144:147], a[16:31]
    ds_read_b64_tr_b16 a[120:121], v236 offset:160
    ds_read_b64_tr_b16 a[122:123], v236 offset:1312
    v_accvgpr_read_b32 v54, a6
    v_mul_f32 v48, v48, v56
    v_rcp_f32 v50, v50
    v_fma_f32 v51, v51, v218, v218
    v_accvgpr_read_b32 v60, a12
    v_exp_f32 v53, v53
    v_mfma_f32_32x32x16_bf16 a[16:31], a[100:103], v[148:151], a[16:31]
    ds_read_b64_tr_b16 a[124:125], v236 offset:4768
    ds_read_b64_tr_b16 a[126:127], v236 offset:5920
    buffer_load_dwordx4 a[240:243], v244, s[84:87], s62 offen offset:2048 sc1
    v_mul_f32 v54, v222, v54
    v_accvgpr_read_b32 v55, a7
    v_mul_f32 v49, v49, v57
    v_rcp_f32 v51, v51
    v_fma_f32 v52, v52, v218, v218
    v_accvgpr_read_b32 v61, a13
    v_exp_f32 v54, v54
    v_mfma_f32_32x32x16_bf16 a[16:31], a[104:107], v[152:155], a[16:31]
    ds_read_b64_tr_b16 a[128:129], v236 offset:9376
    ds_read_b64_tr_b16 a[130:131], v236 offset:10528
    v_mul_f32 v55, v222, v55
    v_cvt_pk_bf16_f32 v64, v48, v49
    v_mul_f32 v50, v50, v58
    v_rcp_f32 v52, v52
    v_fma_f32 v53, v53, v218, v218
    v_accvgpr_read_b32 v62, a14
    s_waitcnt lgkmcnt(6)
    v_mfma_f32_32x32x16_bf16 a[16:31], a[108:111], v[156:159], a[16:31]
    ds_read_b64_tr_b16 a[96:97], v236 offset:13984
    ds_read_b64_tr_b16 a[98:99], v236 offset:15136
    buffer_load_dwordx4 a[244:247], v244, s[84:87], s62 offen offset:3072 sc1
    v_exp_f32 v55, v55
    v_mul_f32 v51, v51, v59
    v_rcp_f32 v53, v53
    v_fma_f32 v54, v54, v218, v218
    v_accvgpr_read_b32 v63, a15
    v_cvt_pk_bf16_f32 v65, v50, v51
    v_mul_f32 v52, v52, v60
    v_mfma_f32_32x32x16_bf16 a[16:31], a[112:115], v[160:163], a[16:31]
    ds_read_b64_tr_b16 a[100:101], v233 offset:160
    ds_read_b64_tr_b16 a[102:103], v233 offset:1312
    v_rcp_f32 v54, v54
    v_fma_f32 v55, v55, v218, v218
    v_mul_f32 v53, v53, v61
    v_rcp_f32 v55, v55
    s_nop 0
    v_cvt_pk_bf16_f32 v66, v52, v53
    v_mfma_f32_32x32x16_bf16 a[16:31], a[116:119], v[164:167], a[16:31]
    ds_read_b64_tr_b16 a[104:105], v233 offset:4768
    ds_read_b64_tr_b16 a[106:107], v233 offset:5920
    buffer_load_dwordx4 a[248:251], v245, s[84:87], s62 offen offset:0 sc1
    s_add_u32 s62, s62, 20480
    v_mul_f32 v54, v54, v62
    s_nop 0
    v_mul_f32 v55, v55, v63
    s_nop 0
    v_cvt_pk_bf16_f32 v67, v54, v55
    s_nop 0
    buffer_store_dwordx4 v[64:67], v237, s[40:43], s56 offen offset:1536 sc1
    s_waitcnt lgkmcnt(6)
    v_mfma_f32_32x32x16_bf16 a[32:47], a[120:123], v[120:123], a[32:47]
    ds_read_b64_tr_b16 a[108:109], v233 offset:9376
    ds_read_b64_tr_b16 a[110:111], v233 offset:10528
    v_mfma_f32_32x32x16_bf16 a[32:47], a[124:127], v[124:127], a[32:47]
    ds_read_b64_tr_b16 a[112:113], v233 offset:13984
    ds_read_b64_tr_b16 a[114:115], v233 offset:15136
    buffer_load_dwordx4 v[80:83], v244, s[84:87], s62 offen offset:0 sc1
    v_mfma_f32_32x32x16_bf16 a[32:47], a[128:131], v[128:131], a[32:47]
    ds_read_b64_tr_b16 a[116:117], v234 offset:160
    ds_read_b64_tr_b16 a[118:119], v234 offset:1312
    v_accvgpr_read_b32 v8, a16
    v_mul_f32 v8, v222, v8
    v_accvgpr_read_b32 v9, a17
    v_exp_f32 v8, v8
    v_mul_f32 v9, v222, v9
    v_accvgpr_read_b32 v10, a18
    s_waitcnt lgkmcnt(6)
    v_mfma_f32_32x32x16_bf16 a[32:47], a[96:99], v[132:135], a[32:47]
    ds_read_b64_tr_b16 a[120:121], v234 offset:4768
    ds_read_b64_tr_b16 a[122:123], v234 offset:5920
    buffer_load_dwordx4 v[84:87], v244, s[84:87], s62 offen offset:1024 sc1
    v_accvgpr_read_b32 v16, a24
    v_exp_f32 v9, v9
    v_mul_f32 v10, v222, v10
    v_accvgpr_read_b32 v11, a19
    v_fma_f32 v8, v8, v218, v218
    v_accvgpr_read_b32 v17, a25
    v_exp_f32 v10, v10
    v_mfma_f32_32x32x16_bf16 a[32:47], a[100:103], v[136:139], a[32:47]
    ds_read_b64_tr_b16 a[124:125], v234 offset:9376
    ds_read_b64_tr_b16 a[126:127], v234 offset:10528
    v_mul_f32 v11, v222, v11
    v_accvgpr_read_b32 v12, a20
    v_rcp_f32 v8, v8
    v_fma_f32 v9, v9, v218, v218
    v_accvgpr_read_b32 v18, a26
    v_exp_f32 v11, v11
    v_mfma_f32_32x32x16_bf16 a[32:47], a[104:107], v[140:143], a[32:47]
    ds_read_b64_tr_b16 a[128:129], v234 offset:13984
    ds_read_b64_tr_b16 a[130:131], v234 offset:15136
    buffer_load_dwordx4 v[88:91], v244, s[84:87], s62 offen offset:2048 sc1
    v_mul_f32 v12, v222, v12
    v_accvgpr_read_b32 v13, a21
    v_rcp_f32 v9, v9
    v_fma_f32 v10, v10, v218, v218
    v_accvgpr_read_b32 v19, a27
    v_exp_f32 v12, v12
    v_mul_f32 v13, v222, v13
    s_waitcnt lgkmcnt(6)
    v_mfma_f32_32x32x16_bf16 a[32:47], a[108:111], v[144:147], a[32:47]
    ds_read_b64_tr_b16 a[96:97], v236 offset:192
    ds_read_b64_tr_b16 a[98:99], v236 offset:1344
    v_accvgpr_read_b32 v14, a22
    v_mul_f32 v8, v8, v16
    v_rcp_f32 v10, v10
    v_fma_f32 v11, v11, v218, v218
    v_accvgpr_read_b32 v20, a28
    v_exp_f32 v13, v13
    v_mfma_f32_32x32x16_bf16 a[32:47], a[112:115], v[148:151], a[32:47]
    ds_read_b64_tr_b16 a[100:101], v236 offset:4800
    ds_read_b64_tr_b16 a[102:103], v236 offset:5952
    buffer_load_dwordx4 v[92:95], v244, s[84:87], s62 offen offset:3072 sc1
    v_mul_f32 v14, v222, v14
    v_accvgpr_read_b32 v15, a23
    v_mul_f32 v9, v9, v17
    v_rcp_f32 v11, v11
    v_fma_f32 v12, v12, v218, v218
    v_accvgpr_read_b32 v21, a29
    v_exp_f32 v14, v14
    v_mfma_f32_32x32x16_bf16 a[32:47], a[116:119], v[152:155], a[32:47]
    ds_read_b64_tr_b16 a[104:105], v236 offset:9408
    ds_read_b64_tr_b16 a[106:107], v236 offset:10560
    v_mul_f32 v15, v222, v15
    v_cvt_pk_bf16_f32 v24, v8, v9
    v_mul_f32 v10, v10, v18
    v_rcp_f32 v12, v12
    v_fma_f32 v13, v13, v218, v218
    v_accvgpr_read_b32 v22, a30
    s_waitcnt lgkmcnt(6)
    v_mfma_f32_32x32x16_bf16 a[32:47], a[120:123], v[156:159], a[32:47]
    ds_read_b64_tr_b16 a[108:109], v236 offset:14016
    ds_read_b64_tr_b16 a[110:111], v236 offset:15168
    buffer_load_dwordx4 v[96:99], v245, s[84:87], s62 offen offset:0 sc1
    s_add_u32 s62, s62, 20480
    v_exp_f32 v15, v15
    v_mul_f32 v11, v11, v19
    v_rcp_f32 v13, v13
    v_fma_f32 v14, v14, v218, v218
    v_accvgpr_read_b32 v23, a31
    v_cvt_pk_bf16_f32 v25, v10, v11
    v_mul_f32 v12, v12, v20
    v_mfma_f32_32x32x16_bf16 a[32:47], a[124:127], v[160:163], a[32:47]
    ds_read_b64_tr_b16 a[112:113], v233 offset:192
    ds_read_b64_tr_b16 a[114:115], v233 offset:1344
    v_rcp_f32 v14, v14
    v_fma_f32 v15, v15, v218, v218
    v_mul_f32 v13, v13, v21
    v_rcp_f32 v15, v15
    s_nop 0
    v_cvt_pk_bf16_f32 v26, v12, v13
    v_mfma_f32_32x32x16_bf16 a[32:47], a[128:131], v[164:167], a[32:47]
    ds_read_b64_tr_b16 a[116:117], v233 offset:4800
    ds_read_b64_tr_b16 a[118:119], v233 offset:5952
    buffer_load_dwordx4 v[100:103], v244, s[84:87], s62 offen offset:0 sc1
    v_mul_f32 v14, v14, v22
    s_nop 0
    v_mul_f32 v15, v15, v23
    s_nop 0
    v_cvt_pk_bf16_f32 v27, v14, v15
    s_nop 0
    buffer_store_dwordx4 v[24:27], v237, s[40:43], s56 offen offset:2048 sc1
    s_waitcnt lgkmcnt(6)
    v_mfma_f32_32x32x16_bf16 a[48:63], a[96:99], v[120:123], a[48:63]
    ds_read_b64_tr_b16 a[120:121], v233 offset:9408
    ds_read_b64_tr_b16 a[122:123], v233 offset:10560
    v_mfma_f32_32x32x16_bf16 a[48:63], a[100:103], v[124:127], a[48:63]
    ds_read_b64_tr_b16 a[124:125], v233 offset:14016
    ds_read_b64_tr_b16 a[126:127], v233 offset:15168
    buffer_load_dwordx4 v[104:107], v244, s[84:87], s62 offen offset:1024 sc1
    v_mfma_f32_32x32x16_bf16 a[48:63], a[104:107], v[128:131], a[48:63]
    ds_read_b64_tr_b16 a[128:129], v234 offset:192
    ds_read_b64_tr_b16 a[130:131], v234 offset:1344
    v_accvgpr_read_b32 v48, a32
    v_mul_f32 v48, v222, v48
    v_accvgpr_read_b32 v49, a33
    v_exp_f32 v48, v48
    v_mul_f32 v49, v222, v49
    v_accvgpr_read_b32 v50, a34
    s_waitcnt lgkmcnt(6)
    v_mfma_f32_32x32x16_bf16 a[48:63], a[108:111], v[132:135], a[48:63]
    ds_read_b64_tr_b16 a[96:97], v234 offset:4800
    ds_read_b64_tr_b16 a[98:99], v234 offset:5952
    buffer_load_dwordx4 v[108:111], v244, s[84:87], s62 offen offset:2048 sc1
    v_accvgpr_read_b32 v56, a40
    v_exp_f32 v49, v49
    v_mul_f32 v50, v222, v50
    v_accvgpr_read_b32 v51, a35
    v_fma_f32 v48, v48, v218, v218
    v_accvgpr_read_b32 v57, a41
    v_exp_f32 v50, v50
    v_mfma_f32_32x32x16_bf16 a[48:63], a[112:115], v[136:139], a[48:63]
    ds_read_b64_tr_b16 a[100:101], v234 offset:9408
    ds_read_b64_tr_b16 a[102:103], v234 offset:10560
    v_mul_f32 v51, v222, v51
    v_accvgpr_read_b32 v52, a36
    v_rcp_f32 v48, v48
    v_fma_f32 v49, v49, v218, v218
    v_accvgpr_read_b32 v58, a42
    v_exp_f32 v51, v51
    v_mfma_f32_32x32x16_bf16 a[48:63], a[116:119], v[140:143], a[48:63]
    ds_read_b64_tr_b16 a[104:105], v234 offset:14016
    ds_read_b64_tr_b16 a[106:107], v234 offset:15168
    buffer_load_dwordx4 v[112:115], v244, s[84:87], s62 offen offset:3072 sc1
    v_mul_f32 v52, v222, v52
    v_accvgpr_read_b32 v53, a37
    v_rcp_f32 v49, v49
    v_fma_f32 v50, v50, v218, v218
    v_accvgpr_read_b32 v59, a43
    v_exp_f32 v52, v52
    v_mul_f32 v53, v222, v53
    s_waitcnt lgkmcnt(6)
    v_mfma_f32_32x32x16_bf16 a[48:63], a[120:123], v[144:147], a[48:63]
    ds_read_b64_tr_b16 a[108:109], v236 offset:224
    ds_read_b64_tr_b16 a[110:111], v236 offset:1376
    v_accvgpr_read_b32 v54, a38
    v_mul_f32 v48, v48, v56
    v_rcp_f32 v50, v50
    v_fma_f32 v51, v51, v218, v218
    v_accvgpr_read_b32 v60, a44
    v_exp_f32 v53, v53
    v_mfma_f32_32x32x16_bf16 a[48:63], a[124:127], v[148:151], a[48:63]
    ds_read_b64_tr_b16 a[112:113], v236 offset:4832
    ds_read_b64_tr_b16 a[114:115], v236 offset:5984
    buffer_load_dwordx4 v[116:119], v245, s[84:87], s62 offen offset:0 sc1
    s_add_u32 s62, s62, 20480
    v_mul_f32 v54, v222, v54
    v_accvgpr_read_b32 v55, a39
    v_mul_f32 v49, v49, v57
    v_rcp_f32 v51, v51
    v_fma_f32 v52, v52, v218, v218
    v_accvgpr_read_b32 v61, a45
    v_exp_f32 v54, v54
    v_mfma_f32_32x32x16_bf16 a[48:63], a[128:131], v[152:155], a[48:63]
    ds_read_b64_tr_b16 a[116:117], v236 offset:9440
    ds_read_b64_tr_b16 a[118:119], v236 offset:10592
    v_mul_f32 v55, v222, v55
    v_cvt_pk_bf16_f32 v64, v48, v49
    v_mul_f32 v50, v50, v58
    v_rcp_f32 v52, v52
    v_fma_f32 v53, v53, v218, v218
    v_accvgpr_read_b32 v62, a46
    s_waitcnt lgkmcnt(6)
    v_mfma_f32_32x32x16_bf16 a[48:63], a[96:99], v[156:159], a[48:63]
    ds_read_b64_tr_b16 a[120:121], v236 offset:14048
    ds_read_b64_tr_b16 a[122:123], v236 offset:15200
    buffer_load_dwordx4 v[168:171], v244, s[84:87], s62 offen offset:0 sc1
    v_exp_f32 v55, v55
    v_mul_f32 v51, v51, v59
    v_rcp_f32 v53, v53
    v_fma_f32 v54, v54, v218, v218
    v_accvgpr_read_b32 v63, a47
    v_cvt_pk_bf16_f32 v65, v50, v51
    v_mul_f32 v52, v52, v60
    v_mfma_f32_32x32x16_bf16 a[48:63], a[100:103], v[160:163], a[48:63]
    ds_read_b64_tr_b16 a[124:125], v233 offset:224
    ds_read_b64_tr_b16 a[126:127], v233 offset:1376
    v_rcp_f32 v54, v54
    v_fma_f32 v55, v55, v218, v218
    v_mul_f32 v53, v53, v61
    v_rcp_f32 v55, v55
    s_nop 0
    v_cvt_pk_bf16_f32 v66, v52, v53
    v_mfma_f32_32x32x16_bf16 a[48:63], a[104:107], v[164:167], a[48:63]
    ds_read_b64_tr_b16 a[128:129], v233 offset:4832
    ds_read_b64_tr_b16 a[130:131], v233 offset:5984
    buffer_load_dwordx4 v[172:175], v244, s[84:87], s62 offen offset:1024 sc1
    v_mul_f32 v54, v54, v62
    s_nop 0
    v_mul_f32 v55, v55, v63
    s_nop 0
    v_cvt_pk_bf16_f32 v67, v54, v55
    s_nop 0
    buffer_store_dwordx4 v[64:67], v237, s[40:43], s56 offen offset:2560 sc1
    s_waitcnt lgkmcnt(6)
    v_mfma_f32_32x32x16_bf16 a[64:79], a[108:111], v[120:123], a[64:79]
    ds_read_b64_tr_b16 a[96:97], v233 offset:9440
    ds_read_b64_tr_b16 a[98:99], v233 offset:10592
    v_mfma_f32_32x32x16_bf16 a[64:79], a[112:115], v[124:127], a[64:79]
    ds_read_b64_tr_b16 a[100:101], v233 offset:14048
    ds_read_b64_tr_b16 a[102:103], v233 offset:15200
    buffer_load_dwordx4 v[176:179], v244, s[84:87], s62 offen offset:2048 sc1
    v_mfma_f32_32x32x16_bf16 a[64:79], a[116:119], v[128:131], a[64:79]
    ds_read_b64_tr_b16 a[104:105], v234 offset:224
    ds_read_b64_tr_b16 a[106:107], v234 offset:1376
    v_accvgpr_read_b32 v8, a48
    v_mul_f32 v8, v222, v8
    v_accvgpr_read_b32 v9, a49
    v_exp_f32 v8, v8
    v_mul_f32 v9, v222, v9
    v_accvgpr_read_b32 v10, a50
    s_waitcnt lgkmcnt(6)
    v_mfma_f32_32x32x16_bf16 a[64:79], a[120:123], v[132:135], a[64:79]
    ds_read_b64_tr_b16 a[108:109], v234 offset:4832
    ds_read_b64_tr_b16 a[110:111], v234 offset:5984
    buffer_load_dwordx4 v[180:183], v244, s[84:87], s62 offen offset:3072 sc1
    v_accvgpr_read_b32 v16, a56
    v_exp_f32 v9, v9
    v_mul_f32 v10, v222, v10
    v_accvgpr_read_b32 v11, a51
    v_fma_f32 v8, v8, v218, v218
    v_accvgpr_read_b32 v17, a57
    v_exp_f32 v10, v10
    v_mfma_f32_32x32x16_bf16 a[64:79], a[124:127], v[136:139], a[64:79]
    ds_read_b64_tr_b16 a[112:113], v234 offset:9440
    ds_read_b64_tr_b16 a[114:115], v234 offset:10592
    v_mul_f32 v11, v222, v11
    v_accvgpr_read_b32 v12, a52
    v_rcp_f32 v8, v8
    v_fma_f32 v9, v9, v218, v218
    v_accvgpr_read_b32 v18, a58
    v_exp_f32 v11, v11
    v_mfma_f32_32x32x16_bf16 a[64:79], a[128:131], v[140:143], a[64:79]
    ds_read_b64_tr_b16 a[116:117], v234 offset:14048
    ds_read_b64_tr_b16 a[118:119], v234 offset:15200
    buffer_load_dwordx4 v[184:187], v245, s[84:87], s62 offen offset:0 sc1
    s_add_u32 s62, s62, 20480
    v_mul_f32 v12, v222, v12
    v_accvgpr_read_b32 v13, a53
    v_rcp_f32 v9, v9
    v_fma_f32 v10, v10, v218, v218
    v_accvgpr_read_b32 v19, a59
    v_exp_f32 v12, v12
    v_mul_f32 v13, v222, v13
    s_waitcnt lgkmcnt(6)
    v_mfma_f32_32x32x16_bf16 a[64:79], a[96:99], v[144:147], a[64:79]
    ds_read_b64_tr_b16 a[120:121], v236 offset:256
    ds_read_b64_tr_b16 a[122:123], v236 offset:1408
    v_accvgpr_read_b32 v14, a54
    v_mul_f32 v8, v8, v16
    v_rcp_f32 v10, v10
    v_fma_f32 v11, v11, v218, v218
    v_accvgpr_read_b32 v20, a60
    v_exp_f32 v13, v13
    v_mfma_f32_32x32x16_bf16 a[64:79], a[100:103], v[148:151], a[64:79]
    ds_read_b64_tr_b16 a[124:125], v236 offset:4864
    ds_read_b64_tr_b16 a[126:127], v236 offset:6016
    buffer_load_dwordx4 v[188:191], v244, s[84:87], s62 offen offset:0 sc1
    v_mul_f32 v14, v222, v14
    v_accvgpr_read_b32 v15, a55
    v_mul_f32 v9, v9, v17
    v_rcp_f32 v11, v11
    v_fma_f32 v12, v12, v218, v218
    v_accvgpr_read_b32 v21, a61
    v_exp_f32 v14, v14
    v_mfma_f32_32x32x16_bf16 a[64:79], a[104:107], v[152:155], a[64:79]
    ds_read_b64_tr_b16 a[128:129], v236 offset:9472
    ds_read_b64_tr_b16 a[130:131], v236 offset:10624
    v_mul_f32 v15, v222, v15
    v_cvt_pk_bf16_f32 v24, v8, v9
    v_mul_f32 v10, v10, v18
    v_rcp_f32 v12, v12
    v_fma_f32 v13, v13, v218, v218
    v_accvgpr_read_b32 v22, a62
    s_waitcnt lgkmcnt(6)
    v_mfma_f32_32x32x16_bf16 a[64:79], a[108:111], v[156:159], a[64:79]
    ds_read_b64_tr_b16 a[96:97], v236 offset:14080
    ds_read_b64_tr_b16 a[98:99], v236 offset:15232
    buffer_load_dwordx4 v[192:195], v244, s[84:87], s62 offen offset:1024 sc1
    v_exp_f32 v15, v15
    v_mul_f32 v11, v11, v19
    v_rcp_f32 v13, v13
    v_fma_f32 v14, v14, v218, v218
    v_accvgpr_read_b32 v23, a63
    v_cvt_pk_bf16_f32 v25, v10, v11
    v_mul_f32 v12, v12, v20
    v_mfma_f32_32x32x16_bf16 a[64:79], a[112:115], v[160:163], a[64:79]
    ds_read_b64_tr_b16 a[100:101], v233 offset:256
    ds_read_b64_tr_b16 a[102:103], v233 offset:1408
    v_rcp_f32 v14, v14
    v_fma_f32 v15, v15, v218, v218
    v_mul_f32 v13, v13, v21
    v_rcp_f32 v15, v15
    s_nop 0
    v_cvt_pk_bf16_f32 v26, v12, v13
    v_mfma_f32_32x32x16_bf16 a[64:79], a[116:119], v[164:167], a[64:79]
    ds_read_b64_tr_b16 a[104:105], v233 offset:4864
    ds_read_b64_tr_b16 a[106:107], v233 offset:6016
    buffer_load_dwordx4 v[196:199], v244, s[84:87], s62 offen offset:2048 sc1
    v_mul_f32 v14, v14, v22
    s_nop 0
    v_mul_f32 v15, v15, v23
    s_nop 0
    v_cvt_pk_bf16_f32 v27, v14, v15
    s_nop 0
    buffer_store_dwordx4 v[24:27], v237, s[40:43], s56 offen offset:3072 sc1
    s_waitcnt lgkmcnt(6)
    v_mfma_f32_32x32x16_bf16 a[80:95], a[120:123], v[120:123], a[80:95]
    ds_read_b64_tr_b16 a[108:109], v233 offset:9472
    ds_read_b64_tr_b16 a[110:111], v233 offset:10624
    v_mfma_f32_32x32x16_bf16 a[80:95], a[124:127], v[124:127], a[80:95]
    ds_read_b64_tr_b16 a[112:113], v233 offset:14080
    ds_read_b64_tr_b16 a[114:115], v233 offset:15232
    buffer_load_dwordx4 v[200:203], v244, s[84:87], s62 offen offset:3072 sc1
    v_mfma_f32_32x32x16_bf16 a[80:95], a[128:131], v[128:131], a[80:95]
    ds_read_b64_tr_b16 a[116:117], v234 offset:256
    ds_read_b64_tr_b16 a[118:119], v234 offset:1408
    s_nop 3
    v_accvgpr_read_b32 v48, a64
    v_mul_f32 v48, v222, v48
    v_accvgpr_read_b32 v49, a65
    v_exp_f32 v48, v48
    v_mul_f32 v49, v222, v49
    s_waitcnt lgkmcnt(6)
    v_mfma_f32_32x32x16_bf16 a[80:95], a[96:99], v[132:135], a[80:95]
    ds_read_b64_tr_b16 a[120:121], v234 offset:4864
    ds_read_b64_tr_b16 a[122:123], v234 offset:6016
    buffer_load_dwordx4 v[204:207], v245, s[84:87], s62 offen offset:0 sc1
    s_add_u32 s62, s62, 20480
    v_accvgpr_read_b32 v50, a66
    v_accvgpr_read_b32 v56, a72
    v_exp_f32 v49, v49
    v_mul_f32 v50, v222, v50
    v_accvgpr_read_b32 v51, a67
    v_fma_f32 v48, v48, v218, v218
    v_accvgpr_read_b32 v57, a73
    v_mfma_f32_32x32x16_bf16 a[80:95], a[100:103], v[136:139], a[80:95]
    ds_read_b64_tr_b16 a[124:125], v234 offset:9472
    ds_read_b64_tr_b16 a[126:127], v234 offset:10624
    v_exp_f32 v50, v50
    v_mul_f32 v51, v222, v51
    v_accvgpr_read_b32 v52, a68
    v_rcp_f32 v48, v48
    v_fma_f32 v49, v49, v218, v218
    v_accvgpr_read_b32 v58, a74
    v_mfma_f32_32x32x16_bf16 a[80:95], a[104:107], v[140:143], a[80:95]
    ds_read_b64_tr_b16 a[128:129], v234 offset:14080
    ds_read_b64_tr_b16 a[130:131], v234 offset:15232
    v_exp_f32 v51, v51
    v_mul_f32 v52, v222, v52
    v_accvgpr_read_b32 v53, a69
    v_rcp_f32 v49, v49
    v_fma_f32 v50, v50, v218, v218
    v_accvgpr_read_b32 v59, a75
    v_exp_f32 v52, v52
    s_waitcnt lgkmcnt(6)
    v_mfma_f32_32x32x16_bf16 a[80:95], a[108:111], v[144:147], a[80:95]
    v_mul_f32 v53, v222, v53
    v_accvgpr_read_b32 v54, a70
    v_mul_f32 v48, v48, v56
    v_rcp_f32 v50, v50
    v_fma_f32 v51, v51, v218, v218
    v_accvgpr_read_b32 v60, a76
    v_exp_f32 v53, v53
    v_mfma_f32_32x32x16_bf16 a[80:95], a[112:115], v[148:151], a[80:95]
    v_mul_f32 v54, v222, v54
    v_accvgpr_read_b32 v55, a71
    v_mul_f32 v49, v49, v57
    v_rcp_f32 v51, v51
    v_fma_f32 v52, v52, v218, v218
    v_accvgpr_read_b32 v61, a77
    v_mfma_f32_32x32x16_bf16 a[80:95], a[116:119], v[152:155], a[80:95]
    v_exp_f32 v54, v54
    v_mul_f32 v55, v222, v55
    v_cvt_pk_bf16_f32 v64, v48, v49
    v_mul_f32 v50, v50, v58
    v_rcp_f32 v52, v52
    v_fma_f32 v53, v53, v218, v218
    v_accvgpr_read_b32 v62, a78
    s_waitcnt lgkmcnt(0)
    v_mfma_f32_32x32x16_bf16 a[80:95], a[120:123], v[156:159], a[80:95]
    v_exp_f32 v55, v55
    v_mul_f32 v51, v51, v59
    v_rcp_f32 v53, v53
    v_fma_f32 v54, v54, v218, v218
    v_accvgpr_read_b32 v63, a79
    v_cvt_pk_bf16_f32 v65, v50, v51
    v_mfma_f32_32x32x16_bf16 a[80:95], a[124:127], v[160:163], a[80:95]
    v_mul_f32 v52, v52, v60
    v_rcp_f32 v54, v54
    v_fma_f32 v55, v55, v218, v218
    v_mul_f32 v53, v53, v61
    v_rcp_f32 v55, v55
    s_nop 0
    v_cvt_pk_bf16_f32 v66, v52, v53
    v_mfma_f32_32x32x16_bf16 a[80:95], a[128:131], v[164:167], a[80:95]
    v_mul_f32 v54, v54, v62
    s_nop 0
    v_mul_f32 v55, v55, v63
    s_nop 0
    v_cvt_pk_bf16_f32 v67, v54, v55
    s_nop 0
    buffer_store_dwordx4 v[64:67], v237, s[40:43], s56 offen offset:3584 sc1
    s_nop 7
    s_nop 3
    v_accvgpr_read_b32 v8, a80
    v_mul_f32 v8, v222, v8
    v_accvgpr_read_b32 v9, a81
    v_exp_f32 v8, v8
    v_mul_f32 v9, v222, v9
    v_accvgpr_read_b32 v10, a82
    v_accvgpr_read_b32 v16, a88
    v_exp_f32 v9, v9
    v_mul_f32 v10, v222, v10
    v_accvgpr_read_b32 v11, a83
    v_fma_f32 v8, v8, v218, v218
    v_accvgpr_read_b32 v17, a89
    v_exp_f32 v10, v10
    v_mul_f32 v11, v222, v11
    v_accvgpr_read_b32 v12, a84
    v_rcp_f32 v8, v8
    v_fma_f32 v9, v9, v218, v218
    v_accvgpr_read_b32 v18, a90
    v_exp_f32 v11, v11
    v_mul_f32 v12, v222, v12
    v_accvgpr_read_b32 v13, a85
    v_rcp_f32 v9, v9
    v_fma_f32 v10, v10, v218, v218
    v_accvgpr_read_b32 v19, a91
    v_exp_f32 v12, v12
    v_mul_f32 v13, v222, v13
    v_accvgpr_read_b32 v14, a86
    v_mul_f32 v8, v8, v16
    v_rcp_f32 v10, v10
    v_fma_f32 v11, v11, v218, v218
    v_accvgpr_read_b32 v20, a92
    v_exp_f32 v13, v13
    v_mul_f32 v14, v222, v14
    v_accvgpr_read_b32 v15, a87
    v_mul_f32 v9, v9, v17
    v_rcp_f32 v11, v11
    v_fma_f32 v12, v12, v218, v218
    v_accvgpr_read_b32 v21, a93
    v_exp_f32 v14, v14
    v_mul_f32 v15, v222, v15
    v_cvt_pk_bf16_f32 v24, v8, v9
    v_mul_f32 v10, v10, v18
    v_rcp_f32 v12, v12
    v_fma_f32 v13, v13, v218, v218
    v_accvgpr_read_b32 v22, a94
    v_exp_f32 v15, v15
    v_mul_f32 v11, v11, v19
    v_rcp_f32 v13, v13
    v_fma_f32 v14, v14, v218, v218
    v_accvgpr_read_b32 v23, a95
    v_cvt_pk_bf16_f32 v25, v10, v11
    v_mul_f32 v12, v12, v20
    v_rcp_f32 v14, v14
    v_fma_f32 v15, v15, v218, v218
    v_mul_f32 v13, v13, v21
    v_rcp_f32 v15, v15
    s_nop 0
    v_cvt_pk_bf16_f32 v26, v12, v13
    v_mul_f32 v14, v14, v22
    s_nop 0
    v_mul_f32 v15, v15, v23
    s_nop 0
    v_cvt_pk_bf16_f32 v27, v14, v15
    s_nop 0
    buffer_store_dwordx4 v[24:27], v237, s[40:43], s57 offen offset:0 sc1
    s_barrier
    s_mov_b32 s57, s62
    s_mov_b32 s72, s63
    s_add_u32 s32, s28, 16777216
    s_addc_u32 s33, s29, 0
    s_mov_b32 s34, 2211840
    s_mov_b32 s35, 0x20000
    s_add_u32 s68, s28, 12648448
    s_addc_u32 s69, s29, 0
    s_mov_b32 s70, 278528
    s_mov_b32 s71, 0x20000
    s_mul_i32 s58, s3, 40960
    s_cmp_lt_u32 s3, 2
    s_cselect_b32 s61, 0, 0x40000000
    v_mov_b32 v250, s100
    s_and_b32 s94, s2, 7
    s_lshr_b32 s95, s2, 3
    s_lshr_b32 s30, s95, 3
    s_and_b32 s31, s95, 7
    s_lshr_b32 s96, s94, 0
    s_mul_i32 s96, s96, 4
    s_add_u32 s30, s30, s96
    s_and_b32 s96, s94, 0
    s_lshl_b32 s96, s96, 3
    s_add_u32 s31, s31, s96
    s_mul_i32 s56, s31, 160
    s_add_u32 m0, s58, 15360
    s_nop 0
    buffer_load_dwordx4 v244, s[32:35], s57 offen offset:0 sc1 lds
    buffer_load_dwordx4 v244, s[32:35], s57 offen offset:1024 sc1 lds
    buffer_load_dwordx4 v244, s[32:35], s57 offen offset:2048 sc1 lds
    buffer_load_dwordx4 v244, s[32:35], s57 offen offset:3072 sc1 lds
    s_add_u32 m0, s58, 19456
    s_nop 0
    buffer_load_dwordx4 v245, s[32:35], s57 offen offset:0 sc1 lds
    s_add_u32 s57, s57, 20480
    s_waitcnt vmcnt(5)
    buffer_store_dword v250, v249, s[68:71], 0 offen sc1
    s_branch f_join
f_conv:
    s_lshl_b32 s52, s30, 3
    s_lshl_b32 s53, s3, 1
    s_add_u32 s52, s52, s53
    s_add_u32 s52, s52, 768
    s_lshl_b32 s99, s30, 8
    s_add_u32 s99, s99, 262144
    s_mov_b32 s32, s6
    s_mov_b32 s33, s7
    s_mov_b32 s34, 2621440
    s_mov_b32 s35, 0x20000
    s_mov_b32 s36, s8
    s_mov_b32 s37, s9
    s_mov_b32 s38, 2621440
    s_mov_b32 s39, 0x20000
    s_mov_b32 s40, s10
    s_mov_b32 s41, s11
    s_mov_b32 s42, 5120
    s_mov_b32 s43, 0x20000
    s_mul_i32 s48, s52, 52429
    s_lshr_b32 s48, s48, 21
    s_mul_i32 s49, s48, 40
    s_sub_u32 s49, s52, s49
    s_mul_i32 s50, s48, 81920
    s_lshl_b32 s51, s49, 5
    s_add_u32 s50, s50, s51
    v_and_b32 v2, 7, v0
    v_lshrrev_b32 v3, 3, v0
    v_mul_u32_u24 v5, 10240, v3
    v_lshl_add_u32 v5, v2, 3, v5
    v_add_u32 v5, s50, v5
    v_subrev_u32 v6, 3840, v5
    v_lshlrev_b32 v7, 5, v2
    s_lshl_b32 s51, s49, 7
    s_movk_i32 s50, 5120
    buffer_load_dwordx4 v[46:49], v7, s[40:43], s51 offen offset:0
    buffer_load_dwordx4 v[50:53], v7, s[40:43], s51 offen offset:16
    buffer_load_dwordx2 v[8:9], v6, s[32:35], 0 offen offset:0
    buffer_load_dwordx2 v[10:11], v6, s[32:35], 0 offen offset:1280
    buffer_load_dwordx2 v[12:13], v6, s[32:35], 0 offen offset:2560
    buffer_load_dwordx2 v[14:15], v5, s[32:35], 0 offen offset:0
    buffer_load_dwordx2 v[30:31], v5, s[36:39], 0 offen offset:0
    buffer_load_dwordx2 v[16:17], v5, s[32:35], 0 offen offset:1280
    buffer_load_dwordx2 v[32:33], v5, s[36:39], 0 offen offset:1280
    buffer_load_dwordx2 v[18:19], v5, s[32:35], 0 offen offset:2560
    buffer_load_dwordx2 v[34:35], v5, s[36:39], 0 offen offset:2560
    buffer_load_dwordx2 v[20:21], v5, s[32:35], 0 offen offset:3840
    buffer_load_dwordx2 v[36:37], v5, s[36:39], 0 offen offset:3840
    buffer_load_dwordx2 v[22:23], v5, s[32:35], s50 offen offset:0
    buffer_load_dwordx2 v[38:39], v5, s[36:39], s50 offen offset:0
    buffer_load_dwordx2 v[24:25], v5, s[32:35], s50 offen offset:1280
    buffer_load_dwordx2 v[40:41], v5, s[36:39], s50 offen offset:1280
    buffer_load_dwordx2 v[26:27], v5, s[32:35], s50 offen offset:2560
    buffer_load_dwordx2 v[42:43], v5, s[36:39], s50 offen offset:2560
    buffer_load_dwordx2 v[28:29], v5, s[32:35], s50 offen offset:3840
    buffer_load_dwordx2 v[44:45], v5, s[36:39], s50 offen offset:3840
    s_mov_b32 s44, s28
    s_mov_b32 s45, s29
    s_mov_b32 s46, 2621440
    s_mov_b32 s47, 0x20000
    v_lshlrev_b32 v116, 14, v3
    v_lshl_add_u32 v116, v2, 4, v116
    v_sub_u32 v4, 7, v2
    v_lshl_add_u32 v4, v4, 3, v3
    v_lshlrev_b32 v119, 2, v4
    v_lshrrev_b32 v3, 2, v0
    v_add_u32 v3, s49, v3
    v_lshlrev_b32 v4, 4, v3
    v_mul_u32_u24 v5, 6554, v4
    v_lshrrev_b32 v5, 16, v5
    v_and_b32 v6, 3, v0
    v_add_u32 v5, v5, v6
    v_mul_u32_u24 v6, 10, v5
    v_add_u32 v4, 15, v4
    v_cmp_le_u32 vcc, v6, v4
    v_cmp_gt_u32 s[92:93], 8, v0
    v_lshrrev_b32 v6, 4, v6
    v_sub_u32 v3, v3, v6
    s_and_b64 vcc, vcc, s[92:93]
    v_lshlrev_b32 v5, 8, v5
    v_lshl_add_u32 v5, v3, 7, v5
    s_lshl_b32 s51, s48, 2
    v_add_u32 v5, s51, v5
    v_mov_b32 v6, 0x40000000
    v_cndmask_b32 v117, v6, v5, vcc
    s_sub_u32 s50, 31, s48
    s_lshl_b32 s50, s50, 7
    s_lshl_b32 s51, s49, 16
    s_add_u32 s50, s50, s51
    s_mov_b32 s56, s12
    s_mov_b32 s57, s13
    s_mov_b32 s58, 2621440
    s_mov_b32 s59, 0x20000
    s_mul_i32 s60, s30, 10
    s_lshl_b32 s61, s3, 1
    s_add_u32 s61, s60, s61
    s_lshr_b32 s62, s3, 1
    s_add_u32 s62, s62, s60
    s_add_u32 s62, s62, 8
    s_lshl_b32 s63, s61, 12
    s_add_u32 s64, s63, 4096
    s_lshl_b32 s65, s62, 12
    s_load_dwordx2 s[66:67], s[12:13], s63
    s_load_dwordx2 s[68:69], s[12:13], s64
    s_load_dwordx2 s[70:71], s[12:13], s65
    s_lshl_b32 s72, s61, 1
    s_load_dword s73, s[14:15], s72
    s_lshl_b32 s72, s62, 1
    s_and_b32 s72, s72, 0xfffffffc
    s_load_dword s74, s[14:15], s72
    s_mul_i32 s75, s3, 16896
    s_mul_i32 s76, s3, 18432
    s_add_u32 s76, s76, 67584
    v_lshlrev_b32 v232, 4, v0
    s_waitcnt lgkmcnt(0)
    s_mul_i32 s100, s101, 0x9E3779B1
    s_add_u32 s100, s100, 0x7F4A7C15
    s_mov_b32 s51, 0xffff0000
    s_waitcnt vmcnt(0)
    v_lshlrev_b32 v76, 16, v46
    v_lshlrev_b32 v77, 16, v48
    v_and_b32 v78, s51, v46
    v_and_b32 v79, s51, v48
    v_lshlrev_b32 v80, 16, v47
    v_lshlrev_b32 v81, 16, v49
    v_and_b32 v82, s51, v47
    v_and_b32 v83, s51, v49
    v_lshlrev_b32 v54, 16, v8
    v_and_b32 v55, s51, v8
    v_lshlrev_b32 v56, 16, v10
    v_and_b32 v57, s51, v10
    v_lshlrev_b32 v58, 16, v12
    v_and_b32 v59, s51, v12
    v_lshlrev_b32 v60, 16, v14
    v_and_b32 v61, s51, v14
    v_lshlrev_b32 v62, 16, v16
    v_and_b32 v63, s51, v16
    v_lshlrev_b32 v64, 16, v18
    v_and_b32 v65, s51, v18
    v_lshlrev_b32 v66, 16, v20
    v_and_b32 v67, s51, v20
    v_lshlrev_b32 v68, 16, v22
    v_and_b32 v69, s51, v22
    v_lshlrev_b32 v70, 16, v24
    v_and_b32 v71, s51, v24
    v_lshlrev_b32 v72, 16, v26
    v_and_b32 v73, s51, v26
    v_lshlrev_b32 v74, 16, v28
    v_and_b32 v75, s51, v28
    v_pk_mul_f32 v[84:85], v[82:83], v[54:55]
    v_pk_mul_f32 v[86:87], v[82:83], v[56:57]
    v_pk_mul_f32 v[88:89], v[82:83], v[58:59]
    v_pk_mul_f32 v[90:91], v[82:83], v[60:61]
    v_pk_mul_f32 v[92:93], v[82:83], v[62:63]
    v_pk_mul_f32 v[94:95], v[82:83], v[64:65]
    v_pk_mul_f32 v[96:97], v[82:83], v[66:67]
    v_pk_mul_f32 v[98:99], v[82:83], v[68:69]
    v_pk_fma_f32 v[84:85], v[80:81], v[56:57], v[84:85]
    v_pk_fma_f32 v[86:87], v[80:81], v[58:59], v[86:87]
    v_pk_fma_f32 v[88:89], v[80:81], v[60:61], v[88:89]
    v_pk_fma_f32 v[90:91], v[80:81], v[62:63], v[90:91]
    v_pk_fma_f32 v[92:93], v[80:81], v[64:65], v[92:93]
    v_pk_fma_f32 v[94:95], v[80:81], v[66:67], v[94:95]
    v_pk_fma_f32 v[96:97], v[80:81], v[68:69], v[96:97]
    v_pk_fma_f32 v[98:99], v[80:81], v[70:71], v[98:99]
    v_pk_fma_f32 v[84:85], v[78:79], v[58:59], v[84:85]
    v_pk_fma_f32 v[86:87], v[78:79], v[60:61], v[86:87]
    v_pk_fma_f32 v[88:89], v[78:79], v[62:63], v[88:89]
    v_pk_fma_f32 v[90:91], v[78:79], v[64:65], v[90:91]
    v_pk_fma_f32 v[92:93], v[78:79], v[66:67], v[92:93]
    v_pk_fma_f32 v[94:95], v[78:79], v[68:69], v[94:95]
    v_pk_fma_f32 v[96:97], v[78:79], v[70:71], v[96:97]
    v_pk_fma_f32 v[98:99], v[78:79], v[72:73], v[98:99]
    v_pk_fma_f32 v[84:85], v[76:77], v[60:61], v[84:85]
    v_pk_fma_f32 v[86:87], v[76:77], v[62:63], v[86:87]
    v_pk_fma_f32 v[88:89], v[76:77], v[64:65], v[88:89]
    v_pk_fma_f32 v[90:91], v[76:77], v[66:67], v[90:91]
    v_pk_fma_f32 v[92:93], v[76:77], v[68:69], v[92:93]
    v_pk_fma_f32 v[94:95], v[76:77], v[70:71], v[94:95]
    v_pk_fma_f32 v[96:97], v[76:77], v[72:73], v[96:97]
    v_pk_fma_f32 v[98:99], v[76:77], v[74:75], v[98:99]
    v_lshlrev_b32 v54, 16, v30
    v_and_b32 v55, s51, v30
    v_lshlrev_b32 v56, 16, v32
    v_and_b32 v57, s51, v32
    v_lshlrev_b32 v58, 16, v34
    v_and_b32 v59, s51, v34
    v_lshlrev_b32 v60, 16, v36
    v_and_b32 v61, s51, v36
    v_lshlrev_b32 v62, 16, v38
    v_and_b32 v63, s51, v38
    v_lshlrev_b32 v64, 16, v40
    v_and_b32 v65, s51, v40
    v_lshlrev_b32 v66, 16, v42
    v_and_b32 v67, s51, v42
    v_lshlrev_b32 v68, 16, v44
    v_and_b32 v69, s51, v44
    v_pk_mul_f32 v[84:85], v[84:85], v[54:55]
    v_pk_mul_f32 v[86:87], v[86:87], v[56:57]
    v_pk_mul_f32 v[88:89], v[88:89], v[58:59]
    v_pk_mul_f32 v[90:91], v[90:91], v[60:61]
    v_pk_mul_f32 v[92:93], v[92:93], v[62:63]
    v_pk_mul_f32 v[94:95], v[94:95], v[64:65]
    v_pk_mul_f32 v[96:97], v[96:97], v[66:67]
    v_pk_mul_f32 v[98:99], v[98:99], v[68:69]
    v_cvt_pk_bf16_f32 v100, v98, v96
    v_cvt_pk_bf16_f32 v101, v94, v92
    v_cvt_pk_bf16_f32 v102, v90, v88
    v_cvt_pk_bf16_f32 v103, v86, v84
    ds_bpermute_b32 v100, v119, v100
    ds_bpermute_b32 v101, v119, v101
    ds_bpermute_b32 v102, v119, v102
    ds_bpermute_b32 v103, v119, v103
    v_cvt_pk_bf16_f32 v104, v99, v97
    v_cvt_pk_bf16_f32 v105, v95, v93
    v_cvt_pk_bf16_f32 v106, v91, v89
    v_cvt_pk_bf16_f32 v107, v87, v85
    ds_bpermute_b32 v104, v119, v104
    ds_bpermute_b32 v105, v119, v105
    ds_bpermute_b32 v106, v119, v106
    ds_bpermute_b32 v107, v119, v107
    s_waitcnt lgkmcnt(4)
    buffer_store_dwordx4 v[100:103], v116, s[44:47], s50 offen sc1
    s_add_u32 s50, s50, 4096
    s_waitcnt lgkmcnt(0)
    buffer_store_dwordx4 v[104:107], v116, s[44:47], s50 offen sc1
    s_add_u32 s50, s50, 4096
    v_lshlrev_b32 v76, 16, v50
    v_lshlrev_b32 v77, 16, v52
    v_and_b32 v78, s51, v50
    v_and_b32 v79, s51, v52
    v_lshlrev_b32 v80, 16, v51
    v_lshlrev_b32 v81, 16, v53
    v_and_b32 v82, s51, v51
    v_and_b32 v83, s51, v53
    v_lshlrev_b32 v54, 16, v9
    v_and_b32 v55, s51, v9
    v_lshlrev_b32 v56, 16, v11
    v_and_b32 v57, s51, v11
    v_lshlrev_b32 v58, 16, v13
    v_and_b32 v59, s51, v13
    v_lshlrev_b32 v60, 16, v15
    v_and_b32 v61, s51, v15
    v_lshlrev_b32 v62, 16, v17
    v_and_b32 v63, s51, v17
    v_lshlrev_b32 v64, 16, v19
    v_and_b32 v65, s51, v19
    v_lshlrev_b32 v66, 16, v21
    v_and_b32 v67, s51, v21
    v_lshlrev_b32 v68, 16, v23
    v_and_b32 v69, s51, v23
    v_lshlrev_b32 v70, 16, v25
    v_and_b32 v71, s51, v25
    v_lshlrev_b32 v72, 16, v27
    v_and_b32 v73, s51, v27
    v_lshlrev_b32 v74, 16, v29
    v_and_b32 v75, s51, v29
    v_pk_mul_f32 v[84:85], v[82:83], v[54:55]
    v_pk_mul_f32 v[86:87], v[82:83], v[56:57]
    v_pk_mul_f32 v[88:89], v[82:83], v[58:59]
    v_pk_mul_f32 v[90:91], v[82:83], v[60:61]
    v_pk_mul_f32 v[92:93], v[82:83], v[62:63]
    v_pk_mul_f32 v[94:95], v[82:83], v[64:65]
    v_pk_mul_f32 v[96:97], v[82:83], v[66:67]
    v_pk_mul_f32 v[98:99], v[82:83], v[68:69]
    v_pk_fma_f32 v[84:85], v[80:81], v[56:57], v[84:85]
    v_pk_fma_f32 v[86:87], v[80:81], v[58:59], v[86:87]
    v_pk_fma_f32 v[88:89], v[80:81], v[60:61], v[88:89]
    v_pk_fma_f32 v[90:91], v[80:81], v[62:63], v[90:91]
    v_pk_fma_f32 v[92:93], v[80:81], v[64:65], v[92:93]
    v_pk_fma_f32 v[94:95], v[80:81], v[66:67], v[94:95]
    v_pk_fma_f32 v[96:97], v[80:81], v[68:69], v[96:97]
    v_pk_fma_f32 v[98:99], v[80:81], v[70:71], v[98:99]
    v_pk_fma_f32 v[84:85], v[78:79], v[58:59], v[84:85]
    v_pk_fma_f32 v[86:87], v[78:79], v[60:61], v[86:87]
    v_pk_fma_f32 v[88:89], v[78:79], v[62:63], v[88:89]
    v_pk_fma_f32 v[90:91], v[78:79], v[64:65], v[90:91]
    v_pk_fma_f32 v[92:93], v[78:79], v[66:67], v[92:93]
    v_pk_fma_f32 v[94:95], v[78:79], v[68:69], v[94:95]
    v_pk_fma_f32 v[96:97], v[78:79], v[70:71], v[96:97]
    v_pk_fma_f32 v[98:99], v[78:79], v[72:73], v[98:99]
    v_pk_fma_f32 v[84:85], v[76:77], v[60:61], v[84:85]
    v_pk_fma_f32 v[86:87], v[76:77], v[62:63], v[86:87]
    v_pk_fma_f32 v[88:89], v[76:77], v[64:65], v[88:89]
    v_pk_fma_f32 v[90:91], v[76:77], v[66:67], v[90:91]
    v_pk_fma_f32 v[92:93], v[76:77], v[68:69], v[92:93]
    v_pk_fma_f32 v[94:95], v[76:77], v[70:71], v[94:95]
    v_pk_fma_f32 v[96:97], v[76:77], v[72:73], v[96:97]
    v_pk_fma_f32 v[98:99], v[76:77], v[74:75], v[98:99]
    v_lshlrev_b32 v54, 16, v31
    v_and_b32 v55, s51, v31
    v_lshlrev_b32 v56, 16, v33
    v_and_b32 v57, s51, v33
    v_lshlrev_b32 v58, 16, v35
    v_and_b32 v59, s51, v35
    v_lshlrev_b32 v60, 16, v37
    v_and_b32 v61, s51, v37
    v_lshlrev_b32 v62, 16, v39
    v_and_b32 v63, s51, v39
    v_lshlrev_b32 v64, 16, v41
    v_and_b32 v65, s51, v41
    v_lshlrev_b32 v66, 16, v43
    v_and_b32 v67, s51, v43
    v_lshlrev_b32 v68, 16, v45
    v_and_b32 v69, s51, v45
    v_pk_mul_f32 v[84:85], v[84:85], v[54:55]
    v_pk_mul_f32 v[86:87], v[86:87], v[56:57]
    v_pk_mul_f32 v[88:89], v[88:89], v[58:59]
    v_pk_mul_f32 v[90:91], v[90:91], v[60:61]
    v_pk_mul_f32 v[92:93], v[92:93], v[62:63]
    v_pk_mul_f32 v[94:95], v[94:95], v[64:65]
    v_pk_mul_f32 v[96:97], v[96:97], v[66:67]
    v_pk_mul_f32 v[98:99], v[98:99], v[68:69]
    v_cvt_pk_bf16_f32 v108, v98, v96
    v_cvt_pk_bf16_f32 v109, v94, v92
    v_cvt_pk_bf16_f32 v110, v90, v88
    v_cvt_pk_bf16_f32 v111, v86, v84
    ds_bpermute_b32 v108, v119, v108
    ds_bpermute_b32 v109, v119, v109
    ds_bpermute_b32 v110, v119, v110
    ds_bpermute_b32 v111, v119, v111
    v_cvt_pk_bf16_f32 v112, v99, v97
    v_cvt_pk_bf16_f32 v113, v95, v93
    v_cvt_pk_bf16_f32 v114, v91, v89
    v_cvt_pk_bf16_f32 v115, v87, v85
    ds_bpermute_b32 v112, v119, v112
    ds_bpermute_b32 v113, v119, v113
    ds_bpermute_b32 v114, v119, v114
    ds_bpermute_b32 v115, v119, v115
    s_waitcnt lgkmcnt(4)
    buffer_store_dwordx4 v[108:111], v116, s[44:47], s50 offen sc1
    s_add_u32 s50, s50, 4096
    s_waitcnt lgkmcnt(0)
    buffer_store_dwordx4 v[112:115], v116, s[44:47], s50 offen sc1
    s_add_u32 m0, s75, 64
    s_add_u32 s77, s63, 6
    buffer_load_dwordx4 v232, s[56:59], s63 offen offset:0 lds
    buffer_load_dwordx4 v232, s[56:59], s63 offen offset:1024 lds
    buffer_load_dwordx4 v232, s[56:59], s63 offen offset:2048 lds
    buffer_load_dwordx4 v232, s[56:59], s63 offen offset:3072 lds
    s_add_u32 m0, s75, 4288
    s_nop 0
    buffer_load_dwordx4 v232, s[56:59], s77 offen offset:0 lds
    buffer_load_dwordx4 v232, s[56:59], s77 offen offset:1024 lds
    buffer_load_dwordx4 v232, s[56:59], s77 offen offset:2048 lds
    buffer_load_dwordx4 v232, s[56:59], s77 offen offset:3072 lds
    s_add_u32 m0, s75, 8512
    s_add_u32 s77, s64, 6
    buffer_load_dwordx4 v232, s[56:59], s64 offen offset:0 lds
    buffer_load_dwordx4 v232, s[56:59], s64 offen offset:1024 lds
    buffer_load_dwordx4 v232, s[56:59], s64 offen offset:2048 lds
    buffer_load_dwordx4 v232, s[56:59], s64 offen offset:3072 lds
    s_add_u32 m0, s75, 12736
    s_nop 0
    buffer_load_dwordx4 v232, s[56:59], s77 offen offset:0 lds
    buffer_load_dwordx4 v232, s[56:59], s77 offen offset:1024 lds
    buffer_load_dwordx4 v232, s[56:59], s77 offen offset:2048 lds
    buffer_load_dwordx4 v232, s[56:59], s77 offen offset:3072 lds
    s_waitcnt lgkmcnt(0)
    v_mov_b32 v208, 0
    v_mov_b32 v209, 0
    v_mov_b32 v210, 0
    v_mov_b32 v211, 0
    v_and_b32 v233, 3, v0
    v_lshlrev_b32 v233, 4, v233
    v_add_u32 v233, s75, v233
    ds_write_b128 v233, v[208:211] offset:0
    ds_write_b128 v233, v[208:211] offset:4224
    ds_write_b128 v233, v[208:211] offset:8448
    ds_write_b128 v233, v[208:211] offset:12672
    s_lshl_b32 s78, s66, 16
    s_lshr_b32 s79, s66, 16
    s_lshl_b32 s72, s67, 16
    s_or_b32 s79, s79, s72
    v_mov_b32 v234, s78
    v_mov_b32 v235, s79
    v_mov_b32 v215, s75
    ds_write_b64 v215, v[234:235] offset:4280
    s_lshl_b32 s78, s68, 16
    s_lshr_b32 s79, s68, 16
    s_lshl_b32 s72, s69, 16
    s_or_b32 s79, s79, s72
    v_mov_b32 v234, s78
    v_mov_b32 v235, s79
    v_mov_b32 v215, s75
    ds_write_b64 v215, v[234:235] offset:12728
    v_add_u32 v2, 0, v0
    v_mul_u32_u24 v3, 6554, v2
    v_lshrrev_b32 v3, 16, v3
    v_mul_u32_u24 v4, 10, v3
    v_sub_u32 v4, v2, v4
    v_and_b32 v5, 19, v3
    v_bfe_u32 v6, v3, 2, 1
    v_lshl_add_u32 v5, v6, 3, v5
    v_bfe_u32 v6, v3, 3, 1
    v_lshl_add_u32 v5, v6, 2, v5
    v_mul_u32_u24 v5, 1280, v5
    v_lshl_add_u32 v236, v4, 4, v5
    v_add_u32 v2, 64, v0
    v_mul_u32_u24 v3, 6554, v2
    v_lshrrev_b32 v3, 16, v3
    v_mul_u32_u24 v4, 10, v3
    v_sub_u32 v4, v2, v4
    v_and_b32 v5, 19, v3
    v_bfe_u32 v6, v3, 2, 1
    v_lshl_add_u32 v5, v6, 3, v5
    v_bfe_u32 v6, v3, 3, 1
    v_lshl_add_u32 v5, v6, 2, v5
    v_mul_u32_u24 v5, 1280, v5
    v_lshl_add_u32 v237, v4, 4, v5
    v_add_u32 v2, 128, v0
    v_mul_u32_u24 v3, 6554, v2
    v_lshrrev_b32 v3, 16, v3
    v_mul_u32_u24 v4, 10, v3
    v_sub_u32 v4, v2, v4
    v_and_b32 v5, 19, v3
    v_bfe_u32 v6, v3, 2, 1
    v_lshl_add_u32 v5, v6, 3, v5
    v_bfe_u32 v6, v3, 3, 1
    v_lshl_add_u32 v5, v6, 2, v5
    v_mul_u32_u24 v5, 1280, v5
    v_lshl_add_u32 v238, v4, 4, v5
    v_add_u32 v2, 192, v0
    v_mul_u32_u24 v3, 6554, v2
    v_lshrrev_b32 v3, 16, v3
    v_mul_u32_u24 v4, 10, v3
    v_sub_u32 v4, v2, v4
    v_and_b32 v5, 19, v3
    v_bfe_u32 v6, v3, 2, 1
    v_lshl_add_u32 v5, v6, 3, v5
    v_bfe_u32 v6, v3, 3, 1
    v_lshl_add_u32 v5, v6, 2, v5
    v_mul_u32_u24 v5, 1280, v5
    v_lshl_add_u32 v239, v4, 4, v5
    v_add_u32 v2, 256, v0
    v_mul_u32_u24 v3, 6554, v2
    v_lshrrev_b32 v3, 16, v3
    v_mul_u32_u24 v4, 10, v3
    v_sub_u32 v4, v2, v4
    v_and_b32 v5, 19, v3
    v_bfe_u32 v6, v3, 2, 1
    v_lshl_add_u32 v5, v6, 3, v5
    v_bfe_u32 v6, v3, 3, 1
    v_lshl_add_u32 v5, v6, 2, v5
    v_mul_u32_u24 v5, 1280, v5
    v_lshl_add_u32 v240, v4, 4, v5
    v_lshrrev_b32 v2, 4, v0
    v_bfe_u32 v3, v0, 2, 2
    v_and_b32 v4, 3, v0
    v_lshrrev_b32 v5, 1, v2
    v_lshl_add_u32 v5, v5, 4, v3
    v_and_b32 v6, 1, v2
    v_lshl_add_u32 v5, v6, 2, v5
    v_mul_u32_u24 v5, 160, v5
    v_lshl_add_u32 v241, v4, 4, v5
    v_lshl_add_u32 v248, v4, 3, v5
    s_lshr_b32 s52, s30, 3
    s_lshl_b32 s52, s52, 10
    s_and_b32 s53, s30, 7
    s_lshl_b32 s53, s53, 4
    s_add_u32 s52, s52, s53
    s_lshl_b32 s53, s3, 2
    s_add_u32 s52, s52, s53
    s_add_u32 s52, s52, 128
    v_lshlrev_b32 v2, 13, v0
    v_add_u32 v2, s52, v2
    v_mov_b32 v3, 0x40000000
    v_cmp_gt_u32 vcc, 32, v0
    s_nop 0
    v_cndmask_b32 v249, v3, v2, vcc
    s_add_u32 s32, s28, 12910592
    s_addc_u32 s33, s29, 0
    s_mov_b32 s34, 16384
    s_mov_b32 s35, 0x20000
    v_mov_b32 v118, s100
    s_waitcnt vmcnt(16)
    buffer_store_dword v118, v117, s[32:35], 0 offen sc1
    s_lshl_b32 s44, s2, 2
    s_add_u32 s44, s44, s3
    s_mov_b32 s40, s18
    s_mov_b32 s41, s19
    s_mov_b32 s45, s44
    s_sub_u32 s46, s44, 270
    s_cmp_ge_u32 s44, 270
    s_cselect_b32 s40, s20, s40
    s_cselect_b32 s41, s21, s41
    s_cselect_b32 s45, s46, s45
    s_mov_b32 s42, 2211840
    s_mov_b32 s43, 0x20000
    s_lshl_b32 s45, s45, 13
    v_lshlrev_b32 v252, 7, v0
    buffer_load_dword v251, v252, s[40:43], s45 offen
    s_mul_i32 s52, s30, 10
    s_add_u32 s53, s52, 9
    s_xor_b32 s52, s52, s53
    s_lshr_b32 s52, s52, 4
    s_cmp_lg_u32 s52, 0
    s_cselect_b32 s55, -1, 0
    s_mov_b32 s54, -1
    s_lshl_b32 s52, s30, 8
    s_mov_b32 s48, s22
    s_mov_b32 s49, s23
    s_mov_b32 s50, 2211840
    s_mov_b32 s51, 0x20000
    v_lshlrev_b32 v244, 4, v0
    v_add_u32 v245, 4096, v244
    v_lshlrev_b32 v254, 2, v0
    s_add_u32 s36, s28, 16777216
    s_addc_u32 s37, s29, 0
    s_mov_b32 s38, 2211840
    s_mov_b32 s39, 0x20000
    s_add_u32 s40, s28, 12648448
    s_addc_u32 s41, s29, 0
    s_mov_b32 s42, 278528
    s_mov_b32 s43, 0x20000
    s_and_b32 s94, s2, 7
    s_lshr_b32 s95, s2, 3
    s_lshr_b32 s45, s95, 3
    s_and_b32 s44, s95, 7
    s_lshr_b32 s96, s94, 0
    s_mul_i32 s96, s96, 4
    s_add_u32 s45, s45, s96
    s_and_b32 s96, s94, 0
    s_lshl_b32 s96, s96, 3
    s_add_u32 s44, s44, s96
    s_lshl_b32 s45, s45, 3
    s_add_u32 s45, s45, s44
    s_lshl_b32 s45, s45, 10
    s_mul_i32 s44, s44, 276480
    s_mul_i32 s94, s3, 5120
    s_add_u32 s44, s44, s94
    v_min_u32 v233, 27, v0
    v_lshlrev_b32 v233, 4, v233
    v_add_u32 v233, s76, v233
    v_and_b32 v2, 1, v0
    v_bfe_u32 v3, v0, 1, 3
    v_lshrrev_b32 v4, 4, v0
    v_mul_u32_u24 v5, 4216, v2
    v_sub_u32 v5, 4224, v5
    v_lshl_add_u32 v5, v3, 3, v5
    v_lshl_add_u32 v5, v4, 4, v5
    v_add_u32 v212, s75, v5
    v_mul_u32_u24 v5, 4576, v2
    v_sub_u32 v5, 5024, v5
    v_lshlrev_b32 v6, 6, v3
    v_sub_u32 v5, v5, v6
    v_lshl_add_u32 v5, v4, 4, v5
    v_add_u32 v213, s76, v5
    v_lshlrev_b32 v5, 6, v3
    v_lshl_add_u32 v5, v4, 4, v5
    v_lshl_add_u32 v214, v2, 3, v5
    v_lshl_add_u32 v5, v3, 2, v2
    v_lshl_add_u32 v5, v4, 3, v5
    v_sub_u32 v5, 29, v5
    v_mov_b32 v6, 0xffff
    v_mov_b32 v7, 0xffff0000
    v_cmp_eq_u32 vcc, 0, v5
    v_cmp_eq_u32 s[84:85], 1, v5
    s_nop 1
    v_cndmask_b32 v216, 0, v6, vcc
    v_cndmask_b32 v216, v216, v7, s[84:85]
    v_cmp_eq_u32 vcc, 2, v5
    v_cmp_eq_u32 s[84:85], 3, v5
    s_nop 1
    v_cndmask_b32 v217, 0, v6, vcc
    v_cndmask_b32 v217, v217, v7, s[84:85]
    v_cmp_eq_u32 vcc, 4, v5
    v_cmp_eq_u32 s[84:85], 5, v5
    s_nop 1
    v_cndmask_b32 v218, 0, v6, vcc
    v_cndmask_b32 v218, v218, v7, s[84:85]
    v_cmp_eq_u32 vcc, 6, v5
    v_cmp_eq_u32 s[84:85], 7, v5
    s_nop 1
    v_cndmask_b32 v219, 0, v6, vcc
    v_cndmask_b32 v219, v219, v7, s[84:85]
    s_add_u32 s88, s28, 2621440
    s_addc_u32 s89, s29, 0
    s_mov_b32 s90, 2621440
    s_mov_b32 s91, 0x20000
    s_and_b32 s46, s30, 7
    s_lshl_b32 s46, s46, 2
    s_add_u32 s46, s46, s3
    s_lshr_b32 s47, s30, 3
    s_mul_i32 s84, s47, 160
    s_mul_i32 s95, s46, 40960
    s_add_u32 s84, s84, s95
    s_add_u32 s85, s84, 1310720
    s_add_u32 s86, s76, 9216
    s_mul_i32 s87, s3, 5120
    s_add_u32 s87, s87, 141312
    v_add_u32 v242, s86, v241
    v_add_u32 v243, s87, v241
    v_add_u32 v246, s86, v248
    v_add_u32 v247, s87, v248
    s_mul_i32 s47, s47, 54
    s_add_u32 s47, s47, s46
    s_mul_i32 s47, s47, 5120
    s_cmp_lt_u32 s46, 22
    s_cselect_b32 s46, 163840, 0x40000000
    s_add_u32 s46, s46, s47
    s_cmp_lg_u32 s3, 3
    s_cbranch_scc1 f_kok
    s_mov_b32 s53, 30000
poll_5:
    buffer_load_dword v2, v254, s[32:35], s52 offen sc1
    s_waitcnt vmcnt(0)
    v_cmp_ne_u32 vcc, s100, v2
    s_and_b64 vcc, vcc, s[54:55]
    s_cbranch_vccz polld_6
    s_sub_u32 s53, s53, 1
    s_cbranch_scc0 poll_5
polld_6:
f_kok:
    s_barrier
    s_add_u32 s80, s28, s63
    s_addc_u32 s81, s29, 0
    s_movk_i32 s82, 4096
    s_mov_b32 s83, 0x20000
    s_add_u32 m0, s76, 0
    s_nop 0
    buffer_load_dwordx4 v232, s[80:83], 0 offen offset:0  sc1 lds
    buffer_load_dwordx4 v232, s[80:83], 0 offen offset:1024  sc1 lds
    buffer_load_dwordx4 v232, s[80:83], 0 offen offset:2048  sc1 lds
    buffer_load_dwordx4 v232, s[80:83], 0 offen offset:3072  sc1 lds
    s_add_u32 m0, s76, 4576
    s_nop 0
    buffer_load_dwordx4 v232, s[80:83], 4 offen offset:0  sc1 lds
    buffer_load_dwordx4 v232, s[80:83], 4 offen offset:1024  sc1 lds
    buffer_load_dwordx4 v232, s[80:83], 4 offen offset:2048  sc1 lds
    buffer_load_dwordx4 v232, s[80:83], 4 offen offset:3072  sc1 lds
    ds_write_b128 v233, v[208:211] offset:4096
    ds_write_b128 v233, v[208:211] offset:8672
    s_and_b32 s72, s73, 0xffff
    s_mul_i32 s72, s72, 0x10001
    v_and_b32 v220, s72, v216
    v_and_b32 v221, s72, v217
    v_and_b32 v222, s72, v218
    v_and_b32 v223, s72, v219
    s_waitcnt vmcnt(0)
    ds_read_b128 a[32:35], v213 offset:3584
    ds_read_b64 a[0:1], v212 offset:0
    ds_read_b64 a[2:3], v212 offset:8
    ds_read_b128 a[36:39], v213 offset:3072
    ds_read_b64 a[4:5], v212 offset:512
    ds_read_b64 a[6:7], v212 offset:520
    ds_read_b128 a[40:43], v213 offset:2560
    ds_read_b64 a[8:9], v212 offset:1024
    ds_read_b64 a[10:11], v212 offset:1032
    ds_read_b128 a[44:47], v213 offset:2048
    ds_read_b64 a[12:13], v212 offset:1536
    ds_read_b64 a[14:15], v212 offset:1544
    ds_read_b128 a[48:51], v213 offset:1536
    ds_read_b64 a[16:17], v212 offset:2048
    ds_read_b64 a[18:19], v212 offset:2056
    ds_read_b128 a[52:55], v213 offset:1024
    ds_read_b64 a[20:21], v212 offset:2560
    ds_read_b64 a[22:23], v212 offset:2568
    ds_read_b128 a[56:59], v213 offset:512
    ds_read_b64 a[24:25], v212 offset:3072
    ds_read_b64 a[26:27], v212 offset:3080
    ds_read_b128 a[60:63], v213 offset:0
    ds_read_b64 a[28:29], v212 offset:3584
    ds_read_b64 a[30:31], v212 offset:3592
    s_waitcnt lgkmcnt(0)
    v_mfma_f32_16x16x32_bf16 v[8:11], v[220:223], a[32:35], 0
    ds_read_b128 a[96:99], v213 offset:3648
    v_mfma_f32_16x16x32_bf16 v[12:15], v[220:223], a[36:39], 0
    ds_read_b64 a[64:65], v212 offset:64
    v_mfma_f32_16x16x32_bf16 v[16:19], v[220:223], a[40:43], 0
    ds_read_b64 a[66:67], v212 offset:72
    v_mfma_f32_16x16x32_bf16 v[20:23], v[220:223], a[44:47], 0
    ds_read_b128 a[100:103], v213 offset:3136
    v_mfma_f32_16x16x32_bf16 v[24:27], v[220:223], a[48:51], 0
    ds_read_b64 a[68:69], v212 offset:576
    v_mfma_f32_16x16x32_bf16 v[28:31], v[220:223], a[52:55], 0
    ds_read_b64 a[70:71], v212 offset:584
    v_mfma_f32_16x16x32_bf16 v[32:35], v[220:223], a[56:59], 0
    ds_read_b128 a[104:107], v213 offset:2624
    v_mfma_f32_16x16x32_bf16 v[36:39], v[220:223], a[60:63], 0
    ds_read_b64 a[72:73], v212 offset:1088
    v_mfma_f32_16x16x32_bf16 v[8:11], a[0:3], a[32:35], v[8:11]
    ds_read_b64 a[74:75], v212 offset:1096
    v_mfma_f32_16x16x32_bf16 v[12:15], a[0:3], a[36:39], v[12:15]
    ds_read_b128 a[108:111], v213 offset:2112
    v_mfma_f32_16x16x32_bf16 v[16:19], a[0:3], a[40:43], v[16:19]
    ds_read_b64 a[76:77], v212 offset:1600
    v_mfma_f32_16x16x32_bf16 v[20:23], a[0:3], a[44:47], v[20:23]
    ds_read_b64 a[78:79], v212 offset:1608
    v_mfma_f32_16x16x32_bf16 v[24:27], a[0:3], a[48:51], v[24:27]
    ds_read_b128 a[112:115], v213 offset:1600
    v_mfma_f32_16x16x32_bf16 v[28:31], a[0:3], a[52:55], v[28:31]
    ds_read_b64 a[80:81], v212 offset:2112
    v_mfma_f32_16x16x32_bf16 v[32:35], a[0:3], a[56:59], v[32:35]
    ds_read_b64 a[82:83], v212 offset:2120
    v_mfma_f32_16x16x32_bf16 v[36:39], a[0:3], a[60:63], v[36:39]
    ds_read_b128 a[116:119], v213 offset:1088
    v_mfma_f32_16x16x32_bf16 v[12:15], a[4:7], a[32:35], v[12:15]
    ds_read_b64 a[84:85], v212 offset:2624
    v_mfma_f32_16x16x32_bf16 v[16:19], a[4:7], a[36:39], v[16:19]
    ds_read_b64 a[86:87], v212 offset:2632
    v_mfma_f32_16x16x32_bf16 v[20:23], a[4:7], a[40:43], v[20:23]
    ds_read_b128 a[120:123], v213 offset:576
    v_mfma_f32_16x16x32_bf16 v[24:27], a[4:7], a[44:47], v[24:27]
    ds_read_b64 a[88:89], v212 offset:3136
    v_mfma_f32_16x16x32_bf16 v[28:31], a[4:7], a[48:51], v[28:31]
    ds_read_b64 a[90:91], v212 offset:3144
    v_mfma_f32_16x16x32_bf16 v[32:35], a[4:7], a[52:55], v[32:35]
    ds_read_b128 a[124:127], v213 offset:64
    v_mfma_f32_16x16x32_bf16 v[36:39], a[4:7], a[56:59], v[36:39]
    ds_read_b64 a[92:93], v212 offset:3648
    v_mfma_f32_16x16x32_bf16 v[16:19], a[8:11], a[32:35], v[16:19]
    ds_read_b64 a[94:95], v212 offset:3656
    v_mfma_f32_16x16x32_bf16 v[20:23], a[8:11], a[36:39], v[20:23]
    s_add_u32 m0, s86, 0
    v_mfma_f32_16x16x32_bf16 v[24:27], a[8:11], a[40:43], v[24:27]
    s_nop 0
    v_mfma_f32_16x16x32_bf16 v[28:31], a[8:11], a[44:47], v[28:31]
    buffer_load_dwordx4 v236, s[48:51], s84 offen lds
    v_mfma_f32_16x16x32_bf16 v[32:35], a[8:11], a[48:51], v[32:35]
    s_add_u32 m0, s86, 1024
    v_mfma_f32_16x16x32_bf16 v[36:39], a[8:11], a[52:55], v[36:39]
    s_nop 0
    v_mfma_f32_16x16x32_bf16 v[20:23], a[12:15], a[32:35], v[20:23]
    buffer_load_dwordx4 v237, s[48:51], s84 offen lds
    v_mfma_f32_16x16x32_bf16 v[24:27], a[12:15], a[36:39], v[24:27]
    s_add_u32 m0, s86, 2048
    v_mfma_f32_16x16x32_bf16 v[28:31], a[12:15], a[40:43], v[28:31]
    s_nop 0
    v_mfma_f32_16x16x32_bf16 v[32:35], a[12:15], a[44:47], v[32:35]
    buffer_load_dwordx4 v238, s[48:51], s84 offen lds
    v_mfma_f32_16x16x32_bf16 v[36:39], a[12:15], a[48:51], v[36:39]
    s_add_u32 m0, s86, 3072
    v_mfma_f32_16x16x32_bf16 v[24:27], a[16:19], a[32:35], v[24:27]
    s_nop 0
    v_mfma_f32_16x16x32_bf16 v[28:31], a[16:19], a[36:39], v[28:31]
    buffer_load_dwordx4 v239, s[48:51], s84 offen lds
    v_mfma_f32_16x16x32_bf16 v[32:35], a[16:19], a[40:43], v[32:35]
    s_add_u32 m0, s86, 4096
    v_mfma_f32_16x16x32_bf16 v[36:39], a[16:19], a[44:47], v[36:39]
    s_nop 0
    buffer_load_dwordx4 v240, s[48:51], s84 offen lds
    v_mfma_f32_16x16x32_bf16 v[28:31], a[20:23], a[32:35], v[28:31]
    v_mfma_f32_16x16x32_bf16 v[32:35], a[20:23], a[36:39], v[32:35]
    v_mfma_f32_16x16x32_bf16 v[36:39], a[20:23], a[40:43], v[36:39]
    v_mfma_f32_16x16x32_bf16 v[32:35], a[24:27], a[32:35], v[32:35]
    v_mfma_f32_16x16x32_bf16 v[36:39], a[24:27], a[36:39], v[36:39]
    v_mfma_f32_16x16x32_bf16 v[36:39], a[28:31], a[32:35], v[36:39]
    s_waitcnt lgkmcnt(0)
    v_mfma_f32_16x16x32_bf16 v[8:11], a[64:67], a[96:99], v[8:11]
    ds_read_b128 a[32:35], v213 offset:3712
    v_mfma_f32_16x16x32_bf16 v[12:15], a[64:67], a[100:103], v[12:15]
    ds_read_b64 a[0:1], v212 offset:128
    v_mfma_f32_16x16x32_bf16 v[16:19], a[64:67], a[104:107], v[16:19]
    ds_read_b64 a[2:3], v212 offset:136
    v_mfma_f32_16x16x32_bf16 v[20:23], a[64:67], a[108:111], v[20:23]
    ds_read_b128 a[36:39], v213 offset:3200
    ds_read_b64 a[4:5], v212 offset:640
    v_mfma_f32_16x16x32_bf16 v[24:27], a[64:67], a[112:115], v[24:27]
    ds_read_b64 a[6:7], v212 offset:648
    v_mfma_f32_16x16x32_bf16 v[28:31], a[64:67], a[116:119], v[28:31]
    ds_read_b128 a[40:43], v213 offset:2688
    v_mfma_f32_16x16x32_bf16 v[32:35], a[64:67], a[120:123], v[32:35]
    ds_read_b64 a[8:9], v212 offset:1152
    ds_read_b64 a[10:11], v212 offset:1160
    v_mfma_f32_16x16x32_bf16 v[36:39], a[64:67], a[124:127], v[36:39]
    ds_read_b128 a[44:47], v213 offset:2176
    v_mfma_f32_16x16x32_bf16 v[12:15], a[68:71], a[96:99], v[12:15]
    ds_read_b64 a[12:13], v212 offset:1664
    v_mfma_f32_16x16x32_bf16 v[16:19], a[68:71], a[100:103], v[16:19]
    ds_read_b64 a[14:15], v212 offset:1672
    ds_read_b128 a[48:51], v213 offset:1664
    v_mfma_f32_16x16x32_bf16 v[20:23], a[68:71], a[104:107], v[20:23]
    ds_read_b64 a[16:17], v212 offset:2176
    v_mfma_f32_16x16x32_bf16 v[24:27], a[68:71], a[108:111], v[24:27]
    ds_read_b64 a[18:19], v212 offset:2184
    v_mfma_f32_16x16x32_bf16 v[28:31], a[68:71], a[112:115], v[28:31]
    ds_read_b128 a[52:55], v213 offset:1152
    v_mfma_f32_16x16x32_bf16 v[32:35], a[68:71], a[116:119], v[32:35]
    ds_read_b64 a[20:21], v212 offset:2688
    ds_read_b64 a[22:23], v212 offset:2696
    v_mfma_f32_16x16x32_bf16 v[36:39], a[68:71], a[120:123], v[36:39]
    ds_read_b128 a[56:59], v213 offset:640
    v_mfma_f32_16x16x32_bf16 v[16:19], a[72:75], a[96:99], v[16:19]
    ds_read_b64 a[24:25], v212 offset:3200
    v_mfma_f32_16x16x32_bf16 v[20:23], a[72:75], a[100:103], v[20:23]
    ds_read_b64 a[26:27], v212 offset:3208
    ds_read_b128 a[60:63], v213 offset:128
    v_mfma_f32_16x16x32_bf16 v[24:27], a[72:75], a[104:107], v[24:27]
    ds_read_b64 a[28:29], v212 offset:3712
    v_mfma_f32_16x16x32_bf16 v[28:31], a[72:75], a[108:111], v[28:31]
    ds_read_b64 a[30:31], v212 offset:3720
    v_mfma_f32_16x16x32_bf16 v[32:35], a[72:75], a[112:115], v[32:35]
    s_add_u32 m0, s87, 0
    s_nop 0
    v_mfma_f32_16x16x32_bf16 v[36:39], a[72:75], a[116:119], v[36:39]
    buffer_load_dwordx4 v236, s[48:51], s85 offen lds
    v_mfma_f32_16x16x32_bf16 v[20:23], a[76:79], a[96:99], v[20:23]
    s_add_u32 m0, s87, 1024
    v_mfma_f32_16x16x32_bf16 v[24:27], a[76:79], a[100:103], v[24:27]
    s_nop 0
    v_mfma_f32_16x16x32_bf16 v[28:31], a[76:79], a[104:107], v[28:31]
    buffer_load_dwordx4 v237, s[48:51], s85 offen lds
    s_add_u32 m0, s87, 2048
    v_mfma_f32_16x16x32_bf16 v[32:35], a[76:79], a[108:111], v[32:35]
    s_nop 0
    v_mfma_f32_16x16x32_bf16 v[36:39], a[76:79], a[112:115], v[36:39]
    buffer_load_dwordx4 v238, s[48:51], s85 offen lds
    v_mfma_f32_16x16x32_bf16 v[24:27], a[80:83], a[96:99], v[24:27]
    s_add_u32 m0, s87, 3072
    s_nop 0
    v_mfma_f32_16x16x32_bf16 v[28:31], a[80:83], a[100:103], v[28:31]
    buffer_load_dwordx4 v239, s[48:51], s85 offen lds
    v_mfma_f32_16x16x32_bf16 v[32:35], a[80:83], a[104:107], v[32:35]
    s_add_u32 m0, s87, 4096
    v_mfma_f32_16x16x32_bf16 v[36:39], a[80:83], a[108:111], v[36:39]
    s_nop 0
    buffer_load_dwordx4 v240, s[48:51], s85 offen lds
    v_mfma_f32_16x16x32_bf16 v[28:31], a[84:87], a[96:99], v[28:31]
    v_mfma_f32_16x16x32_bf16 v[32:35], a[84:87], a[100:103], v[32:35]
    v_mfma_f32_16x16x32_bf16 v[36:39], a[84:87], a[104:107], v[36:39]
    v_mfma_f32_16x16x32_bf16 v[32:35], a[88:91], a[96:99], v[32:35]
    v_mfma_f32_16x16x32_bf16 v[36:39], a[88:91], a[100:103], v[36:39]
    v_mfma_f32_16x16x32_bf16 v[36:39], a[92:95], a[96:99], v[36:39]
    s_waitcnt lgkmcnt(0)
    v_mfma_f32_16x16x32_bf16 v[8:11], a[0:3], a[32:35], v[8:11]
    ds_read_b128 a[96:99], v213 offset:3776
    v_mfma_f32_16x16x32_bf16 v[12:15], a[0:3], a[36:39], v[12:15]
    ds_read_b64 a[64:65], v212 offset:192
    v_mfma_f32_16x16x32_bf16 v[16:19], a[0:3], a[40:43], v[16:19]
    ds_read_b64 a[66:67], v212 offset:200
    v_mfma_f32_16x16x32_bf16 v[20:23], a[0:3], a[44:47], v[20:23]
    ds_read_b128 a[100:103], v213 offset:3264
    v_mfma_f32_16x16x32_bf16 v[24:27], a[0:3], a[48:51], v[24:27]
    ds_read_b64 a[68:69], v212 offset:704
    v_mfma_f32_16x16x32_bf16 v[28:31], a[0:3], a[52:55], v[28:31]
    ds_read_b64 a[70:71], v212 offset:712
    v_mfma_f32_16x16x32_bf16 v[32:35], a[0:3], a[56:59], v[32:35]
    ds_read_b128 a[104:107], v213 offset:2752
    v_mfma_f32_16x16x32_bf16 v[36:39], a[0:3], a[60:63], v[36:39]
    ds_read_b64 a[72:73], v212 offset:1216
    v_mfma_f32_16x16x32_bf16 v[12:15], a[4:7], a[32:35], v[12:15]
    ds_read_b64 a[74:75], v212 offset:1224
    v_mfma_f32_16x16x32_bf16 v[16:19], a[4:7], a[36:39], v[16:19]
    ds_read_b128 a[108:111], v213 offset:2240
    v_mfma_f32_16x16x32_bf16 v[20:23], a[4:7], a[40:43], v[20:23]
    ds_read_b64 a[76:77], v212 offset:1728
    v_mfma_f32_16x16x32_bf16 v[24:27], a[4:7], a[44:47], v[24:27]
    ds_read_b64 a[78:79], v212 offset:1736
    v_mfma_f32_16x16x32_bf16 v[28:31], a[4:7], a[48:51], v[28:31]
    ds_read_b128 a[112:115], v213 offset:1728
    v_mfma_f32_16x16x32_bf16 v[32:35], a[4:7], a[52:55], v[32:35]
    ds_read_b64 a[80:81], v212 offset:2240
    v_mfma_f32_16x16x32_bf16 v[36:39], a[4:7], a[56:59], v[36:39]
    ds_read_b64 a[82:83], v212 offset:2248
    v_mfma_f32_16x16x32_bf16 v[16:19], a[8:11], a[32:35], v[16:19]
    ds_read_b128 a[116:119], v213 offset:1216
    v_mfma_f32_16x16x32_bf16 v[20:23], a[8:11], a[36:39], v[20:23]
    ds_read_b64 a[84:85], v212 offset:2752
    v_mfma_f32_16x16x32_bf16 v[24:27], a[8:11], a[40:43], v[24:27]
    ds_read_b64 a[86:87], v212 offset:2760
    v_mfma_f32_16x16x32_bf16 v[28:31], a[8:11], a[44:47], v[28:31]
    ds_read_b128 a[120:123], v213 offset:704
    v_mfma_f32_16x16x32_bf16 v[32:35], a[8:11], a[48:51], v[32:35]
    ds_read_b64 a[88:89], v212 offset:3264
    v_mfma_f32_16x16x32_bf16 v[36:39], a[8:11], a[52:55], v[36:39]
    ds_read_b64 a[90:91], v212 offset:3272
    v_mfma_f32_16x16x32_bf16 v[20:23], a[12:15], a[32:35], v[20:23]
    ds_read_b128 a[124:127], v213 offset:192
    v_mfma_f32_16x16x32_bf16 v[24:27], a[12:15], a[36:39], v[24:27]
    ds_read_b64 a[92:93], v212 offset:3776
    v_mfma_f32_16x16x32_bf16 v[28:31], a[12:15], a[40:43], v[28:31]
    ds_read_b64 a[94:95], v212 offset:3784
    v_mfma_f32_16x16x32_bf16 v[32:35], a[12:15], a[44:47], v[32:35]
    v_mfma_f32_16x16x32_bf16 v[36:39], a[12:15], a[48:51], v[36:39]
    v_mfma_f32_16x16x32_bf16 v[24:27], a[16:19], a[32:35], v[24:27]
    v_mfma_f32_16x16x32_bf16 v[28:31], a[16:19], a[36:39], v[28:31]
    v_mfma_f32_16x16x32_bf16 v[32:35], a[16:19], a[40:43], v[32:35]
    v_mfma_f32_16x16x32_bf16 v[36:39], a[16:19], a[44:47], v[36:39]
    v_mfma_f32_16x16x32_bf16 v[28:31], a[20:23], a[32:35], v[28:31]
    v_mfma_f32_16x16x32_bf16 v[32:35], a[20:23], a[36:39], v[32:35]
    v_mfma_f32_16x16x32_bf16 v[36:39], a[20:23], a[40:43], v[36:39]
    v_mfma_f32_16x16x32_bf16 v[32:35], a[24:27], a[32:35], v[32:35]
    v_mfma_f32_16x16x32_bf16 v[36:39], a[24:27], a[36:39], v[36:39]
    v_mfma_f32_16x16x32_bf16 v[36:39], a[28:31], a[32:35], v[36:39]
    s_waitcnt lgkmcnt(0)
    v_mfma_f32_16x16x32_bf16 v[8:11], a[64:67], a[96:99], v[8:11]
    ds_read_b128 a[32:35], v213 offset:3840
    v_mfma_f32_16x16x32_bf16 v[12:15], a[64:67], a[100:103], v[12:15]
    ds_read_b64 a[0:1], v212 offset:256
    v_mfma_f32_16x16x32_bf16 v[16:19], a[64:67], a[104:107], v[16:19]
    ds_read_b64 a[2:3], v212 offset:264
    v_mfma_f32_16x16x32_bf16 v[20:23], a[64:67], a[108:111], v[20:23]
    ds_read_b128 a[36:39], v213 offset:3328
    v_mfma_f32_16x16x32_bf16 v[24:27], a[64:67], a[112:115], v[24:27]
    ds_read_b64 a[4:5], v212 offset:768
    v_mfma_f32_16x16x32_bf16 v[28:31], a[64:67], a[116:119], v[28:31]
    ds_read_b64 a[6:7], v212 offset:776
    ds_read_b128 a[40:43], v213 offset:2816
    v_mfma_f32_16x16x32_bf16 v[32:35], a[64:67], a[120:123], v[32:35]
    ds_read_b64 a[8:9], v212 offset:1280
    v_mfma_f32_16x16x32_bf16 v[36:39], a[64:67], a[124:127], v[36:39]
    ds_read_b64 a[10:11], v212 offset:1288
    v_mfma_f32_16x16x32_bf16 v[12:15], a[68:71], a[96:99], v[12:15]
    ds_read_b128 a[44:47], v213 offset:2304
    v_mfma_f32_16x16x32_bf16 v[16:19], a[68:71], a[100:103], v[16:19]
    ds_read_b64 a[12:13], v212 offset:1792
    v_mfma_f32_16x16x32_bf16 v[20:23], a[68:71], a[104:107], v[20:23]
    ds_read_b64 a[14:15], v212 offset:1800
    v_mfma_f32_16x16x32_bf16 v[24:27], a[68:71], a[108:111], v[24:27]
    ds_read_b128 a[48:51], v213 offset:1792
    ds_read_b64 a[16:17], v212 offset:2304
    v_mfma_f32_16x16x32_bf16 v[28:31], a[68:71], a[112:115], v[28:31]
    ds_read_b64 a[18:19], v212 offset:2312
    v_mfma_f32_16x16x32_bf16 v[32:35], a[68:71], a[116:119], v[32:35]
    ds_read_b128 a[52:55], v213 offset:1280
    v_mfma_f32_16x16x32_bf16 v[36:39], a[68:71], a[120:123], v[36:39]
    ds_read_b64 a[20:21], v212 offset:2816
    v_mfma_f32_16x16x32_bf16 v[16:19], a[72:75], a[96:99], v[16:19]
    ds_read_b64 a[22:23], v212 offset:2824
    v_mfma_f32_16x16x32_bf16 v[20:23], a[72:75], a[100:103], v[20:23]
    ds_read_b128 a[56:59], v213 offset:768
    v_mfma_f32_16x16x32_bf16 v[24:27], a[72:75], a[104:107], v[24:27]
    ds_read_b64 a[24:25], v212 offset:3328
    ds_read_b64 a[26:27], v212 offset:3336
    v_mfma_f32_16x16x32_bf16 v[28:31], a[72:75], a[108:111], v[28:31]
    ds_read_b128 a[60:63], v213 offset:256
    v_mfma_f32_16x16x32_bf16 v[32:35], a[72:75], a[112:115], v[32:35]
    ds_read_b64 a[28:29], v212 offset:3840
    v_mfma_f32_16x16x32_bf16 v[36:39], a[72:75], a[116:119], v[36:39]
    ds_read_b64 a[30:31], v212 offset:3848
    v_mfma_f32_16x16x32_bf16 v[20:23], a[76:79], a[96:99], v[20:23]
    s_waitcnt vmcnt(5)
    v_mfma_f32_16x16x32_bf16 v[24:27], a[76:79], a[100:103], v[24:27]
    ds_read_b64_tr_b16 v[72:73], v242 offset:0
    v_mfma_f32_16x16x32_bf16 v[28:31], a[76:79], a[104:107], v[28:31]
    ds_read_b64_tr_b16 v[74:75], v242 offset:1280
    ds_read_b64_tr_b16 v[76:77], v242 offset:8
    v_mfma_f32_16x16x32_bf16 v[32:35], a[76:79], a[108:111], v[32:35]
    ds_read_b64_tr_b16 v[78:79], v242 offset:1288
    v_mfma_f32_16x16x32_bf16 v[36:39], a[76:79], a[112:115], v[36:39]
    ds_read_b64_tr_b16 v[80:81], v242 offset:64
    v_mfma_f32_16x16x32_bf16 v[24:27], a[80:83], a[96:99], v[24:27]
    ds_read_b64_tr_b16 v[82:83], v242 offset:1344
    v_mfma_f32_16x16x32_bf16 v[28:31], a[80:83], a[100:103], v[28:31]
    ds_read_b64_tr_b16 v[84:85], v242 offset:72
    v_mfma_f32_16x16x32_bf16 v[32:35], a[80:83], a[104:107], v[32:35]
    ds_read_b64_tr_b16 v[86:87], v242 offset:1352
    v_mfma_f32_16x16x32_bf16 v[36:39], a[80:83], a[108:111], v[36:39]
    ds_read_b64_tr_b16 v[88:89], v246 offset:128
    ds_read_b64_tr_b16 v[90:91], v246 offset:1408
    v_mfma_f32_16x16x32_bf16 v[28:31], a[84:87], a[96:99], v[28:31]
    v_mfma_f32_16x16x32_bf16 v[32:35], a[84:87], a[100:103], v[32:35]
    v_mfma_f32_16x16x32_bf16 v[36:39], a[84:87], a[104:107], v[36:39]
    v_mfma_f32_16x16x32_bf16 v[32:35], a[88:91], a[96:99], v[32:35]
    v_mfma_f32_16x16x32_bf16 v[36:39], a[88:91], a[100:103], v[36:39]
    v_mfma_f32_16x16x32_bf16 v[36:39], a[92:95], a[96:99], v[36:39]
    s_waitcnt lgkmcnt(0)
    v_mfma_f32_16x16x32_bf16 v[8:11], a[0:3], a[32:35], v[8:11]
    ds_read_b128 a[96:99], v213 offset:3904
    v_mfma_f32_16x16x32_bf16 v[12:15], a[0:3], a[36:39], v[12:15]
    ds_read_b64 a[64:65], v212 offset:320
    ds_read_b64 a[66:67], v212 offset:328
    v_mfma_f32_16x16x32_bf16 v[16:19], a[0:3], a[40:43], v[16:19]
    ds_read_b128 a[100:103], v213 offset:3392
    ds_read_b64 a[68:69], v212 offset:832
    v_mfma_f32_16x16x32_bf16 v[20:23], a[0:3], a[44:47], v[20:23]
    ds_read_b64 a[70:71], v212 offset:840
    v_mfma_f32_16x16x32_bf16 v[24:27], a[0:3], a[48:51], v[24:27]
    ds_read_b128 a[104:107], v213 offset:2880
    ds_read_b64 a[72:73], v212 offset:1344
    v_mfma_f32_16x16x32_bf16 v[28:31], a[0:3], a[52:55], v[28:31]
    ds_read_b64 a[74:75], v212 offset:1352
    ds_read_b128 a[108:111], v213 offset:2368
    v_mfma_f32_16x16x32_bf16 v[32:35], a[0:3], a[56:59], v[32:35]
    ds_read_b64 a[76:77], v212 offset:1856
    v_mfma_f32_16x16x32_bf16 v[36:39], a[0:3], a[60:63], v[36:39]
    ds_read_b64 a[78:79], v212 offset:1864
    ds_read_b128 a[112:115], v213 offset:1856
    v_mfma_f32_16x16x32_bf16 v[12:15], a[4:7], a[32:35], v[12:15]
    ds_read_b64 a[80:81], v212 offset:2368
    ds_read_b64 a[82:83], v212 offset:2376
    v_mfma_f32_16x16x32_bf16 v[16:19], a[4:7], a[36:39], v[16:19]
    ds_read_b128 a[116:119], v213 offset:1344
    v_mfma_f32_16x16x32_bf16 v[20:23], a[4:7], a[40:43], v[20:23]
    ds_read_b64 a[84:85], v212 offset:2880
    ds_read_b64 a[86:87], v212 offset:2888
    v_mfma_f32_16x16x32_bf16 v[24:27], a[4:7], a[44:47], v[24:27]
    ds_read_b128 a[120:123], v213 offset:832
    ds_read_b64 a[88:89], v212 offset:3392
    v_mfma_f32_16x16x32_bf16 v[28:31], a[4:7], a[48:51], v[28:31]
    ds_read_b64 a[90:91], v212 offset:3400
    v_mfma_f32_16x16x32_bf16 v[32:35], a[4:7], a[52:55], v[32:35]
    ds_read_b128 a[124:127], v213 offset:320
    ds_read_b64 a[92:93], v212 offset:3904
    v_mfma_f32_16x16x32_bf16 v[36:39], a[4:7], a[56:59], v[36:39]
    ds_read_b64 a[94:95], v212 offset:3912
    buffer_store_dwordx4 v[72:75], v244, s[36:39], s47 offen offset:0 sc1
    v_mfma_f32_16x16x32_bf16 v[16:19], a[8:11], a[32:35], v[16:19]
    buffer_store_dwordx4 v[76:79], v244, s[36:39], s47 offen offset:1024 sc1
    v_mfma_f32_16x16x32_bf16 v[20:23], a[8:11], a[36:39], v[20:23]
    buffer_store_dwordx4 v[80:83], v244, s[36:39], s47 offen offset:2048 sc1
    buffer_store_dwordx4 v[84:87], v244, s[36:39], s47 offen offset:3072 sc1
    v_mfma_f32_16x16x32_bf16 v[24:27], a[8:11], a[40:43], v[24:27]
    buffer_store_dwordx4 v[88:91], v245, s[36:39], s47 offen offset:0 sc1
    s_add_u32 s80, s28, s64
    v_mfma_f32_16x16x32_bf16 v[28:31], a[8:11], a[44:47], v[28:31]
    s_addc_u32 s81, s29, 0
    v_mfma_f32_16x16x32_bf16 v[32:35], a[8:11], a[48:51], v[32:35]
    s_movk_i32 s82, 4096
    s_mov_b32 s83, 0x20000
    v_mfma_f32_16x16x32_bf16 v[36:39], a[8:11], a[52:55], v[36:39]
    s_add_u32 m0, s76, 9216
    s_nop 0
    v_mfma_f32_16x16x32_bf16 v[20:23], a[12:15], a[32:35], v[20:23]
    buffer_load_dwordx4 v232, s[80:83], 0 offen offset:0  sc1 lds
    v_mfma_f32_16x16x32_bf16 v[24:27], a[12:15], a[36:39], v[24:27]
    buffer_load_dwordx4 v232, s[80:83], 0 offen offset:1024  sc1 lds
    buffer_load_dwordx4 v232, s[80:83], 0 offen offset:2048  sc1 lds
    v_mfma_f32_16x16x32_bf16 v[28:31], a[12:15], a[40:43], v[28:31]
    buffer_load_dwordx4 v232, s[80:83], 0 offen offset:3072  sc1 lds
    s_waitcnt vmcnt(9)
    v_mfma_f32_16x16x32_bf16 v[32:35], a[12:15], a[44:47], v[32:35]
    ds_read_b64_tr_b16 v[92:93], v243 offset:0
    v_mfma_f32_16x16x32_bf16 v[36:39], a[12:15], a[48:51], v[36:39]
    ds_read_b64_tr_b16 v[94:95], v243 offset:1280
    ds_read_b64_tr_b16 v[96:97], v243 offset:8
    v_mfma_f32_16x16x32_bf16 v[24:27], a[16:19], a[32:35], v[24:27]
    ds_read_b64_tr_b16 v[98:99], v243 offset:1288
    ds_read_b64_tr_b16 v[100:101], v243 offset:64
    v_mfma_f32_16x16x32_bf16 v[28:31], a[16:19], a[36:39], v[28:31]
    ds_read_b64_tr_b16 v[102:103], v243 offset:1344
    v_mfma_f32_16x16x32_bf16 v[32:35], a[16:19], a[40:43], v[32:35]
    ds_read_b64_tr_b16 v[104:105], v243 offset:72
    ds_read_b64_tr_b16 v[106:107], v243 offset:1352
    v_mfma_f32_16x16x32_bf16 v[36:39], a[16:19], a[44:47], v[36:39]
    ds_read_b64_tr_b16 v[108:109], v247 offset:128
    ds_read_b64_tr_b16 v[110:111], v247 offset:1408
    v_mfma_f32_16x16x32_bf16 v[28:31], a[20:23], a[32:35], v[28:31]
    v_mfma_f32_16x16x32_bf16 v[32:35], a[20:23], a[36:39], v[32:35]
    v_mfma_f32_16x16x32_bf16 v[36:39], a[20:23], a[40:43], v[36:39]
    v_mfma_f32_16x16x32_bf16 v[32:35], a[24:27], a[32:35], v[32:35]
    v_mfma_f32_16x16x32_bf16 v[36:39], a[24:27], a[36:39], v[36:39]
    v_mfma_f32_16x16x32_bf16 v[36:39], a[28:31], a[32:35], v[36:39]
    s_waitcnt lgkmcnt(0)
    v_mfma_f32_16x16x32_bf16 v[8:11], a[64:67], a[96:99], v[8:11]
    ds_read_b128 a[32:35], v213 offset:3968
    v_mfma_f32_16x16x32_bf16 v[12:15], a[64:67], a[100:103], v[12:15]
    ds_read_b64 a[0:1], v212 offset:384
    v_mfma_f32_16x16x32_bf16 v[16:19], a[64:67], a[104:107], v[16:19]
    ds_read_b64 a[2:3], v212 offset:392
    v_mfma_f32_16x16x32_bf16 v[20:23], a[64:67], a[108:111], v[20:23]
    ds_read_b128 a[36:39], v213 offset:3456
    v_mfma_f32_16x16x32_bf16 v[24:27], a[64:67], a[112:115], v[24:27]
    ds_read_b64 a[4:5], v212 offset:896
    ds_read_b64 a[6:7], v212 offset:904
    v_mfma_f32_16x16x32_bf16 v[28:31], a[64:67], a[116:119], v[28:31]
    ds_read_b128 a[40:43], v213 offset:2944
    v_mfma_f32_16x16x32_bf16 v[32:35], a[64:67], a[120:123], v[32:35]
    ds_read_b64 a[8:9], v212 offset:1408
    v_mfma_f32_16x16x32_bf16 v[36:39], a[64:67], a[124:127], v[36:39]
    ds_read_b64 a[10:11], v212 offset:1416
    v_mfma_f32_16x16x32_bf16 v[12:15], a[68:71], a[96:99], v[12:15]
    ds_read_b128 a[44:47], v213 offset:2432
    ds_read_b64 a[12:13], v212 offset:1920
    v_mfma_f32_16x16x32_bf16 v[16:19], a[68:71], a[100:103], v[16:19]
    ds_read_b64 a[14:15], v212 offset:1928
    v_mfma_f32_16x16x32_bf16 v[20:23], a[68:71], a[104:107], v[20:23]
    ds_read_b128 a[48:51], v213 offset:1920
    v_mfma_f32_16x16x32_bf16 v[24:27], a[68:71], a[108:111], v[24:27]
    ds_read_b64 a[16:17], v212 offset:2432
    v_mfma_f32_16x16x32_bf16 v[28:31], a[68:71], a[112:115], v[28:31]
    ds_read_b64 a[18:19], v212 offset:2440
    ds_read_b128 a[52:55], v213 offset:1408
    v_mfma_f32_16x16x32_bf16 v[32:35], a[68:71], a[116:119], v[32:35]
    ds_read_b64 a[20:21], v212 offset:2944
    v_mfma_f32_16x16x32_bf16 v[36:39], a[68:71], a[120:123], v[36:39]
    ds_read_b64 a[22:23], v212 offset:2952
    v_mfma_f32_16x16x32_bf16 v[16:19], a[72:75], a[96:99], v[16:19]
    ds_read_b128 a[56:59], v213 offset:896
    v_mfma_f32_16x16x32_bf16 v[20:23], a[72:75], a[100:103], v[20:23]
    ds_read_b64 a[24:25], v212 offset:3456
    v_mfma_f32_16x16x32_bf16 v[24:27], a[72:75], a[104:107], v[24:27]
    ds_read_b64 a[26:27], v212 offset:3464
    ds_read_b128 a[60:63], v213 offset:384
    v_mfma_f32_16x16x32_bf16 v[28:31], a[72:75], a[108:111], v[28:31]
    ds_read_b64 a[28:29], v212 offset:3968
    v_mfma_f32_16x16x32_bf16 v[32:35], a[72:75], a[112:115], v[32:35]
    ds_read_b64 a[30:31], v212 offset:3976
    v_mfma_f32_16x16x32_bf16 v[36:39], a[72:75], a[116:119], v[36:39]
    s_add_u32 m0, s76, 13792
    v_mfma_f32_16x16x32_bf16 v[20:23], a[76:79], a[96:99], v[20:23]
    s_nop 0
    buffer_load_dwordx4 v232, s[80:83], 4 offen offset:0  sc1 lds
    v_mfma_f32_16x16x32_bf16 v[24:27], a[76:79], a[100:103], v[24:27]
    buffer_load_dwordx4 v232, s[80:83], 4 offen offset:1024  sc1 lds
    v_mfma_f32_16x16x32_bf16 v[28:31], a[76:79], a[104:107], v[28:31]
    buffer_load_dwordx4 v232, s[80:83], 4 offen offset:2048  sc1 lds
    v_mfma_f32_16x16x32_bf16 v[32:35], a[76:79], a[108:111], v[32:35]
    buffer_load_dwordx4 v232, s[80:83], 4 offen offset:3072  sc1 lds
    v_mfma_f32_16x16x32_bf16 v[36:39], a[76:79], a[112:115], v[36:39]
    ds_write_b128 v233, v[208:211] offset:13312
    ds_write_b128 v233, v[208:211] offset:17888
    v_mfma_f32_16x16x32_bf16 v[24:27], a[80:83], a[96:99], v[24:27]
    buffer_store_dwordx4 v[92:95], v244, s[36:39], s46 offen offset:0 sc1
    v_mfma_f32_16x16x32_bf16 v[28:31], a[80:83], a[100:103], v[28:31]
    buffer_store_dwordx4 v[96:99], v244, s[36:39], s46 offen offset:1024 sc1
    v_mfma_f32_16x16x32_bf16 v[32:35], a[80:83], a[104:107], v[32:35]
    buffer_store_dwordx4 v[100:103], v244, s[36:39], s46 offen offset:2048 sc1
    v_mfma_f32_16x16x32_bf16 v[36:39], a[80:83], a[108:111], v[36:39]
    buffer_store_dwordx4 v[104:107], v244, s[36:39], s46 offen offset:3072 sc1
    buffer_store_dwordx4 v[108:111], v245, s[36:39], s46 offen offset:0 sc1
    v_mfma_f32_16x16x32_bf16 v[28:31], a[84:87], a[96:99], v[28:31]
    v_mfma_f32_16x16x32_bf16 v[32:35], a[84:87], a[100:103], v[32:35]
    v_mfma_f32_16x16x32_bf16 v[36:39], a[84:87], a[104:107], v[36:39]
    v_mfma_f32_16x16x32_bf16 v[32:35], a[88:91], a[96:99], v[32:35]
    v_mfma_f32_16x16x32_bf16 v[36:39], a[88:91], a[100:103], v[36:39]
    v_mfma_f32_16x16x32_bf16 v[36:39], a[92:95], a[96:99], v[36:39]
    s_waitcnt lgkmcnt(0)
    v_mfma_f32_16x16x32_bf16 v[8:11], a[0:3], a[32:35], v[8:11]
    ds_read_b128 a[96:99], v213 offset:4032
    v_mfma_f32_16x16x32_bf16 v[12:15], a[0:3], a[36:39], v[12:15]
    ds_read_b64 a[64:65], v212 offset:448
    v_mfma_f32_16x16x32_bf16 v[16:19], a[0:3], a[40:43], v[16:19]
    ds_read_b64 a[66:67], v212 offset:456
    v_mfma_f32_16x16x32_bf16 v[20:23], a[0:3], a[44:47], v[20:23]
    ds_read_b128 a[100:103], v213 offset:3520
    v_mfma_f32_16x16x32_bf16 v[24:27], a[0:3], a[48:51], v[24:27]
    ds_read_b64 a[68:69], v212 offset:960
    v_mfma_f32_16x16x32_bf16 v[28:31], a[0:3], a[52:55], v[28:31]
    ds_read_b64 a[70:71], v212 offset:968
    v_mfma_f32_16x16x32_bf16 v[32:35], a[0:3], a[56:59], v[32:35]
    ds_read_b128 a[104:107], v213 offset:3008
    v_mfma_f32_16x16x32_bf16 v[36:39], a[0:3], a[60:63], v[36:39]
    ds_read_b64 a[72:73], v212 offset:1472
    v_mfma_f32_16x16x32_bf16 v[12:15], a[4:7], a[32:35], v[12:15]
    ds_read_b64 a[74:75], v212 offset:1480
    v_mfma_f32_16x16x32_bf16 v[16:19], a[4:7], a[36:39], v[16:19]
    ds_read_b128 a[108:111], v213 offset:2496
    v_mfma_f32_16x16x32_bf16 v[20:23], a[4:7], a[40:43], v[20:23]
    ds_read_b64 a[76:77], v212 offset:1984
    v_mfma_f32_16x16x32_bf16 v[24:27], a[4:7], a[44:47], v[24:27]
    ds_read_b64 a[78:79], v212 offset:1992
    v_mfma_f32_16x16x32_bf16 v[28:31], a[4:7], a[48:51], v[28:31]
    ds_read_b128 a[112:115], v213 offset:1984
    v_mfma_f32_16x16x32_bf16 v[32:35], a[4:7], a[52:55], v[32:35]
    ds_read_b64 a[80:81], v212 offset:2496
    v_mfma_f32_16x16x32_bf16 v[36:39], a[4:7], a[56:59], v[36:39]
    ds_read_b64 a[82:83], v212 offset:2504
    v_mfma_f32_16x16x32_bf16 v[16:19], a[8:11], a[32:35], v[16:19]
    ds_read_b128 a[116:119], v213 offset:1472
    v_mfma_f32_16x16x32_bf16 v[20:23], a[8:11], a[36:39], v[20:23]
    ds_read_b64 a[84:85], v212 offset:3008
    v_mfma_f32_16x16x32_bf16 v[24:27], a[8:11], a[40:43], v[24:27]
    ds_read_b64 a[86:87], v212 offset:3016
    v_mfma_f32_16x16x32_bf16 v[28:31], a[8:11], a[44:47], v[28:31]
    ds_read_b128 a[120:123], v213 offset:960
    v_mfma_f32_16x16x32_bf16 v[32:35], a[8:11], a[48:51], v[32:35]
    ds_read_b64 a[88:89], v212 offset:3520
    v_mfma_f32_16x16x32_bf16 v[36:39], a[8:11], a[52:55], v[36:39]
    ds_read_b64 a[90:91], v212 offset:3528
    v_mfma_f32_16x16x32_bf16 v[20:23], a[12:15], a[32:35], v[20:23]
    ds_read_b128 a[124:127], v213 offset:448
    v_mfma_f32_16x16x32_bf16 v[24:27], a[12:15], a[36:39], v[24:27]
    ds_read_b64 a[92:93], v212 offset:4032
    v_mfma_f32_16x16x32_bf16 v[28:31], a[12:15], a[40:43], v[28:31]
    ds_read_b64 a[94:95], v212 offset:4040
    v_mfma_f32_16x16x32_bf16 v[32:35], a[12:15], a[44:47], v[32:35]
    v_mfma_f32_16x16x32_bf16 v[36:39], a[12:15], a[48:51], v[36:39]
    v_mfma_f32_16x16x32_bf16 v[24:27], a[16:19], a[32:35], v[24:27]
    v_mfma_f32_16x16x32_bf16 v[28:31], a[16:19], a[36:39], v[28:31]
    v_mfma_f32_16x16x32_bf16 v[32:35], a[16:19], a[40:43], v[32:35]
    v_mfma_f32_16x16x32_bf16 v[36:39], a[16:19], a[44:47], v[36:39]
    v_mfma_f32_16x16x32_bf16 v[28:31], a[20:23], a[32:35], v[28:31]
    v_mfma_f32_16x16x32_bf16 v[32:35], a[20:23], a[36:39], v[32:35]
    v_mfma_f32_16x16x32_bf16 v[36:39], a[20:23], a[40:43], v[36:39]
    v_mfma_f32_16x16x32_bf16 v[32:35], a[24:27], a[32:35], v[32:35]
    v_mfma_f32_16x16x32_bf16 v[36:39], a[24:27], a[36:39], v[36:39]
    v_mfma_f32_16x16x32_bf16 v[36:39], a[28:31], a[32:35], v[36:39]
    s_waitcnt lgkmcnt(0)
    v_mfma_f32_16x16x32_bf16 v[8:11], a[64:67], a[96:99], v[8:11]
    s_waitcnt vmcnt(5)
    v_mfma_f32_16x16x32_bf16 v[12:15], a[64:67], a[100:103], v[12:15]
    ds_read_b128 a[32:35], v213 offset:12800
    v_mfma_f32_16x16x32_bf16 v[16:19], a[64:67], a[104:107], v[16:19]
    ds_read_b64 a[0:1], v212 offset:8448
    ds_read_b64 a[2:3], v212 offset:8456
    v_mfma_f32_16x16x32_bf16 v[20:23], a[64:67], a[108:111], v[20:23]
    ds_read_b128 a[36:39], v213 offset:12288
    v_mfma_f32_16x16x32_bf16 v[24:27], a[64:67], a[112:115], v[24:27]
    ds_read_b64 a[4:5], v212 offset:8960
    v_mfma_f32_16x16x32_bf16 v[28:31], a[64:67], a[116:119], v[28:31]
    ds_read_b64 a[6:7], v212 offset:8968
    ds_read_b128 a[40:43], v213 offset:11776
    v_mfma_f32_16x16x32_bf16 v[32:35], a[64:67], a[120:123], v[32:35]
    ds_read_b64 a[8:9], v212 offset:9472
    v_mfma_f32_16x16x32_bf16 v[36:39], a[64:67], a[124:127], v[36:39]
    ds_read_b64 a[10:11], v212 offset:9480
    v_mfma_f32_16x16x32_bf16 v[12:15], a[68:71], a[96:99], v[12:15]
    ds_read_b128 a[44:47], v213 offset:11264
    ds_read_b64 a[12:13], v212 offset:9984
    v_mfma_f32_16x16x32_bf16 v[16:19], a[68:71], a[100:103], v[16:19]
    ds_read_b64 a[14:15], v212 offset:9992
    v_mfma_f32_16x16x32_bf16 v[20:23], a[68:71], a[104:107], v[20:23]
    ds_read_b128 a[48:51], v213 offset:10752
    v_mfma_f32_16x16x32_bf16 v[24:27], a[68:71], a[108:111], v[24:27]
    ds_read_b64 a[16:17], v212 offset:10496
    ds_read_b64 a[18:19], v212 offset:10504
    v_mfma_f32_16x16x32_bf16 v[28:31], a[68:71], a[112:115], v[28:31]
    ds_read_b128 a[52:55], v213 offset:10240
    v_mfma_f32_16x16x32_bf16 v[32:35], a[68:71], a[116:119], v[32:35]
    ds_read_b64 a[20:21], v212 offset:11008
    v_mfma_f32_16x16x32_bf16 v[36:39], a[68:71], a[120:123], v[36:39]
    ds_read_b64 a[22:23], v212 offset:11016
    ds_read_b128 a[56:59], v213 offset:9728
    v_mfma_f32_16x16x32_bf16 v[16:19], a[72:75], a[96:99], v[16:19]
    ds_read_b64 a[24:25], v212 offset:11520
    v_mfma_f32_16x16x32_bf16 v[20:23], a[72:75], a[100:103], v[20:23]
    ds_read_b64 a[26:27], v212 offset:11528
    v_mfma_f32_16x16x32_bf16 v[24:27], a[72:75], a[104:107], v[24:27]
    ds_read_b128 a[60:63], v213 offset:9216
    ds_read_b64 a[28:29], v212 offset:12032
    v_mfma_f32_16x16x32_bf16 v[28:31], a[72:75], a[108:111], v[28:31]
    ds_read_b64 a[30:31], v212 offset:12040
    v_mfma_f32_16x16x32_bf16 v[32:35], a[72:75], a[112:115], v[32:35]
    s_lshr_b32 s72, s73, 16
    v_mfma_f32_16x16x32_bf16 v[36:39], a[72:75], a[116:119], v[36:39]
    s_mul_i32 s72, s72, 0x10001
    v_and_b32 v220, s72, v216
    v_mfma_f32_16x16x32_bf16 v[20:23], a[76:79], a[96:99], v[20:23]
    v_and_b32 v221, s72, v217
    v_mfma_f32_16x16x32_bf16 v[24:27], a[76:79], a[100:103], v[24:27]
    v_and_b32 v222, s72, v218
    v_mfma_f32_16x16x32_bf16 v[28:31], a[76:79], a[104:107], v[28:31]
    v_and_b32 v223, s72, v219
    v_mov_b32 v250, s100
    v_mfma_f32_16x16x32_bf16 v[32:35], a[76:79], a[108:111], v[32:35]
    s_waitcnt vmcnt(0)
    v_mfma_f32_16x16x32_bf16 v[36:39], a[76:79], a[112:115], v[36:39]
    buffer_store_dword v250, v249, s[40:43], 0 offen offset:128 sc1
    v_mfma_f32_16x16x32_bf16 v[24:27], a[80:83], a[96:99], v[24:27]
    s_add_u32 m0, s75, 64
    s_add_u32 s77, s65, 6
    v_mfma_f32_16x16x32_bf16 v[28:31], a[80:83], a[100:103], v[28:31]
    buffer_load_dwordx4 v232, s[56:59], s65 offen offset:0 lds
    v_mfma_f32_16x16x32_bf16 v[32:35], a[80:83], a[104:107], v[32:35]
    buffer_load_dwordx4 v232, s[56:59], s65 offen offset:1024 lds
    v_mfma_f32_16x16x32_bf16 v[36:39], a[80:83], a[108:111], v[36:39]
    buffer_load_dwordx4 v232, s[56:59], s65 offen offset:2048 lds
    buffer_load_dwordx4 v232, s[56:59], s65 offen offset:3072 lds
    v_mfma_f32_16x16x32_bf16 v[28:31], a[84:87], a[96:99], v[28:31]
    v_mfma_f32_16x16x32_bf16 v[32:35], a[84:87], a[100:103], v[32:35]
    v_mfma_f32_16x16x32_bf16 v[36:39], a[84:87], a[104:107], v[36:39]
    v_mfma_f32_16x16x32_bf16 v[32:35], a[88:91], a[96:99], v[32:35]
    v_mfma_f32_16x16x32_bf16 v[36:39], a[88:91], a[100:103], v[36:39]
    v_mfma_f32_16x16x32_bf16 v[36:39], a[92:95], a[96:99], v[36:39]
    s_lshr_b32 s72, s3, 1
    s_lshl_b32 s72, s72, 4
    s_lshr_b32 s74, s74, s72
    s_waitcnt lgkmcnt(0)
    v_mfma_f32_16x16x32_bf16 v[40:43], v[220:223], a[32:35], 0
    ds_read_b128 a[96:99], v213 offset:12864
    v_mfma_f32_16x16x32_bf16 v[44:47], v[220:223], a[36:39], 0
    ds_read_b64 a[64:65], v212 offset:8512
    v_mfma_f32_16x16x32_bf16 v[48:51], v[220:223], a[40:43], 0
    ds_read_b64 a[66:67], v212 offset:8520
    v_mfma_f32_16x16x32_bf16 v[52:55], v[220:223], a[44:47], 0
    ds_read_b128 a[100:103], v213 offset:12352
    v_mfma_f32_16x16x32_bf16 v[56:59], v[220:223], a[48:51], 0
    ds_read_b64 a[68:69], v212 offset:9024
    v_mfma_f32_16x16x32_bf16 v[60:63], v[220:223], a[52:55], 0
    ds_read_b64 a[70:71], v212 offset:9032
    v_mfma_f32_16x16x32_bf16 v[64:67], v[220:223], a[56:59], 0
    ds_read_b128 a[104:107], v213 offset:11840
    v_mfma_f32_16x16x32_bf16 v[68:71], v[220:223], a[60:63], 0
    ds_read_b64 a[72:73], v212 offset:9536
    v_mfma_f32_16x16x32_bf16 v[40:43], a[0:3], a[32:35], v[40:43]
    ds_read_b64 a[74:75], v212 offset:9544
    v_mfma_f32_16x16x32_bf16 v[44:47], a[0:3], a[36:39], v[44:47]
    ds_read_b128 a[108:111], v213 offset:11328
    v_mfma_f32_16x16x32_bf16 v[48:51], a[0:3], a[40:43], v[48:51]
    ds_read_b64 a[76:77], v212 offset:10048
    v_mfma_f32_16x16x32_bf16 v[52:55], a[0:3], a[44:47], v[52:55]
    ds_read_b64 a[78:79], v212 offset:10056
    v_mfma_f32_16x16x32_bf16 v[56:59], a[0:3], a[48:51], v[56:59]
    ds_read_b128 a[112:115], v213 offset:10816
    v_mfma_f32_16x16x32_bf16 v[60:63], a[0:3], a[52:55], v[60:63]
    ds_read_b64 a[80:81], v212 offset:10560
    v_mfma_f32_16x16x32_bf16 v[64:67], a[0:3], a[56:59], v[64:67]
    ds_read_b64 a[82:83], v212 offset:10568
    v_mfma_f32_16x16x32_bf16 v[68:71], a[0:3], a[60:63], v[68:71]
    ds_read_b128 a[116:119], v213 offset:10304
    v_mfma_f32_16x16x32_bf16 v[44:47], a[4:7], a[32:35], v[44:47]
    ds_read_b64 a[84:85], v212 offset:11072
    v_mfma_f32_16x16x32_bf16 v[48:51], a[4:7], a[36:39], v[48:51]
    ds_read_b64 a[86:87], v212 offset:11080
    v_mfma_f32_16x16x32_bf16 v[52:55], a[4:7], a[40:43], v[52:55]
    ds_read_b128 a[120:123], v213 offset:9792
    v_mfma_f32_16x16x32_bf16 v[56:59], a[4:7], a[44:47], v[56:59]
    ds_read_b64 a[88:89], v212 offset:11584
    v_mfma_f32_16x16x32_bf16 v[60:63], a[4:7], a[48:51], v[60:63]
    ds_read_b64 a[90:91], v212 offset:11592
    v_mfma_f32_16x16x32_bf16 v[64:67], a[4:7], a[52:55], v[64:67]
    ds_read_b128 a[124:127], v213 offset:9280
    v_mfma_f32_16x16x32_bf16 v[68:71], a[4:7], a[56:59], v[68:71]
    ds_read_b64 a[92:93], v212 offset:12096
    v_mfma_f32_16x16x32_bf16 v[48:51], a[8:11], a[32:35], v[48:51]
    ds_read_b64 a[94:95], v212 offset:12104
    v_mfma_f32_16x16x32_bf16 v[52:55], a[8:11], a[36:39], v[52:55]
    s_add_u32 m0, s75, 4288
    v_mfma_f32_16x16x32_bf16 v[56:59], a[8:11], a[40:43], v[56:59]
    s_nop 0
    v_mfma_f32_16x16x32_bf16 v[60:63], a[8:11], a[44:47], v[60:63]
    buffer_load_dwordx4 v232, s[56:59], s77 offen offset:0 lds
    v_mfma_f32_16x16x32_bf16 v[64:67], a[8:11], a[48:51], v[64:67]
    buffer_load_dwordx4 v232, s[56:59], s77 offen offset:1024 lds
    v_mfma_f32_16x16x32_bf16 v[68:71], a[8:11], a[52:55], v[68:71]
    buffer_load_dwordx4 v232, s[56:59], s77 offen offset:2048 lds
    v_mfma_f32_16x16x32_bf16 v[52:55], a[12:15], a[32:35], v[52:55]
    buffer_load_dwordx4 v232, s[56:59], s77 offen offset:3072 lds
    v_mfma_f32_16x16x32_bf16 v[56:59], a[12:15], a[36:39], v[56:59]
    s_lshl_b32 s78, s70, 16
    v_mfma_f32_16x16x32_bf16 v[60:63], a[12:15], a[40:43], v[60:63]
    s_lshr_b32 s79, s70, 16
    v_mfma_f32_16x16x32_bf16 v[64:67], a[12:15], a[44:47], v[64:67]
    s_lshl_b32 s72, s71, 16
    v_mfma_f32_16x16x32_bf16 v[68:71], a[12:15], a[48:51], v[68:71]
    s_or_b32 s79, s79, s72
    v_mfma_f32_16x16x32_bf16 v[56:59], a[16:19], a[32:35], v[56:59]
    v_mov_b32 v234, s78
    v_mfma_f32_16x16x32_bf16 v[60:63], a[16:19], a[36:39], v[60:63]
    v_mov_b32 v235, s79
    v_mfma_f32_16x16x32_bf16 v[64:67], a[16:19], a[40:43], v[64:67]
    v_mov_b32 v215, s75
    v_mfma_f32_16x16x32_bf16 v[68:71], a[16:19], a[44:47], v[68:71]
    ds_write_b64 v215, v[234:235] offset:4280
    v_mfma_f32_16x16x32_bf16 v[60:63], a[20:23], a[32:35], v[60:63]
    v_mfma_f32_16x16x32_bf16 v[64:67], a[20:23], a[36:39], v[64:67]
    v_mfma_f32_16x16x32_bf16 v[68:71], a[20:23], a[40:43], v[68:71]
    v_mfma_f32_16x16x32_bf16 v[64:67], a[24:27], a[32:35], v[64:67]
    v_mfma_f32_16x16x32_bf16 v[68:71], a[24:27], a[36:39], v[68:71]
    v_mfma_f32_16x16x32_bf16 v[68:71], a[28:31], a[32:35], v[68:71]
    s_waitcnt lgkmcnt(0)
    v_mfma_f32_16x16x32_bf16 v[40:43], a[64:67], a[96:99], v[40:43]
    ds_read_b128 a[32:35], v213 offset:12928
    v_mfma_f32_16x16x32_bf16 v[44:47], a[64:67], a[100:103], v[44:47]
    ds_read_b64 a[0:1], v212 offset:8576
    ds_read_b64 a[2:3], v212 offset:8584
    v_mfma_f32_16x16x32_bf16 v[48:51], a[64:67], a[104:107], v[48:51]
    ds_read_b128 a[36:39], v213 offset:12416
    ds_read_b64 a[4:5], v212 offset:9088
    v_mfma_f32_16x16x32_bf16 v[52:55], a[64:67], a[108:111], v[52:55]
    ds_read_b64 a[6:7], v212 offset:9096
    ds_read_b128 a[40:43], v213 offset:11904
    v_mfma_f32_16x16x32_bf16 v[56:59], a[64:67], a[112:115], v[56:59]
    ds_read_b64 a[8:9], v212 offset:9600
    ds_read_b64 a[10:11], v212 offset:9608
    v_mfma_f32_16x16x32_bf16 v[60:63], a[64:67], a[116:119], v[60:63]
    ds_read_b128 a[44:47], v213 offset:11392
    ds_read_b64 a[12:13], v212 offset:10112
    v_mfma_f32_16x16x32_bf16 v[64:67], a[64:67], a[120:123], v[64:67]
    ds_read_b64 a[14:15], v212 offset:10120
    ds_read_b128 a[48:51], v213 offset:10880
    v_mfma_f32_16x16x32_bf16 v[68:71], a[64:67], a[124:127], v[68:71]
    ds_read_b64 a[16:17], v212 offset:10624
    ds_read_b64 a[18:19], v212 offset:10632
    v_mfma_f32_16x16x32_bf16 v[44:47], a[68:71], a[96:99], v[44:47]
    ds_read_b128 a[52:55], v213 offset:10368
    ds_read_b64 a[20:21], v212 offset:11136
    v_mfma_f32_16x16x32_bf16 v[48:51], a[68:71], a[100:103], v[48:51]
    ds_read_b64 a[22:23], v212 offset:11144
    ds_read_b128 a[56:59], v213 offset:9856
    v_mfma_f32_16x16x32_bf16 v[52:55], a[68:71], a[104:107], v[52:55]
    ds_read_b64 a[24:25], v212 offset:11648
    ds_read_b64 a[26:27], v212 offset:11656
    v_mfma_f32_16x16x32_bf16 v[56:59], a[68:71], a[108:111], v[56:59]
    ds_read_b128 a[60:63], v213 offset:9344
    ds_read_b64 a[28:29], v212 offset:12160
    v_mfma_f32_16x16x32_bf16 v[60:63], a[68:71], a[112:115], v[60:63]
    ds_read_b64 a[30:31], v212 offset:12168
    v_cvt_pk_bf16_f32 v224, v8, v9
    v_mfma_f32_16x16x32_bf16 v[64:67], a[68:71], a[116:119], v[64:67]
    v_cvt_pk_bf16_f32 v225, v10, v11
    buffer_store_dwordx2 v[224:225], v214, s[88:91], s63 offen offset:0 sc1
    v_mfma_f32_16x16x32_bf16 v[68:71], a[68:71], a[120:123], v[68:71]
    v_cvt_pk_bf16_f32 v226, v12, v13
    v_cvt_pk_bf16_f32 v227, v14, v15
    v_mfma_f32_16x16x32_bf16 v[48:51], a[72:75], a[96:99], v[48:51]
    buffer_store_dwordx2 v[226:227], v214, s[88:91], s63 offen offset:512 sc1
    v_mfma_f32_16x16x32_bf16 v[52:55], a[72:75], a[100:103], v[52:55]
    v_cvt_pk_bf16_f32 v228, v16, v17
    v_cvt_pk_bf16_f32 v229, v18, v19
    v_mfma_f32_16x16x32_bf16 v[56:59], a[72:75], a[104:107], v[56:59]
    buffer_store_dwordx2 v[228:229], v214, s[88:91], s63 offen offset:1024 sc1
    v_cvt_pk_bf16_f32 v230, v20, v21
    v_mfma_f32_16x16x32_bf16 v[60:63], a[72:75], a[108:111], v[60:63]
    v_cvt_pk_bf16_f32 v231, v22, v23
    buffer_store_dwordx2 v[230:231], v214, s[88:91], s63 offen offset:1536 sc1
    v_mfma_f32_16x16x32_bf16 v[64:67], a[72:75], a[112:115], v[64:67]
    v_cvt_pk_bf16_f32 v224, v24, v25
    v_cvt_pk_bf16_f32 v225, v26, v27
    v_mfma_f32_16x16x32_bf16 v[68:71], a[72:75], a[116:119], v[68:71]
    buffer_store_dwordx2 v[224:225], v214, s[88:91], s63 offen offset:2048 sc1
    v_cvt_pk_bf16_f32 v226, v28, v29
    v_mfma_f32_16x16x32_bf16 v[52:55], a[76:79], a[96:99], v[52:55]
    v_cvt_pk_bf16_f32 v227, v30, v31
    buffer_store_dwordx2 v[226:227], v214, s[88:91], s63 offen offset:2560 sc1
    v_mfma_f32_16x16x32_bf16 v[56:59], a[76:79], a[100:103], v[56:59]
    v_cvt_pk_bf16_f32 v228, v32, v33
    v_cvt_pk_bf16_f32 v229, v34, v35
    v_mfma_f32_16x16x32_bf16 v[60:63], a[76:79], a[104:107], v[60:63]
    buffer_store_dwordx2 v[228:229], v214, s[88:91], s63 offen offset:3072 sc1
    v_cvt_pk_bf16_f32 v230, v36, v37
    v_mfma_f32_16x16x32_bf16 v[64:67], a[76:79], a[108:111], v[64:67]
    v_cvt_pk_bf16_f32 v231, v38, v39
    buffer_store_dwordx2 v[230:231], v214, s[88:91], s63 offen offset:3584 sc1
    v_mfma_f32_16x16x32_bf16 v[68:71], a[76:79], a[112:115], v[68:71]
    s_add_u32 s80, s28, s65
    s_addc_u32 s81, s29, 0
    v_mfma_f32_16x16x32_bf16 v[56:59], a[80:83], a[96:99], v[56:59]
    s_movk_i32 s82, 4096
    s_mov_b32 s83, 0x20000
    v_mfma_f32_16x16x32_bf16 v[60:63], a[80:83], a[100:103], v[60:63]
    s_add_u32 m0, s76, 0
    s_nop 0
    v_mfma_f32_16x16x32_bf16 v[64:67], a[80:83], a[104:107], v[64:67]
    buffer_load_dwordx4 v232, s[80:83], 0 offen offset:0  sc1 lds
    buffer_load_dwordx4 v232, s[80:83], 0 offen offset:1024  sc1 lds
    v_mfma_f32_16x16x32_bf16 v[68:71], a[80:83], a[108:111], v[68:71]
    buffer_load_dwordx4 v232, s[80:83], 0 offen offset:2048  sc1 lds
    buffer_load_dwordx4 v232, s[80:83], 0 offen offset:3072  sc1 lds
    v_mfma_f32_16x16x32_bf16 v[60:63], a[84:87], a[96:99], v[60:63]
    v_mfma_f32_16x16x32_bf16 v[64:67], a[84:87], a[100:103], v[64:67]
    v_mfma_f32_16x16x32_bf16 v[68:71], a[84:87], a[104:107], v[68:71]
    v_mfma_f32_16x16x32_bf16 v[64:67], a[88:91], a[96:99], v[64:67]
    v_mfma_f32_16x16x32_bf16 v[68:71], a[88:91], a[100:103], v[68:71]
    v_mfma_f32_16x16x32_bf16 v[68:71], a[92:95], a[96:99], v[68:71]
    s_waitcnt lgkmcnt(0)
    v_mfma_f32_16x16x32_bf16 v[40:43], a[0:3], a[32:35], v[40:43]
    ds_read_b128 a[96:99], v213 offset:12992
    v_mfma_f32_16x16x32_bf16 v[44:47], a[0:3], a[36:39], v[44:47]
    ds_read_b64 a[64:65], v212 offset:8640
    v_mfma_f32_16x16x32_bf16 v[48:51], a[0:3], a[40:43], v[48:51]
    ds_read_b64 a[66:67], v212 offset:8648
    v_mfma_f32_16x16x32_bf16 v[52:55], a[0:3], a[44:47], v[52:55]
    ds_read_b128 a[100:103], v213 offset:12480
    v_mfma_f32_16x16x32_bf16 v[56:59], a[0:3], a[48:51], v[56:59]
    ds_read_b64 a[68:69], v212 offset:9152
    v_mfma_f32_16x16x32_bf16 v[60:63], a[0:3], a[52:55], v[60:63]
    ds_read_b64 a[70:71], v212 offset:9160
    v_mfma_f32_16x16x32_bf16 v[64:67], a[0:3], a[56:59], v[64:67]
    ds_read_b128 a[104:107], v213 offset:11968
    v_mfma_f32_16x16x32_bf16 v[68:71], a[0:3], a[60:63], v[68:71]
    ds_read_b64 a[72:73], v212 offset:9664
    v_mfma_f32_16x16x32_bf16 v[44:47], a[4:7], a[32:35], v[44:47]
    ds_read_b64 a[74:75], v212 offset:9672
    v_mfma_f32_16x16x32_bf16 v[48:51], a[4:7], a[36:39], v[48:51]
    ds_read_b128 a[108:111], v213 offset:11456
    v_mfma_f32_16x16x32_bf16 v[52:55], a[4:7], a[40:43], v[52:55]
    ds_read_b64 a[76:77], v212 offset:10176
    v_mfma_f32_16x16x32_bf16 v[56:59], a[4:7], a[44:47], v[56:59]
    ds_read_b64 a[78:79], v212 offset:10184
    v_mfma_f32_16x16x32_bf16 v[60:63], a[4:7], a[48:51], v[60:63]
    ds_read_b128 a[112:115], v213 offset:10944
    v_mfma_f32_16x16x32_bf16 v[64:67], a[4:7], a[52:55], v[64:67]
    ds_read_b64 a[80:81], v212 offset:10688
    v_mfma_f32_16x16x32_bf16 v[68:71], a[4:7], a[56:59], v[68:71]
    ds_read_b64 a[82:83], v212 offset:10696
    v_mfma_f32_16x16x32_bf16 v[48:51], a[8:11], a[32:35], v[48:51]
    ds_read_b128 a[116:119], v213 offset:10432
    v_mfma_f32_16x16x32_bf16 v[52:55], a[8:11], a[36:39], v[52:55]
    ds_read_b64 a[84:85], v212 offset:11200
    v_mfma_f32_16x16x32_bf16 v[56:59], a[8:11], a[40:43], v[56:59]
    ds_read_b64 a[86:87], v212 offset:11208
    v_mfma_f32_16x16x32_bf16 v[60:63], a[8:11], a[44:47], v[60:63]
    ds_read_b128 a[120:123], v213 offset:9920
    v_mfma_f32_16x16x32_bf16 v[64:67], a[8:11], a[48:51], v[64:67]
    ds_read_b64 a[88:89], v212 offset:11712
    v_mfma_f32_16x16x32_bf16 v[68:71], a[8:11], a[52:55], v[68:71]
    ds_read_b64 a[90:91], v212 offset:11720
    v_mfma_f32_16x16x32_bf16 v[52:55], a[12:15], a[32:35], v[52:55]
    ds_read_b128 a[124:127], v213 offset:9408
    v_mfma_f32_16x16x32_bf16 v[56:59], a[12:15], a[36:39], v[56:59]
    ds_read_b64 a[92:93], v212 offset:12224
    v_mfma_f32_16x16x32_bf16 v[60:63], a[12:15], a[40:43], v[60:63]
    ds_read_b64 a[94:95], v212 offset:12232
    v_mfma_f32_16x16x32_bf16 v[64:67], a[12:15], a[44:47], v[64:67]
    s_add_u32 m0, s76, 4576
    v_mfma_f32_16x16x32_bf16 v[68:71], a[12:15], a[48:51], v[68:71]
    s_nop 0
    v_mfma_f32_16x16x32_bf16 v[56:59], a[16:19], a[32:35], v[56:59]
    buffer_load_dwordx4 v232, s[80:83], 4 offen offset:0  sc1 lds
    v_mfma_f32_16x16x32_bf16 v[60:63], a[16:19], a[36:39], v[60:63]
    buffer_load_dwordx4 v232, s[80:83], 4 offen offset:1024  sc1 lds
    v_mfma_f32_16x16x32_bf16 v[64:67], a[16:19], a[40:43], v[64:67]
    buffer_load_dwordx4 v232, s[80:83], 4 offen offset:2048  sc1 lds
    v_mfma_f32_16x16x32_bf16 v[68:71], a[16:19], a[44:47], v[68:71]
    buffer_load_dwordx4 v232, s[80:83], 4 offen offset:3072  sc1 lds
    buffer_load_dword v251, v254, s[40:43], s45 offen offset:256 sc1
    v_mfma_f32_16x16x32_bf16 v[60:63], a[20:23], a[32:35], v[60:63]
    v_mfma_f32_16x16x32_bf16 v[64:67], a[20:23], a[36:39], v[64:67]
    v_mfma_f32_16x16x32_bf16 v[68:71], a[20:23], a[40:43], v[68:71]
    v_mfma_f32_16x16x32_bf16 v[64:67], a[24:27], a[32:35], v[64:67]
    v_mfma_f32_16x16x32_bf16 v[68:71], a[24:27], a[36:39], v[68:71]
    v_mfma_f32_16x16x32_bf16 v[68:71], a[28:31], a[32:35], v[68:71]
    s_waitcnt lgkmcnt(0)
    v_mfma_f32_16x16x32_bf16 v[40:43], a[64:67], a[96:99], v[40:43]
    ds_read_b128 a[32:35], v213 offset:13056
    v_mfma_f32_16x16x32_bf16 v[44:47], a[64:67], a[100:103], v[44:47]
    ds_read_b64 a[0:1], v212 offset:8704
    v_mfma_f32_16x16x32_bf16 v[48:51], a[64:67], a[104:107], v[48:51]
    ds_read_b64 a[2:3], v212 offset:8712
    v_mfma_f32_16x16x32_bf16 v[52:55], a[64:67], a[108:111], v[52:55]
    ds_read_b128 a[36:39], v213 offset:12544
    v_mfma_f32_16x16x32_bf16 v[56:59], a[64:67], a[112:115], v[56:59]
    ds_read_b64 a[4:5], v212 offset:9216
    v_mfma_f32_16x16x32_bf16 v[60:63], a[64:67], a[116:119], v[60:63]
    ds_read_b64 a[6:7], v212 offset:9224
    v_mfma_f32_16x16x32_bf16 v[64:67], a[64:67], a[120:123], v[64:67]
    ds_read_b128 a[40:43], v213 offset:12032
    v_mfma_f32_16x16x32_bf16 v[68:71], a[64:67], a[124:127], v[68:71]
    ds_read_b64 a[8:9], v212 offset:9728
    v_mfma_f32_16x16x32_bf16 v[44:47], a[68:71], a[96:99], v[44:47]
    ds_read_b64 a[10:11], v212 offset:9736
    v_mfma_f32_16x16x32_bf16 v[48:51], a[68:71], a[100:103], v[48:51]
    ds_read_b128 a[44:47], v213 offset:11520
    v_mfma_f32_16x16x32_bf16 v[52:55], a[68:71], a[104:107], v[52:55]
    ds_read_b64 a[12:13], v212 offset:10240
    v_mfma_f32_16x16x32_bf16 v[56:59], a[68:71], a[108:111], v[56:59]
    ds_read_b64 a[14:15], v212 offset:10248
    v_mfma_f32_16x16x32_bf16 v[60:63], a[68:71], a[112:115], v[60:63]
    ds_read_b128 a[48:51], v213 offset:11008
    v_mfma_f32_16x16x32_bf16 v[64:67], a[68:71], a[116:119], v[64:67]
    ds_read_b64 a[16:17], v212 offset:10752
    v_mfma_f32_16x16x32_bf16 v[68:71], a[68:71], a[120:123], v[68:71]
    ds_read_b64 a[18:19], v212 offset:10760
    v_mfma_f32_16x16x32_bf16 v[48:51], a[72:75], a[96:99], v[48:51]
    ds_read_b128 a[52:55], v213 offset:10496
    v_mfma_f32_16x16x32_bf16 v[52:55], a[72:75], a[100:103], v[52:55]
    ds_read_b64 a[20:21], v212 offset:11264
    v_mfma_f32_16x16x32_bf16 v[56:59], a[72:75], a[104:107], v[56:59]
    ds_read_b64 a[22:23], v212 offset:11272
    v_mfma_f32_16x16x32_bf16 v[60:63], a[72:75], a[108:111], v[60:63]
    ds_read_b128 a[56:59], v213 offset:9984
    v_mfma_f32_16x16x32_bf16 v[64:67], a[72:75], a[112:115], v[64:67]
    ds_read_b64 a[24:25], v212 offset:11776
    v_mfma_f32_16x16x32_bf16 v[68:71], a[72:75], a[116:119], v[68:71]
    ds_read_b64 a[26:27], v212 offset:11784
    v_mfma_f32_16x16x32_bf16 v[52:55], a[76:79], a[96:99], v[52:55]
    ds_read_b128 a[60:63], v213 offset:9472
    v_mfma_f32_16x16x32_bf16 v[56:59], a[76:79], a[100:103], v[56:59]
    ds_read_b64 a[28:29], v212 offset:12288
    v_mfma_f32_16x16x32_bf16 v[60:63], a[76:79], a[104:107], v[60:63]
    ds_read_b64 a[30:31], v212 offset:12296
    v_mfma_f32_16x16x32_bf16 v[64:67], a[76:79], a[108:111], v[64:67]
    v_mfma_f32_16x16x32_bf16 v[68:71], a[76:79], a[112:115], v[68:71]
    v_mfma_f32_16x16x32_bf16 v[56:59], a[80:83], a[96:99], v[56:59]
    v_mfma_f32_16x16x32_bf16 v[60:63], a[80:83], a[100:103], v[60:63]
    v_mfma_f32_16x16x32_bf16 v[64:67], a[80:83], a[104:107], v[64:67]
    v_mfma_f32_16x16x32_bf16 v[68:71], a[80:83], a[108:111], v[68:71]
    v_mfma_f32_16x16x32_bf16 v[60:63], a[84:87], a[96:99], v[60:63]
    v_mfma_f32_16x16x32_bf16 v[64:67], a[84:87], a[100:103], v[64:67]
    v_mfma_f32_16x16x32_bf16 v[68:71], a[84:87], a[104:107], v[68:71]
    v_mfma_f32_16x16x32_bf16 v[64:67], a[88:91], a[96:99], v[64:67]
    v_mfma_f32_16x16x32_bf16 v[68:71], a[88:91], a[100:103], v[68:71]
    v_mfma_f32_16x16x32_bf16 v[68:71], a[92:95], a[96:99], v[68:71]
    s_waitcnt lgkmcnt(0)
    v_mfma_f32_16x16x32_bf16 v[40:43], a[0:3], a[32:35], v[40:43]
    ds_read_b128 a[96:99], v213 offset:13120
    v_mfma_f32_16x16x32_bf16 v[44:47], a[0:3], a[36:39], v[44:47]
    ds_read_b64 a[64:65], v212 offset:8768
    v_mfma_f32_16x16x32_bf16 v[48:51], a[0:3], a[40:43], v[48:51]
    ds_read_b64 a[66:67], v212 offset:8776
    v_mfma_f32_16x16x32_bf16 v[52:55], a[0:3], a[44:47], v[52:55]
    ds_read_b128 a[100:103], v213 offset:12608
    v_mfma_f32_16x16x32_bf16 v[56:59], a[0:3], a[48:51], v[56:59]
    ds_read_b64 a[68:69], v212 offset:9280
    v_mfma_f32_16x16x32_bf16 v[60:63], a[0:3], a[52:55], v[60:63]
    ds_read_b64 a[70:71], v212 offset:9288
    v_mfma_f32_16x16x32_bf16 v[64:67], a[0:3], a[56:59], v[64:67]
    ds_read_b128 a[104:107], v213 offset:12096
    v_mfma_f32_16x16x32_bf16 v[68:71], a[0:3], a[60:63], v[68:71]
    ds_read_b64 a[72:73], v212 offset:9792
    v_mfma_f32_16x16x32_bf16 v[44:47], a[4:7], a[32:35], v[44:47]
    ds_read_b64 a[74:75], v212 offset:9800
    v_mfma_f32_16x16x32_bf16 v[48:51], a[4:7], a[36:39], v[48:51]
    ds_read_b128 a[108:111], v213 offset:11584
    v_mfma_f32_16x16x32_bf16 v[52:55], a[4:7], a[40:43], v[52:55]
    ds_read_b64 a[76:77], v212 offset:10304
    v_mfma_f32_16x16x32_bf16 v[56:59], a[4:7], a[44:47], v[56:59]
    ds_read_b64 a[78:79], v212 offset:10312
    v_mfma_f32_16x16x32_bf16 v[60:63], a[4:7], a[48:51], v[60:63]
    ds_read_b128 a[112:115], v213 offset:11072
    v_mfma_f32_16x16x32_bf16 v[64:67], a[4:7], a[52:55], v[64:67]
    ds_read_b64 a[80:81], v212 offset:10816
    v_mfma_f32_16x16x32_bf16 v[68:71], a[4:7], a[56:59], v[68:71]
    ds_read_b64 a[82:83], v212 offset:10824
    v_mfma_f32_16x16x32_bf16 v[48:51], a[8:11], a[32:35], v[48:51]
    ds_read_b128 a[116:119], v213 offset:10560
    v_mfma_f32_16x16x32_bf16 v[52:55], a[8:11], a[36:39], v[52:55]
    ds_read_b64 a[84:85], v212 offset:11328
    v_mfma_f32_16x16x32_bf16 v[56:59], a[8:11], a[40:43], v[56:59]
    ds_read_b64 a[86:87], v212 offset:11336
    v_mfma_f32_16x16x32_bf16 v[60:63], a[8:11], a[44:47], v[60:63]
    ds_read_b128 a[120:123], v213 offset:10048
    v_mfma_f32_16x16x32_bf16 v[64:67], a[8:11], a[48:51], v[64:67]
    ds_read_b64 a[88:89], v212 offset:11840
    v_mfma_f32_16x16x32_bf16 v[68:71], a[8:11], a[52:55], v[68:71]
    ds_read_b64 a[90:91], v212 offset:11848
    v_mfma_f32_16x16x32_bf16 v[52:55], a[12:15], a[32:35], v[52:55]
    ds_read_b128 a[124:127], v213 offset:9536
    v_mfma_f32_16x16x32_bf16 v[56:59], a[12:15], a[36:39], v[56:59]
    ds_read_b64 a[92:93], v212 offset:12352
    v_mfma_f32_16x16x32_bf16 v[60:63], a[12:15], a[40:43], v[60:63]
    ds_read_b64 a[94:95], v212 offset:12360
    v_mfma_f32_16x16x32_bf16 v[64:67], a[12:15], a[44:47], v[64:67]
    s_waitcnt vmcnt(0)
    s_mov_b32 s94, -1
    s_mov_b32 s95, 0
    v_cmp_ne_u32 vcc, s100, v251
    s_and_b64 vcc, vcc, s[94:95]
    s_cbranch_vccz wok_7
    s_add_u32 s97, s45, 256
    s_mov_b32 s96, 30000
poll_8:
    buffer_load_dword v251, v254, s[40:43], s97 offen sc1
    s_waitcnt vmcnt(0)
    v_cmp_ne_u32 vcc, s100, v251
    s_and_b64 vcc, vcc, s[94:95]
    s_cbranch_vccz polld_9
    s_sub_u32 s96, s96, 1
    s_cbranch_scc0 poll_8
polld_9:
wok_7:
    v_mfma_f32_16x16x32_bf16 v[68:71], a[12:15], a[48:51], v[68:71]
    buffer_load_dwordx4 a[132:135], v244, s[36:39], s44 offen offset:0 sc1
    v_mfma_f32_16x16x32_bf16 v[56:59], a[16:19], a[32:35], v[56:59]
    buffer_load_dwordx4 a[136:139], v244, s[36:39], s44 offen offset:1024 sc1
    v_mfma_f32_16x16x32_bf16 v[60:63], a[16:19], a[36:39], v[60:63]
    buffer_load_dwordx4 a[140:143], v244, s[36:39], s44 offen offset:2048 sc1
    v_mfma_f32_16x16x32_bf16 v[64:67], a[16:19], a[40:43], v[64:67]
    buffer_load_dwordx4 a[144:147], v244, s[36:39], s44 offen offset:3072 sc1
    v_mfma_f32_16x16x32_bf16 v[68:71], a[16:19], a[44:47], v[68:71]
    v_mfma_f32_16x16x32_bf16 v[60:63], a[20:23], a[32:35], v[60:63]
    v_mfma_f32_16x16x32_bf16 v[64:67], a[20:23], a[36:39], v[64:67]
    v_mfma_f32_16x16x32_bf16 v[68:71], a[20:23], a[40:43], v[68:71]
    v_mfma_f32_16x16x32_bf16 v[64:67], a[24:27], a[32:35], v[64:67]
    v_mfma_f32_16x16x32_bf16 v[68:71], a[24:27], a[36:39], v[68:71]
    v_mfma_f32_16x16x32_bf16 v[68:71], a[28:31], a[32:35], v[68:71]
    s_waitcnt lgkmcnt(0)
    v_mfma_f32_16x16x32_bf16 v[40:43], a[64:67], a[96:99], v[40:43]
    ds_read_b128 a[32:35], v213 offset:13184
    v_mfma_f32_16x16x32_bf16 v[44:47], a[64:67], a[100:103], v[44:47]
    ds_read_b64 a[0:1], v212 offset:8832
    v_mfma_f32_16x16x32_bf16 v[48:51], a[64:67], a[104:107], v[48:51]
    ds_read_b64 a[2:3], v212 offset:8840
    v_mfma_f32_16x16x32_bf16 v[52:55], a[64:67], a[108:111], v[52:55]
    ds_read_b128 a[36:39], v213 offset:12672
    v_mfma_f32_16x16x32_bf16 v[56:59], a[64:67], a[112:115], v[56:59]
    ds_read_b64 a[4:5], v212 offset:9344
    v_mfma_f32_16x16x32_bf16 v[60:63], a[64:67], a[116:119], v[60:63]
    ds_read_b64 a[6:7], v212 offset:9352
    v_mfma_f32_16x16x32_bf16 v[64:67], a[64:67], a[120:123], v[64:67]
    ds_read_b128 a[40:43], v213 offset:12160
    v_mfma_f32_16x16x32_bf16 v[68:71], a[64:67], a[124:127], v[68:71]
    ds_read_b64 a[8:9], v212 offset:9856
    v_mfma_f32_16x16x32_bf16 v[44:47], a[68:71], a[96:99], v[44:47]
    ds_read_b64 a[10:11], v212 offset:9864
    v_mfma_f32_16x16x32_bf16 v[48:51], a[68:71], a[100:103], v[48:51]
    ds_read_b128 a[44:47], v213 offset:11648
    v_mfma_f32_16x16x32_bf16 v[52:55], a[68:71], a[104:107], v[52:55]
    ds_read_b64 a[12:13], v212 offset:10368
    v_mfma_f32_16x16x32_bf16 v[56:59], a[68:71], a[108:111], v[56:59]
    ds_read_b64 a[14:15], v212 offset:10376
    v_mfma_f32_16x16x32_bf16 v[60:63], a[68:71], a[112:115], v[60:63]
    ds_read_b128 a[48:51], v213 offset:11136
    v_mfma_f32_16x16x32_bf16 v[64:67], a[68:71], a[116:119], v[64:67]
    ds_read_b64 a[16:17], v212 offset:10880
    v_mfma_f32_16x16x32_bf16 v[68:71], a[68:71], a[120:123], v[68:71]
    ds_read_b64 a[18:19], v212 offset:10888
    v_mfma_f32_16x16x32_bf16 v[48:51], a[72:75], a[96:99], v[48:51]
    ds_read_b128 a[52:55], v213 offset:10624
    v_mfma_f32_16x16x32_bf16 v[52:55], a[72:75], a[100:103], v[52:55]
    ds_read_b64 a[20:21], v212 offset:11392
    v_mfma_f32_16x16x32_bf16 v[56:59], a[72:75], a[104:107], v[56:59]
    ds_read_b64 a[22:23], v212 offset:11400
    v_mfma_f32_16x16x32_bf16 v[60:63], a[72:75], a[108:111], v[60:63]
    ds_read_b128 a[56:59], v213 offset:10112
    v_mfma_f32_16x16x32_bf16 v[64:67], a[72:75], a[112:115], v[64:67]
    ds_read_b64 a[24:25], v212 offset:11904
    v_mfma_f32_16x16x32_bf16 v[68:71], a[72:75], a[116:119], v[68:71]
    ds_read_b64 a[26:27], v212 offset:11912
    v_mfma_f32_16x16x32_bf16 v[52:55], a[76:79], a[96:99], v[52:55]
    ds_read_b128 a[60:63], v213 offset:9600
    v_mfma_f32_16x16x32_bf16 v[56:59], a[76:79], a[100:103], v[56:59]
    ds_read_b64 a[28:29], v212 offset:12416
    v_mfma_f32_16x16x32_bf16 v[60:63], a[76:79], a[104:107], v[60:63]
    ds_read_b64 a[30:31], v212 offset:12424
    v_mfma_f32_16x16x32_bf16 v[64:67], a[76:79], a[108:111], v[64:67]
    buffer_load_dwordx4 a[148:151], v245, s[36:39], s44 offen offset:0 sc1
    v_mfma_f32_16x16x32_bf16 v[68:71], a[76:79], a[112:115], v[68:71]
    s_add_u32 s44, s44, 20480
    v_mfma_f32_16x16x32_bf16 v[56:59], a[80:83], a[96:99], v[56:59]
    buffer_load_dwordx4 a[152:155], v244, s[36:39], s44 offen offset:0 sc1
    v_mfma_f32_16x16x32_bf16 v[60:63], a[80:83], a[100:103], v[60:63]
    buffer_load_dwordx4 a[156:159], v244, s[36:39], s44 offen offset:1024 sc1
    v_mfma_f32_16x16x32_bf16 v[64:67], a[80:83], a[104:107], v[64:67]
    buffer_load_dwordx4 a[160:163], v244, s[36:39], s44 offen offset:2048 sc1
    v_mfma_f32_16x16x32_bf16 v[68:71], a[80:83], a[108:111], v[68:71]
    v_mfma_f32_16x16x32_bf16 v[60:63], a[84:87], a[96:99], v[60:63]
    v_mfma_f32_16x16x32_bf16 v[64:67], a[84:87], a[100:103], v[64:67]
    v_mfma_f32_16x16x32_bf16 v[68:71], a[84:87], a[104:107], v[68:71]
    v_mfma_f32_16x16x32_bf16 v[64:67], a[88:91], a[96:99], v[64:67]
    v_mfma_f32_16x16x32_bf16 v[68:71], a[88:91], a[100:103], v[68:71]
    v_mfma_f32_16x16x32_bf16 v[68:71], a[92:95], a[96:99], v[68:71]
    s_waitcnt lgkmcnt(0)
    v_mfma_f32_16x16x32_bf16 v[40:43], a[0:3], a[32:35], v[40:43]
    ds_read_b128 a[96:99], v213 offset:13248
    v_mfma_f32_16x16x32_bf16 v[44:47], a[0:3], a[36:39], v[44:47]
    ds_read_b64 a[64:65], v212 offset:8896
    v_mfma_f32_16x16x32_bf16 v[48:51], a[0:3], a[40:43], v[48:51]
    ds_read_b64 a[66:67], v212 offset:8904
    v_mfma_f32_16x16x32_bf16 v[52:55], a[0:3], a[44:47], v[52:55]
    ds_read_b128 a[100:103], v213 offset:12736
    v_mfma_f32_16x16x32_bf16 v[56:59], a[0:3], a[48:51], v[56:59]
    ds_read_b64 a[68:69], v212 offset:9408
    v_mfma_f32_16x16x32_bf16 v[60:63], a[0:3], a[52:55], v[60:63]
    ds_read_b64 a[70:71], v212 offset:9416
    v_mfma_f32_16x16x32_bf16 v[64:67], a[0:3], a[56:59], v[64:67]
    ds_read_b128 a[104:107], v213 offset:12224
    v_mfma_f32_16x16x32_bf16 v[68:71], a[0:3], a[60:63], v[68:71]
    ds_read_b64 a[72:73], v212 offset:9920
    v_mfma_f32_16x16x32_bf16 v[44:47], a[4:7], a[32:35], v[44:47]
    ds_read_b64 a[74:75], v212 offset:9928
    v_mfma_f32_16x16x32_bf16 v[48:51], a[4:7], a[36:39], v[48:51]
    ds_read_b128 a[108:111], v213 offset:11712
    v_mfma_f32_16x16x32_bf16 v[52:55], a[4:7], a[40:43], v[52:55]
    ds_read_b64 a[76:77], v212 offset:10432
    v_mfma_f32_16x16x32_bf16 v[56:59], a[4:7], a[44:47], v[56:59]
    ds_read_b64 a[78:79], v212 offset:10440
    v_mfma_f32_16x16x32_bf16 v[60:63], a[4:7], a[48:51], v[60:63]
    ds_read_b128 a[112:115], v213 offset:11200
    v_mfma_f32_16x16x32_bf16 v[64:67], a[4:7], a[52:55], v[64:67]
    ds_read_b64 a[80:81], v212 offset:10944
    v_mfma_f32_16x16x32_bf16 v[68:71], a[4:7], a[56:59], v[68:71]
    ds_read_b64 a[82:83], v212 offset:10952
    v_mfma_f32_16x16x32_bf16 v[48:51], a[8:11], a[32:35], v[48:51]
    ds_read_b128 a[116:119], v213 offset:10688
    v_mfma_f32_16x16x32_bf16 v[52:55], a[8:11], a[36:39], v[52:55]
    ds_read_b64 a[84:85], v212 offset:11456
    v_mfma_f32_16x16x32_bf16 v[56:59], a[8:11], a[40:43], v[56:59]
    ds_read_b64 a[86:87], v212 offset:11464
    v_mfma_f32_16x16x32_bf16 v[60:63], a[8:11], a[44:47], v[60:63]
    ds_read_b128 a[120:123], v213 offset:10176
    v_mfma_f32_16x16x32_bf16 v[64:67], a[8:11], a[48:51], v[64:67]
    ds_read_b64 a[88:89], v212 offset:11968
    v_mfma_f32_16x16x32_bf16 v[68:71], a[8:11], a[52:55], v[68:71]
    ds_read_b64 a[90:91], v212 offset:11976
    v_mfma_f32_16x16x32_bf16 v[52:55], a[12:15], a[32:35], v[52:55]
    ds_read_b128 a[124:127], v213 offset:9664
    v_mfma_f32_16x16x32_bf16 v[56:59], a[12:15], a[36:39], v[56:59]
    ds_read_b64 a[92:93], v212 offset:12480
    v_mfma_f32_16x16x32_bf16 v[60:63], a[12:15], a[40:43], v[60:63]
    ds_read_b64 a[94:95], v212 offset:12488
    v_mfma_f32_16x16x32_bf16 v[64:67], a[12:15], a[44:47], v[64:67]
    buffer_load_dwordx4 a[164:167], v244, s[36:39], s44 offen offset:3072 sc1
    v_mfma_f32_16x16x32_bf16 v[68:71], a[12:15], a[48:51], v[68:71]
    buffer_load_dwordx4 a[168:171], v245, s[36:39], s44 offen offset:0 sc1
    v_mfma_f32_16x16x32_bf16 v[56:59], a[16:19], a[32:35], v[56:59]
    s_add_u32 s44, s44, 20480
    v_mfma_f32_16x16x32_bf16 v[60:63], a[16:19], a[36:39], v[60:63]
    buffer_load_dwordx4 a[172:175], v244, s[36:39], s44 offen offset:0 sc1
    v_mfma_f32_16x16x32_bf16 v[64:67], a[16:19], a[40:43], v[64:67]
    buffer_load_dwordx4 a[176:179], v244, s[36:39], s44 offen offset:1024 sc1
    v_mfma_f32_16x16x32_bf16 v[68:71], a[16:19], a[44:47], v[68:71]
    v_mfma_f32_16x16x32_bf16 v[60:63], a[20:23], a[32:35], v[60:63]
    v_mfma_f32_16x16x32_bf16 v[64:67], a[20:23], a[36:39], v[64:67]
    v_mfma_f32_16x16x32_bf16 v[68:71], a[20:23], a[40:43], v[68:71]
    v_mfma_f32_16x16x32_bf16 v[64:67], a[24:27], a[32:35], v[64:67]
    v_mfma_f32_16x16x32_bf16 v[68:71], a[24:27], a[36:39], v[68:71]
    v_mfma_f32_16x16x32_bf16 v[68:71], a[28:31], a[32:35], v[68:71]
    s_waitcnt lgkmcnt(0)
    v_mfma_f32_16x16x32_bf16 v[40:43], a[64:67], a[96:99], v[40:43]
    v_mfma_f32_16x16x32_bf16 v[44:47], a[64:67], a[100:103], v[44:47]
    ds_read_b128 a[32:35], v213 offset:3584
    v_mfma_f32_16x16x32_bf16 v[48:51], a[64:67], a[104:107], v[48:51]
    ds_read_b64 a[0:1], v212 offset:0
    v_mfma_f32_16x16x32_bf16 v[52:55], a[64:67], a[108:111], v[52:55]
    ds_read_b64 a[2:3], v212 offset:8
    v_mfma_f32_16x16x32_bf16 v[56:59], a[64:67], a[112:115], v[56:59]
    ds_read_b128 a[36:39], v213 offset:3072
    ds_read_b64 a[4:5], v212 offset:512
    v_mfma_f32_16x16x32_bf16 v[60:63], a[64:67], a[116:119], v[60:63]
    ds_read_b64 a[6:7], v212 offset:520
    v_mfma_f32_16x16x32_bf16 v[64:67], a[64:67], a[120:123], v[64:67]
    ds_read_b128 a[40:43], v213 offset:2560
    v_mfma_f32_16x16x32_bf16 v[68:71], a[64:67], a[124:127], v[68:71]
    ds_read_b64 a[8:9], v212 offset:1024
    v_mfma_f32_16x16x32_bf16 v[44:47], a[68:71], a[96:99], v[44:47]
    ds_read_b64 a[10:11], v212 offset:1032
    v_mfma_f32_16x16x32_bf16 v[48:51], a[68:71], a[100:103], v[48:51]
    ds_read_b128 a[44:47], v213 offset:2048
    ds_read_b64 a[12:13], v212 offset:1536
    v_mfma_f32_16x16x32_bf16 v[52:55], a[68:71], a[104:107], v[52:55]
    ds_read_b64 a[14:15], v212 offset:1544
    v_mfma_f32_16x16x32_bf16 v[56:59], a[68:71], a[108:111], v[56:59]
    ds_read_b128 a[48:51], v213 offset:1536
    v_mfma_f32_16x16x32_bf16 v[60:63], a[68:71], a[112:115], v[60:63]
    ds_read_b64 a[16:17], v212 offset:2048
    v_mfma_f32_16x16x32_bf16 v[64:67], a[68:71], a[116:119], v[64:67]
    ds_read_b64 a[18:19], v212 offset:2056
    v_mfma_f32_16x16x32_bf16 v[68:71], a[68:71], a[120:123], v[68:71]
    ds_read_b128 a[52:55], v213 offset:1024
    ds_read_b64 a[20:21], v212 offset:2560
    v_mfma_f32_16x16x32_bf16 v[48:51], a[72:75], a[96:99], v[48:51]
    ds_read_b64 a[22:23], v212 offset:2568
    v_mfma_f32_16x16x32_bf16 v[52:55], a[72:75], a[100:103], v[52:55]
    ds_read_b128 a[56:59], v213 offset:512
    v_mfma_f32_16x16x32_bf16 v[56:59], a[72:75], a[104:107], v[56:59]
    ds_read_b64 a[24:25], v212 offset:3072
    v_mfma_f32_16x16x32_bf16 v[60:63], a[72:75], a[108:111], v[60:63]
    ds_read_b64 a[26:27], v212 offset:3080
    v_mfma_f32_16x16x32_bf16 v[64:67], a[72:75], a[112:115], v[64:67]
    ds_read_b128 a[60:63], v213 offset:0
    ds_read_b64 a[28:29], v212 offset:3584
    v_mfma_f32_16x16x32_bf16 v[68:71], a[72:75], a[116:119], v[68:71]
    ds_read_b64 a[30:31], v212 offset:3592
    v_mfma_f32_16x16x32_bf16 v[52:55], a[76:79], a[96:99], v[52:55]
    s_and_b32 s72, s74, 0xffff
    v_mfma_f32_16x16x32_bf16 v[56:59], a[76:79], a[100:103], v[56:59]
    s_mul_i32 s72, s72, 0x10001
    v_mfma_f32_16x16x32_bf16 v[60:63], a[76:79], a[104:107], v[60:63]
    v_and_b32 v220, s72, v216
    v_mfma_f32_16x16x32_bf16 v[64:67], a[76:79], a[108:111], v[64:67]
    v_and_b32 v221, s72, v217
    v_and_b32 v222, s72, v218
    v_mfma_f32_16x16x32_bf16 v[68:71], a[76:79], a[112:115], v[68:71]
    v_and_b32 v223, s72, v219
    v_mfma_f32_16x16x32_bf16 v[56:59], a[80:83], a[96:99], v[56:59]
    buffer_load_dwordx4 a[180:183], v244, s[36:39], s44 offen offset:2048 sc1
    v_mfma_f32_16x16x32_bf16 v[60:63], a[80:83], a[100:103], v[60:63]
    buffer_load_dwordx4 a[184:187], v244, s[36:39], s44 offen offset:3072 sc1
    v_mfma_f32_16x16x32_bf16 v[64:67], a[80:83], a[104:107], v[64:67]
    buffer_load_dwordx4 a[188:191], v245, s[36:39], s44 offen offset:0 sc1
    v_mfma_f32_16x16x32_bf16 v[68:71], a[80:83], a[108:111], v[68:71]
    s_add_u32 s44, s44, 20480
    buffer_load_dwordx4 a[192:195], v244, s[36:39], s44 offen offset:0 sc1
    v_mfma_f32_16x16x32_bf16 v[60:63], a[84:87], a[96:99], v[60:63]
    v_mfma_f32_16x16x32_bf16 v[64:67], a[84:87], a[100:103], v[64:67]
    v_mfma_f32_16x16x32_bf16 v[68:71], a[84:87], a[104:107], v[68:71]
    v_mfma_f32_16x16x32_bf16 v[64:67], a[88:91], a[96:99], v[64:67]
    v_mfma_f32_16x16x32_bf16 v[68:71], a[88:91], a[100:103], v[68:71]
    v_mfma_f32_16x16x32_bf16 v[68:71], a[92:95], a[96:99], v[68:71]
    s_bitcmp1_b32 s3, 0
    s_cbranch_scc1 cvh_10
    s_waitcnt lgkmcnt(0)
    v_mfma_f32_16x16x32_bf16 v[8:11], v[220:223], a[32:35], 0
    ds_read_b128 a[96:99], v213 offset:3648
    v_mfma_f32_16x16x32_bf16 v[20:23], v[220:223], a[44:47], 0
    ds_read_b64 a[64:65], v212 offset:64
    ds_read_b64 a[66:67], v212 offset:72
    v_mfma_f32_16x16x32_bf16 v[24:27], v[220:223], a[48:51], 0
    ds_read_b128 a[100:103], v213 offset:3136
    ds_read_b64 a[68:69], v212 offset:576
    v_mfma_f32_16x16x32_bf16 v[36:39], v[220:223], a[60:63], 0
    ds_read_b64 a[70:71], v212 offset:584
    ds_read_b128 a[104:107], v213 offset:2624
    v_mfma_f32_16x16x32_bf16 v[8:11], a[0:3], a[32:35], v[8:11]
    ds_read_b64 a[72:73], v212 offset:1088
    ds_read_b64 a[74:75], v212 offset:1096
    v_mfma_f32_16x16x32_bf16 v[20:23], a[0:3], a[44:47], v[20:23]
    ds_read_b128 a[108:111], v213 offset:2112
    v_mfma_f32_16x16x32_bf16 v[24:27], a[0:3], a[48:51], v[24:27]
    ds_read_b64 a[76:77], v212 offset:1600
    ds_read_b64 a[78:79], v212 offset:1608
    v_mfma_f32_16x16x32_bf16 v[36:39], a[0:3], a[60:63], v[36:39]
    ds_read_b128 a[112:115], v213 offset:1600
    ds_read_b64 a[80:81], v212 offset:2112
    v_mfma_f32_16x16x32_bf16 v[20:23], a[4:7], a[40:43], v[20:23]
    ds_read_b64 a[82:83], v212 offset:2120
    ds_read_b128 a[116:119], v213 offset:1088
    v_mfma_f32_16x16x32_bf16 v[24:27], a[4:7], a[44:47], v[24:27]
    ds_read_b64 a[84:85], v212 offset:2624
    ds_read_b64 a[86:87], v212 offset:2632
    v_mfma_f32_16x16x32_bf16 v[36:39], a[4:7], a[56:59], v[36:39]
    ds_read_b128 a[120:123], v213 offset:576
    v_mfma_f32_16x16x32_bf16 v[20:23], a[8:11], a[36:39], v[20:23]
    ds_read_b64 a[88:89], v212 offset:3136
    ds_read_b64 a[90:91], v212 offset:3144
    v_mfma_f32_16x16x32_bf16 v[24:27], a[8:11], a[40:43], v[24:27]
    ds_read_b128 a[124:127], v213 offset:64
    ds_read_b64 a[92:93], v212 offset:3648
    v_mfma_f32_16x16x32_bf16 v[36:39], a[8:11], a[52:55], v[36:39]
    ds_read_b64 a[94:95], v212 offset:3656
    buffer_load_dwordx4 a[196:199], v244, s[36:39], s44 offen offset:1024 sc1
    v_mfma_f32_16x16x32_bf16 v[20:23], a[12:15], a[32:35], v[20:23]
    buffer_load_dwordx4 a[200:203], v244, s[36:39], s44 offen offset:2048 sc1
    buffer_load_dwordx4 a[204:207], v244, s[36:39], s44 offen offset:3072 sc1
    v_mfma_f32_16x16x32_bf16 v[24:27], a[12:15], a[36:39], v[24:27]
    buffer_load_dwordx4 a[208:211], v245, s[36:39], s44 offen offset:0 sc1
    s_add_u32 s44, s44, 20480
    v_mfma_f32_16x16x32_bf16 v[36:39], a[12:15], a[48:51], v[36:39]
    v_mfma_f32_16x16x32_bf16 v[24:27], a[16:19], a[32:35], v[24:27]
    v_mfma_f32_16x16x32_bf16 v[36:39], a[16:19], a[44:47], v[36:39]
    v_mfma_f32_16x16x32_bf16 v[36:39], a[20:23], a[40:43], v[36:39]
    v_mfma_f32_16x16x32_bf16 v[36:39], a[24:27], a[36:39], v[36:39]
    v_mfma_f32_16x16x32_bf16 v[36:39], a[28:31], a[32:35], v[36:39]
    s_waitcnt lgkmcnt(0)
    v_mfma_f32_16x16x32_bf16 v[8:11], a[64:67], a[96:99], v[8:11]
    ds_read_b128 a[32:35], v213 offset:3712
    ds_read_b64 a[0:1], v212 offset:128
    ds_read_b64 a[2:3], v212 offset:136
    ds_read_b128 a[36:39], v213 offset:3200
    v_mfma_f32_16x16x32_bf16 v[20:23], a[64:67], a[108:111], v[20:23]
    ds_read_b64 a[4:5], v212 offset:640
    ds_read_b64 a[6:7], v212 offset:648
    ds_read_b128 a[40:43], v213 offset:2688
    ds_read_b64 a[8:9], v212 offset:1152
    ds_read_b64 a[10:11], v212 offset:1160
    v_mfma_f32_16x16x32_bf16 v[24:27], a[64:67], a[112:115], v[24:27]
    ds_read_b128 a[44:47], v213 offset:2176
    ds_read_b64 a[12:13], v212 offset:1664
    ds_read_b64 a[14:15], v212 offset:1672
    ds_read_b128 a[48:51], v213 offset:1664
    v_mfma_f32_16x16x32_bf16 v[36:39], a[64:67], a[124:127], v[36:39]
    ds_read_b64 a[16:17], v212 offset:2176
    ds_read_b64 a[18:19], v212 offset:2184
    ds_read_b128 a[52:55], v213 offset:1152
    ds_read_b64 a[20:21], v212 offset:2688
    ds_read_b64 a[22:23], v212 offset:2696
    v_mfma_f32_16x16x32_bf16 v[20:23], a[68:71], a[104:107], v[20:23]
    ds_read_b128 a[56:59], v213 offset:640
    ds_read_b64 a[24:25], v212 offset:3200
    ds_read_b64 a[26:27], v212 offset:3208
    ds_read_b128 a[60:63], v213 offset:128
    v_mfma_f32_16x16x32_bf16 v[24:27], a[68:71], a[108:111], v[24:27]
    ds_read_b64 a[28:29], v212 offset:3712
    ds_read_b64 a[30:31], v212 offset:3720
    v_cvt_pk_bf16_f32 v224, v40, v41
    v_cvt_pk_bf16_f32 v225, v42, v43
    buffer_store_dwordx2 v[224:225], v214, s[88:91], s64 offen offset:0 sc1
    v_mfma_f32_16x16x32_bf16 v[36:39], a[68:71], a[120:123], v[36:39]
    v_cvt_pk_bf16_f32 v226, v44, v45
    v_cvt_pk_bf16_f32 v227, v46, v47
    buffer_store_dwordx2 v[226:227], v214, s[88:91], s64 offen offset:512 sc1
    v_cvt_pk_bf16_f32 v228, v48, v49
    v_mfma_f32_16x16x32_bf16 v[20:23], a[72:75], a[100:103], v[20:23]
    v_cvt_pk_bf16_f32 v229, v50, v51
    buffer_store_dwordx2 v[228:229], v214, s[88:91], s64 offen offset:1024 sc1
    v_cvt_pk_bf16_f32 v230, v52, v53
    v_cvt_pk_bf16_f32 v231, v54, v55
    buffer_store_dwordx2 v[230:231], v214, s[88:91], s64 offen offset:1536 sc1
    v_mfma_f32_16x16x32_bf16 v[24:27], a[72:75], a[104:107], v[24:27]
    v_cvt_pk_bf16_f32 v224, v56, v57
    v_cvt_pk_bf16_f32 v225, v58, v59
    buffer_store_dwordx2 v[224:225], v214, s[88:91], s64 offen offset:2048 sc1
    v_cvt_pk_bf16_f32 v226, v60, v61
    v_mfma_f32_16x16x32_bf16 v[36:39], a[72:75], a[116:119], v[36:39]
    v_cvt_pk_bf16_f32 v227, v62, v63
    buffer_store_dwordx2 v[226:227], v214, s[88:91], s64 offen offset:2560 sc1
    v_cvt_pk_bf16_f32 v228, v64, v65
    v_cvt_pk_bf16_f32 v229, v66, v67
    buffer_store_dwordx2 v[228:229], v214, s[88:91], s64 offen offset:3072 sc1
    v_mfma_f32_16x16x32_bf16 v[20:23], a[76:79], a[96:99], v[20:23]
    v_cvt_pk_bf16_f32 v230, v68, v69
    v_cvt_pk_bf16_f32 v231, v70, v71
    buffer_store_dwordx2 v[230:231], v214, s[88:91], s64 offen offset:3584 sc1
    buffer_load_dwordx4 a[212:215], v244, s[36:39], s44 offen offset:0 sc1
    v_mfma_f32_16x16x32_bf16 v[24:27], a[76:79], a[100:103], v[24:27]
    buffer_load_dwordx4 a[216:219], v244, s[36:39], s44 offen offset:1024 sc1
    buffer_load_dwordx4 a[220:223], v244, s[36:39], s44 offen offset:2048 sc1
    buffer_load_dwordx4 a[224:227], v244, s[36:39], s44 offen offset:3072 sc1
    buffer_load_dwordx4 a[228:231], v245, s[36:39], s44 offen offset:0 sc1
    s_add_u32 s44, s44, 20480
    v_mfma_f32_16x16x32_bf16 v[36:39], a[76:79], a[112:115], v[36:39]
    v_mfma_f32_16x16x32_bf16 v[24:27], a[80:83], a[96:99], v[24:27]
    v_mfma_f32_16x16x32_bf16 v[36:39], a[80:83], a[108:111], v[36:39]
    v_mfma_f32_16x16x32_bf16 v[36:39], a[84:87], a[104:107], v[36:39]
    v_mfma_f32_16x16x32_bf16 v[36:39], a[88:91], a[100:103], v[36:39]
    v_mfma_f32_16x16x32_bf16 v[36:39], a[92:95], a[96:99], v[36:39]
    s_waitcnt lgkmcnt(0)
    v_mfma_f32_16x16x32_bf16 v[8:11], a[0:3], a[32:35], v[8:11]
    ds_read_b128 a[96:99], v213 offset:3776
    ds_read_b64 a[64:65], v212 offset:192
    v_mfma_f32_16x16x32_bf16 v[20:23], a[0:3], a[44:47], v[20:23]
    ds_read_b64 a[66:67], v212 offset:200
    ds_read_b128 a[100:103], v213 offset:3264
    v_mfma_f32_16x16x32_bf16 v[24:27], a[0:3], a[48:51], v[24:27]
    ds_read_b64 a[68:69], v212 offset:704
    ds_read_b64 a[70:71], v212 offset:712
    ds_read_b128 a[104:107], v213 offset:2752
    v_mfma_f32_16x16x32_bf16 v[36:39], a[0:3], a[60:63], v[36:39]
    ds_read_b64 a[72:73], v212 offset:1216
    ds_read_b64 a[74:75], v212 offset:1224
    v_mfma_f32_16x16x32_bf16 v[20:23], a[4:7], a[40:43], v[20:23]
    ds_read_b128 a[108:111], v213 offset:2240
    ds_read_b64 a[76:77], v212 offset:1728
    v_mfma_f32_16x16x32_bf16 v[24:27], a[4:7], a[44:47], v[24:27]
    ds_read_b64 a[78:79], v212 offset:1736
    ds_read_b128 a[112:115], v213 offset:1728
    ds_read_b64 a[80:81], v212 offset:2240
    v_mfma_f32_16x16x32_bf16 v[36:39], a[4:7], a[56:59], v[36:39]
    ds_read_b64 a[82:83], v212 offset:2248
    ds_read_b128 a[116:119], v213 offset:1216
    v_mfma_f32_16x16x32_bf16 v[20:23], a[8:11], a[36:39], v[20:23]
    ds_read_b64 a[84:85], v212 offset:2752
    ds_read_b64 a[86:87], v212 offset:2760
    v_mfma_f32_16x16x32_bf16 v[24:27], a[8:11], a[40:43], v[24:27]
    ds_read_b128 a[120:123], v213 offset:704
    ds_read_b64 a[88:89], v212 offset:3264
    ds_read_b64 a[90:91], v212 offset:3272
    v_mfma_f32_16x16x32_bf16 v[36:39], a[8:11], a[52:55], v[36:39]
    ds_read_b128 a[124:127], v213 offset:192
    ds_read_b64 a[92:93], v212 offset:3776
    v_mfma_f32_16x16x32_bf16 v[20:23], a[12:15], a[32:35], v[20:23]
    ds_read_b64 a[94:95], v212 offset:3784
    buffer_load_dwordx4 a[232:235], v244, s[36:39], s44 offen offset:0 sc1
    v_mfma_f32_16x16x32_bf16 v[24:27], a[12:15], a[36:39], v[24:27]
    buffer_load_dwordx4 a[236:239], v244, s[36:39], s44 offen offset:1024 sc1
    buffer_load_dwordx4 a[240:243], v244, s[36:39], s44 offen offset:2048 sc1
    buffer_load_dwordx4 a[244:247], v244, s[36:39], s44 offen offset:3072 sc1
    v_mfma_f32_16x16x32_bf16 v[36:39], a[12:15], a[48:51], v[36:39]
    v_mfma_f32_16x16x32_bf16 v[24:27], a[16:19], a[32:35], v[24:27]
    v_mfma_f32_16x16x32_bf16 v[36:39], a[16:19], a[44:47], v[36:39]
    v_mfma_f32_16x16x32_bf16 v[36:39], a[20:23], a[40:43], v[36:39]
    v_mfma_f32_16x16x32_bf16 v[36:39], a[24:27], a[36:39], v[36:39]
    v_mfma_f32_16x16x32_bf16 v[36:39], a[28:31], a[32:35], v[36:39]
    s_waitcnt lgkmcnt(0)
    v_mfma_f32_16x16x32_bf16 v[8:11], a[64:67], a[96:99], v[8:11]
    ds_read_b128 a[32:35], v213 offset:3840
    ds_read_b64 a[0:1], v212 offset:256
    v_mfma_f32_16x16x32_bf16 v[20:23], a[64:67], a[108:111], v[20:23]
    ds_read_b64 a[2:3], v212 offset:264
    ds_read_b128 a[36:39], v213 offset:3328
    v_mfma_f32_16x16x32_bf16 v[24:27], a[64:67], a[112:115], v[24:27]
    ds_read_b64 a[4:5], v212 offset:768
    ds_read_b64 a[6:7], v212 offset:776
    ds_read_b128 a[40:43], v213 offset:2816
    v_mfma_f32_16x16x32_bf16 v[36:39], a[64:67], a[124:127], v[36:39]
    ds_read_b64 a[8:9], v212 offset:1280
    ds_read_b64 a[10:11], v212 offset:1288
    v_mfma_f32_16x16x32_bf16 v[20:23], a[68:71], a[104:107], v[20:23]
    ds_read_b128 a[44:47], v213 offset:2304
    ds_read_b64 a[12:13], v212 offset:1792
    ds_read_b64 a[14:15], v212 offset:1800
    v_mfma_f32_16x16x32_bf16 v[24:27], a[68:71], a[108:111], v[24:27]
    ds_read_b128 a[48:51], v213 offset:1792
    ds_read_b64 a[16:17], v212 offset:2304
    v_mfma_f32_16x16x32_bf16 v[36:39], a[68:71], a[120:123], v[36:39]
    ds_read_b64 a[18:19], v212 offset:2312
    ds_read_b128 a[52:55], v213 offset:1280
    v_mfma_f32_16x16x32_bf16 v[20:23], a[72:75], a[100:103], v[20:23]
    ds_read_b64 a[20:21], v212 offset:2816
    ds_read_b64 a[22:23], v212 offset:2824
    ds_read_b128 a[56:59], v213 offset:768
    v_mfma_f32_16x16x32_bf16 v[24:27], a[72:75], a[104:107], v[24:27]
    ds_read_b64 a[24:25], v212 offset:3328
    ds_read_b64 a[26:27], v212 offset:3336
    v_mfma_f32_16x16x32_bf16 v[36:39], a[72:75], a[116:119], v[36:39]
    ds_read_b128 a[60:63], v213 offset:256
    ds_read_b64 a[28:29], v212 offset:3840
    ds_read_b64 a[30:31], v212 offset:3848
    v_mfma_f32_16x16x32_bf16 v[20:23], a[76:79], a[96:99], v[20:23]
    buffer_load_dwordx4 a[248:251], v245, s[36:39], s44 offen offset:0 sc1
    s_add_u32 s44, s44, 20480
    v_mfma_f32_16x16x32_bf16 v[24:27], a[76:79], a[100:103], v[24:27]
    buffer_load_dwordx4 v[80:83], v244, s[36:39], s44 offen offset:0 sc1
    buffer_load_dwordx4 v[84:87], v244, s[36:39], s44 offen offset:1024 sc1
    buffer_load_dwordx4 v[88:91], v244, s[36:39], s44 offen offset:2048 sc1
    v_mfma_f32_16x16x32_bf16 v[36:39], a[76:79], a[112:115], v[36:39]
    v_mfma_f32_16x16x32_bf16 v[24:27], a[80:83], a[96:99], v[24:27]
    v_mfma_f32_16x16x32_bf16 v[36:39], a[80:83], a[108:111], v[36:39]
    v_mfma_f32_16x16x32_bf16 v[36:39], a[84:87], a[104:107], v[36:39]
    v_mfma_f32_16x16x32_bf16 v[36:39], a[88:91], a[100:103], v[36:39]
    v_mfma_f32_16x16x32_bf16 v[36:39], a[92:95], a[96:99], v[36:39]
    s_waitcnt lgkmcnt(0)
    v_mfma_f32_16x16x32_bf16 v[8:11], a[0:3], a[32:35], v[8:11]
    ds_read_b128 a[96:99], v213 offset:3904
    ds_read_b64 a[64:65], v212 offset:320
    v_mfma_f32_16x16x32_bf16 v[20:23], a[0:3], a[44:47], v[20:23]
    ds_read_b64 a[66:67], v212 offset:328
    ds_read_b128 a[100:103], v213 offset:3392
    v_mfma_f32_16x16x32_bf16 v[24:27], a[0:3], a[48:51], v[24:27]
    ds_read_b64 a[68:69], v212 offset:832
    ds_read_b64 a[70:71], v212 offset:840
    ds_read_b128 a[104:107], v213 offset:2880
    v_mfma_f32_16x16x32_bf16 v[36:39], a[0:3], a[60:63], v[36:39]
    ds_read_b64 a[72:73], v212 offset:1344
    ds_read_b64 a[74:75], v212 offset:1352
    v_mfma_f32_16x16x32_bf16 v[20:23], a[4:7], a[40:43], v[20:23]
    ds_read_b128 a[108:111], v213 offset:2368
    ds_read_b64 a[76:77], v212 offset:1856
    ds_read_b64 a[78:79], v212 offset:1864
    v_mfma_f32_16x16x32_bf16 v[24:27], a[4:7], a[44:47], v[24:27]
    ds_read_b128 a[112:115], v213 offset:1856
    ds_read_b64 a[80:81], v212 offset:2368
    v_mfma_f32_16x16x32_bf16 v[36:39], a[4:7], a[56:59], v[36:39]
    ds_read_b64 a[82:83], v212 offset:2376
    ds_read_b128 a[116:119], v213 offset:1344
    v_mfma_f32_16x16x32_bf16 v[20:23], a[8:11], a[36:39], v[20:23]
    ds_read_b64 a[84:85], v212 offset:2880
    ds_read_b64 a[86:87], v212 offset:2888
    ds_read_b128 a[120:123], v213 offset:832
    v_mfma_f32_16x16x32_bf16 v[24:27], a[8:11], a[40:43], v[24:27]
    ds_read_b64 a[88:89], v212 offset:3392
    ds_read_b64 a[90:91], v212 offset:3400
    v_mfma_f32_16x16x32_bf16 v[36:39], a[8:11], a[52:55], v[36:39]
    ds_read_b128 a[124:127], v213 offset:320
    ds_read_b64 a[92:93], v212 offset:3904
    ds_read_b64 a[94:95], v212 offset:3912
    v_mfma_f32_16x16x32_bf16 v[20:23], a[12:15], a[32:35], v[20:23]
    buffer_load_dwordx4 v[92:95], v244, s[36:39], s44 offen offset:3072 sc1
    buffer_load_dwordx4 v[96:99], v245, s[36:39], s44 offen offset:0 sc1
    v_mfma_f32_16x16x32_bf16 v[24:27], a[12:15], a[36:39], v[24:27]
    s_add_u32 s44, s44, 20480
    buffer_load_dwordx4 v[100:103], v244, s[36:39], s44 offen offset:0 sc1
    buffer_load_dwordx4 v[104:107], v244, s[36:39], s44 offen offset:1024 sc1
    v_mfma_f32_16x16x32_bf16 v[36:39], a[12:15], a[48:51], v[36:39]
    v_mfma_f32_16x16x32_bf16 v[24:27], a[16:19], a[32:35], v[24:27]
    v_mfma_f32_16x16x32_bf16 v[36:39], a[16:19], a[44:47], v[36:39]
    v_mfma_f32_16x16x32_bf16 v[36:39], a[20:23], a[40:43], v[36:39]
    v_mfma_f32_16x16x32_bf16 v[36:39], a[24:27], a[36:39], v[36:39]
    v_mfma_f32_16x16x32_bf16 v[36:39], a[28:31], a[32:35], v[36:39]
    s_waitcnt lgkmcnt(0)
    v_mfma_f32_16x16x32_bf16 v[8:11], a[64:67], a[96:99], v[8:11]
    ds_read_b128 a[32:35], v213 offset:3968
    ds_read_b64 a[0:1], v212 offset:384
    v_mfma_f32_16x16x32_bf16 v[20:23], a[64:67], a[108:111], v[20:23]
    ds_read_b64 a[2:3], v212 offset:392
    ds_read_b128 a[36:39], v213 offset:3456
    v_mfma_f32_16x16x32_bf16 v[24:27], a[64:67], a[112:115], v[24:27]
    ds_read_b64 a[4:5], v212 offset:896
    ds_read_b64 a[6:7], v212 offset:904
    ds_read_b128 a[40:43], v213 offset:2944
    v_mfma_f32_16x16x32_bf16 v[36:39], a[64:67], a[124:127], v[36:39]
    ds_read_b64 a[8:9], v212 offset:1408
    ds_read_b64 a[10:11], v212 offset:1416
    v_mfma_f32_16x16x32_bf16 v[20:23], a[68:71], a[104:107], v[20:23]
    ds_read_b128 a[44:47], v213 offset:2432
    ds_read_b64 a[12:13], v212 offset:1920
    ds_read_b64 a[14:15], v212 offset:1928
    v_mfma_f32_16x16x32_bf16 v[24:27], a[68:71], a[108:111], v[24:27]
    ds_read_b128 a[48:51], v213 offset:1920
    ds_read_b64 a[16:17], v212 offset:2432
    v_mfma_f32_16x16x32_bf16 v[36:39], a[68:71], a[120:123], v[36:39]
    ds_read_b64 a[18:19], v212 offset:2440
    ds_read_b128 a[52:55], v213 offset:1408
    v_mfma_f32_16x16x32_bf16 v[20:23], a[72:75], a[100:103], v[20:23]
    ds_read_b64 a[20:21], v212 offset:2944
    ds_read_b64 a[22:23], v212 offset:2952
    ds_read_b128 a[56:59], v213 offset:896
    v_mfma_f32_16x16x32_bf16 v[24:27], a[72:75], a[104:107], v[24:27]
    ds_read_b64 a[24:25], v212 offset:3456
    ds_read_b64 a[26:27], v212 offset:3464
    v_mfma_f32_16x16x32_bf16 v[36:39], a[72:75], a[116:119], v[36:39]
    ds_read_b128 a[60:63], v213 offset:384
    ds_read_b64 a[28:29], v212 offset:3968
    ds_read_b64 a[30:31], v212 offset:3976
    v_mfma_f32_16x16x32_bf16 v[20:23], a[76:79], a[96:99], v[20:23]
    buffer_load_dwordx4 v[108:111], v244, s[36:39], s44 offen offset:2048 sc1
    buffer_load_dwordx4 v[112:115], v244, s[36:39], s44 offen offset:3072 sc1
    v_mfma_f32_16x16x32_bf16 v[24:27], a[76:79], a[100:103], v[24:27]
    buffer_load_dwordx4 v[116:119], v245, s[36:39], s44 offen offset:0 sc1
    s_add_u32 s44, s44, 20480
    buffer_load_dwordx4 v[168:171], v244, s[36:39], s44 offen offset:0 sc1
    v_mfma_f32_16x16x32_bf16 v[36:39], a[76:79], a[112:115], v[36:39]
    v_mfma_f32_16x16x32_bf16 v[24:27], a[80:83], a[96:99], v[24:27]
    v_mfma_f32_16x16x32_bf16 v[36:39], a[80:83], a[108:111], v[36:39]
    v_mfma_f32_16x16x32_bf16 v[36:39], a[84:87], a[104:107], v[36:39]
    v_mfma_f32_16x16x32_bf16 v[36:39], a[88:91], a[100:103], v[36:39]
    v_mfma_f32_16x16x32_bf16 v[36:39], a[92:95], a[96:99], v[36:39]
    s_waitcnt lgkmcnt(0)
    v_mfma_f32_16x16x32_bf16 v[8:11], a[0:3], a[32:35], v[8:11]
    ds_read_b128 a[96:99], v213 offset:4032
    ds_read_b64 a[64:65], v212 offset:448
    v_mfma_f32_16x16x32_bf16 v[20:23], a[0:3], a[44:47], v[20:23]
    ds_read_b64 a[66:67], v212 offset:456
    ds_read_b128 a[100:103], v213 offset:3520
    v_mfma_f32_16x16x32_bf16 v[24:27], a[0:3], a[48:51], v[24:27]
    ds_read_b64 a[68:69], v212 offset:960
    ds_read_b64 a[70:71], v212 offset:968
    ds_read_b128 a[104:107], v213 offset:3008
    v_mfma_f32_16x16x32_bf16 v[36:39], a[0:3], a[60:63], v[36:39]
    ds_read_b64 a[72:73], v212 offset:1472
    ds_read_b64 a[74:75], v212 offset:1480
    v_mfma_f32_16x16x32_bf16 v[20:23], a[4:7], a[40:43], v[20:23]
    ds_read_b128 a[108:111], v213 offset:2496
    ds_read_b64 a[76:77], v212 offset:1984
    ds_read_b64 a[78:79], v212 offset:1992
    v_mfma_f32_16x16x32_bf16 v[24:27], a[4:7], a[44:47], v[24:27]
    ds_read_b128 a[112:115], v213 offset:1984
    ds_read_b64 a[80:81], v212 offset:2496
    v_mfma_f32_16x16x32_bf16 v[36:39], a[4:7], a[56:59], v[36:39]
    ds_read_b64 a[82:83], v212 offset:2504
    ds_read_b128 a[116:119], v213 offset:1472
    v_mfma_f32_16x16x32_bf16 v[20:23], a[8:11], a[36:39], v[20:23]
    ds_read_b64 a[84:85], v212 offset:3008
    ds_read_b64 a[86:87], v212 offset:3016
    ds_read_b128 a[120:123], v213 offset:960
    v_mfma_f32_16x16x32_bf16 v[24:27], a[8:11], a[40:43], v[24:27]
    ds_read_b64 a[88:89], v212 offset:3520
    ds_read_b64 a[90:91], v212 offset:3528
    v_mfma_f32_16x16x32_bf16 v[36:39], a[8:11], a[52:55], v[36:39]
    ds_read_b128 a[124:127], v213 offset:448
    ds_read_b64 a[92:93], v212 offset:4032
    ds_read_b64 a[94:95], v212 offset:4040
    v_mfma_f32_16x16x32_bf16 v[20:23], a[12:15], a[32:35], v[20:23]
    buffer_load_dwordx4 v[172:175], v244, s[36:39], s44 offen offset:1024 sc1
    buffer_load_dwordx4 v[176:179], v244, s[36:39], s44 offen offset:2048 sc1
    v_mfma_f32_16x16x32_bf16 v[24:27], a[12:15], a[36:39], v[24:27]
    buffer_load_dwordx4 v[180:183], v244, s[36:39], s44 offen offset:3072 sc1
    buffer_load_dwordx4 v[184:187], v245, s[36:39], s44 offen offset:0 sc1
    s_add_u32 s44, s44, 20480
    v_mfma_f32_16x16x32_bf16 v[36:39], a[12:15], a[48:51], v[36:39]
    v_mfma_f32_16x16x32_bf16 v[24:27], a[16:19], a[32:35], v[24:27]
    v_mfma_f32_16x16x32_bf16 v[36:39], a[16:19], a[44:47], v[36:39]
    v_mfma_f32_16x16x32_bf16 v[36:39], a[20:23], a[40:43], v[36:39]
    v_mfma_f32_16x16x32_bf16 v[36:39], a[24:27], a[36:39], v[36:39]
    v_mfma_f32_16x16x32_bf16 v[36:39], a[28:31], a[32:35], v[36:39]
    s_waitcnt lgkmcnt(0)
    v_mfma_f32_16x16x32_bf16 v[8:11], a[64:67], a[96:99], v[8:11]
    buffer_load_dwordx4 v[188:191], v244, s[36:39], s44 offen offset:0 sc1
    v_mfma_f32_16x16x32_bf16 v[20:23], a[64:67], a[108:111], v[20:23]
    buffer_load_dwordx4 v[192:195], v244, s[36:39], s44 offen offset:1024 sc1
    v_mfma_f32_16x16x32_bf16 v[24:27], a[64:67], a[112:115], v[24:27]
    buffer_load_dwordx4 v[196:199], v244, s[36:39], s44 offen offset:2048 sc1
    v_mfma_f32_16x16x32_bf16 v[36:39], a[64:67], a[124:127], v[36:39]
    buffer_load_dwordx4 v[200:203], v244, s[36:39], s44 offen offset:3072 sc1
    v_mfma_f32_16x16x32_bf16 v[20:23], a[68:71], a[104:107], v[20:23]
    buffer_load_dwordx4 v[204:207], v245, s[36:39], s44 offen offset:0 sc1
    v_mfma_f32_16x16x32_bf16 v[24:27], a[68:71], a[108:111], v[24:27]
    s_add_u32 s44, s44, 20480
    v_mfma_f32_16x16x32_bf16 v[36:39], a[68:71], a[120:123], v[36:39]
    v_mfma_f32_16x16x32_bf16 v[20:23], a[72:75], a[100:103], v[20:23]
    v_mfma_f32_16x16x32_bf16 v[24:27], a[72:75], a[104:107], v[24:27]
    v_mfma_f32_16x16x32_bf16 v[36:39], a[72:75], a[116:119], v[36:39]
    v_mfma_f32_16x16x32_bf16 v[20:23], a[76:79], a[96:99], v[20:23]
    v_mfma_f32_16x16x32_bf16 v[24:27], a[76:79], a[100:103], v[24:27]
    v_mfma_f32_16x16x32_bf16 v[36:39], a[76:79], a[112:115], v[36:39]
    v_mfma_f32_16x16x32_bf16 v[24:27], a[80:83], a[96:99], v[24:27]
    v_mfma_f32_16x16x32_bf16 v[36:39], a[80:83], a[108:111], v[36:39]
    v_mfma_f32_16x16x32_bf16 v[36:39], a[84:87], a[104:107], v[36:39]
    v_mfma_f32_16x16x32_bf16 v[36:39], a[88:91], a[100:103], v[36:39]
    v_mfma_f32_16x16x32_bf16 v[36:39], a[92:95], a[96:99], v[36:39]
    s_nop 7
    v_cvt_pk_bf16_f32 v224, v8, v9
    v_cvt_pk_bf16_f32 v225, v10, v11
    buffer_store_dwordx2 v[224:225], v214, s[88:91], s65 offen offset:0 sc1
    v_cvt_pk_bf16_f32 v226, v20, v21
    v_cvt_pk_bf16_f32 v227, v22, v23
    buffer_store_dwordx2 v[226:227], v214, s[88:91], s65 offen offset:1536 sc1
    v_cvt_pk_bf16_f32 v228, v24, v25
    v_cvt_pk_bf16_f32 v229, v26, v27
    buffer_store_dwordx2 v[228:229], v214, s[88:91], s65 offen offset:2048 sc1
    v_cvt_pk_bf16_f32 v230, v36, v37
    v_cvt_pk_bf16_f32 v231, v38, v39
    buffer_store_dwordx2 v[230:231], v214, s[88:91], s65 offen offset:3584 sc1
    s_branch cve_11
cvh_10:
    s_waitcnt lgkmcnt(0)
    v_mfma_f32_16x16x32_bf16 v[12:15], v[220:223], a[36:39], 0
    ds_read_b128 a[96:99], v213 offset:3648
    v_mfma_f32_16x16x32_bf16 v[16:19], v[220:223], a[40:43], 0
    ds_read_b64 a[64:65], v212 offset:64
    ds_read_b64 a[66:67], v212 offset:72
    v_mfma_f32_16x16x32_bf16 v[28:31], v[220:223], a[52:55], 0
    ds_read_b128 a[100:103], v213 offset:3136
    v_mfma_f32_16x16x32_bf16 v[32:35], v[220:223], a[56:59], 0
    ds_read_b64 a[68:69], v212 offset:576
    ds_read_b64 a[70:71], v212 offset:584
    v_mfma_f32_16x16x32_bf16 v[12:15], a[0:3], a[36:39], v[12:15]
    ds_read_b128 a[104:107], v213 offset:2624
    ds_read_b64 a[72:73], v212 offset:1088
    v_mfma_f32_16x16x32_bf16 v[16:19], a[0:3], a[40:43], v[16:19]
    ds_read_b64 a[74:75], v212 offset:1096
    v_mfma_f32_16x16x32_bf16 v[28:31], a[0:3], a[52:55], v[28:31]
    ds_read_b128 a[108:111], v213 offset:2112
    ds_read_b64 a[76:77], v212 offset:1600
    v_mfma_f32_16x16x32_bf16 v[32:35], a[0:3], a[56:59], v[32:35]
    ds_read_b64 a[78:79], v212 offset:1608
    ds_read_b128 a[112:115], v213 offset:1600
    v_mfma_f32_16x16x32_bf16 v[12:15], a[4:7], a[32:35], v[12:15]
    ds_read_b64 a[80:81], v212 offset:2112
    v_mfma_f32_16x16x32_bf16 v[16:19], a[4:7], a[36:39], v[16:19]
    ds_read_b64 a[82:83], v212 offset:2120
    ds_read_b128 a[116:119], v213 offset:1088
    v_mfma_f32_16x16x32_bf16 v[28:31], a[4:7], a[48:51], v[28:31]
    ds_read_b64 a[84:85], v212 offset:2624
    v_mfma_f32_16x16x32_bf16 v[32:35], a[4:7], a[52:55], v[32:35]
    ds_read_b64 a[86:87], v212 offset:2632
    ds_read_b128 a[120:123], v213 offset:576
    v_mfma_f32_16x16x32_bf16 v[16:19], a[8:11], a[32:35], v[16:19]
    ds_read_b64 a[88:89], v212 offset:3136
    ds_read_b64 a[90:91], v212 offset:3144
    v_mfma_f32_16x16x32_bf16 v[28:31], a[8:11], a[44:47], v[28:31]
    buffer_load_dwordx4 a[196:199], v244, s[36:39], s44 offen offset:1024 sc1
    v_mfma_f32_16x16x32_bf16 v[32:35], a[8:11], a[48:51], v[32:35]
    buffer_load_dwordx4 a[200:203], v244, s[36:39], s44 offen offset:2048 sc1
    buffer_load_dwordx4 a[204:207], v244, s[36:39], s44 offen offset:3072 sc1
    v_mfma_f32_16x16x32_bf16 v[28:31], a[12:15], a[40:43], v[28:31]
    buffer_load_dwordx4 a[208:211], v245, s[36:39], s44 offen offset:0 sc1
    s_add_u32 s44, s44, 20480
    v_mfma_f32_16x16x32_bf16 v[32:35], a[12:15], a[44:47], v[32:35]
    v_mfma_f32_16x16x32_bf16 v[28:31], a[16:19], a[36:39], v[28:31]
    v_mfma_f32_16x16x32_bf16 v[32:35], a[16:19], a[40:43], v[32:35]
    v_mfma_f32_16x16x32_bf16 v[28:31], a[20:23], a[32:35], v[28:31]
    v_mfma_f32_16x16x32_bf16 v[32:35], a[20:23], a[36:39], v[32:35]
    v_mfma_f32_16x16x32_bf16 v[32:35], a[24:27], a[32:35], v[32:35]
    s_waitcnt lgkmcnt(0)
    v_mfma_f32_16x16x32_bf16 v[12:15], a[64:67], a[100:103], v[12:15]
    ds_read_b128 a[32:35], v213 offset:3712
    ds_read_b64 a[0:1], v212 offset:128
    ds_read_b64 a[2:3], v212 offset:136
    ds_read_b128 a[36:39], v213 offset:3200
    v_mfma_f32_16x16x32_bf16 v[16:19], a[64:67], a[104:107], v[16:19]
    ds_read_b64 a[4:5], v212 offset:640
    ds_read_b64 a[6:7], v212 offset:648
    ds_read_b128 a[40:43], v213 offset:2688
    ds_read_b64 a[8:9], v212 offset:1152
    v_mfma_f32_16x16x32_bf16 v[28:31], a[64:67], a[116:119], v[28:31]
    ds_read_b64 a[10:11], v212 offset:1160
    ds_read_b128 a[44:47], v213 offset:2176
    ds_read_b64 a[12:13], v212 offset:1664
    ds_read_b64 a[14:15], v212 offset:1672
    v_mfma_f32_16x16x32_bf16 v[32:35], a[64:67], a[120:123], v[32:35]
    ds_read_b128 a[48:51], v213 offset:1664
    ds_read_b64 a[16:17], v212 offset:2176
    ds_read_b64 a[18:19], v212 offset:2184
    ds_read_b128 a[52:55], v213 offset:1152
    ds_read_b64 a[20:21], v212 offset:2688
    v_mfma_f32_16x16x32_bf16 v[12:15], a[68:71], a[96:99], v[12:15]
    ds_read_b64 a[22:23], v212 offset:2696
    ds_read_b128 a[56:59], v213 offset:640
    ds_read_b64 a[24:25], v212 offset:3200
    ds_read_b64 a[26:27], v212 offset:3208
    v_mfma_f32_16x16x32_bf16 v[16:19], a[68:71], a[100:103], v[16:19]
    v_cvt_pk_bf16_f32 v224, v40, v41
    v_cvt_pk_bf16_f32 v225, v42, v43
    buffer_store_dwordx2 v[224:225], v214, s[88:91], s64 offen offset:0 sc1
    v_cvt_pk_bf16_f32 v226, v44, v45
    v_mfma_f32_16x16x32_bf16 v[28:31], a[68:71], a[112:115], v[28:31]
    v_cvt_pk_bf16_f32 v227, v46, v47
    buffer_store_dwordx2 v[226:227], v214, s[88:91], s64 offen offset:512 sc1
    v_cvt_pk_bf16_f32 v228, v48, v49
    v_cvt_pk_bf16_f32 v229, v50, v51
    v_mfma_f32_16x16x32_bf16 v[32:35], a[68:71], a[116:119], v[32:35]
    buffer_store_dwordx2 v[228:229], v214, s[88:91], s64 offen offset:1024 sc1
    v_cvt_pk_bf16_f32 v230, v52, v53
    v_cvt_pk_bf16_f32 v231, v54, v55
    buffer_store_dwordx2 v[230:231], v214, s[88:91], s64 offen offset:1536 sc1
    v_cvt_pk_bf16_f32 v224, v56, v57
    v_mfma_f32_16x16x32_bf16 v[16:19], a[72:75], a[96:99], v[16:19]
    v_cvt_pk_bf16_f32 v225, v58, v59
    buffer_store_dwordx2 v[224:225], v214, s[88:91], s64 offen offset:2048 sc1
    v_cvt_pk_bf16_f32 v226, v60, v61
    v_cvt_pk_bf16_f32 v227, v62, v63
    v_mfma_f32_16x16x32_bf16 v[28:31], a[72:75], a[108:111], v[28:31]
    buffer_store_dwordx2 v[226:227], v214, s[88:91], s64 offen offset:2560 sc1
    v_cvt_pk_bf16_f32 v228, v64, v65
    v_cvt_pk_bf16_f32 v229, v66, v67
    buffer_store_dwordx2 v[228:229], v214, s[88:91], s64 offen offset:3072 sc1
    v_mfma_f32_16x16x32_bf16 v[32:35], a[72:75], a[112:115], v[32:35]
    v_cvt_pk_bf16_f32 v230, v68, v69
    v_cvt_pk_bf16_f32 v231, v70, v71
    buffer_store_dwordx2 v[230:231], v214, s[88:91], s64 offen offset:3584 sc1
    buffer_load_dwordx4 a[212:215], v244, s[36:39], s44 offen offset:0 sc1
    v_mfma_f32_16x16x32_bf16 v[28:31], a[76:79], a[104:107], v[28:31]
    buffer_load_dwordx4 a[216:219], v244, s[36:39], s44 offen offset:1024 sc1
    buffer_load_dwordx4 a[220:223], v244, s[36:39], s44 offen offset:2048 sc1
    buffer_load_dwordx4 a[224:227], v244, s[36:39], s44 offen offset:3072 sc1
    buffer_load_dwordx4 a[228:231], v245, s[36:39], s44 offen offset:0 sc1
    s_add_u32 s44, s44, 20480
    v_mfma_f32_16x16x32_bf16 v[32:35], a[76:79], a[108:111], v[32:35]
    v_mfma_f32_16x16x32_bf16 v[28:31], a[80:83], a[100:103], v[28:31]
    v_mfma_f32_16x16x32_bf16 v[32:35], a[80:83], a[104:107], v[32:35]
    v_mfma_f32_16x16x32_bf16 v[28:31], a[84:87], a[96:99], v[28:31]
    v_mfma_f32_16x16x32_bf16 v[32:35], a[84:87], a[100:103], v[32:35]
    v_mfma_f32_16x16x32_bf16 v[32:35], a[88:91], a[96:99], v[32:35]
    s_waitcnt lgkmcnt(0)
    v_mfma_f32_16x16x32_bf16 v[12:15], a[0:3], a[36:39], v[12:15]
    ds_read_b128 a[96:99], v213 offset:3776
    ds_read_b64 a[64:65], v212 offset:192
    v_mfma_f32_16x16x32_bf16 v[16:19], a[0:3], a[40:43], v[16:19]
    ds_read_b64 a[66:67], v212 offset:200
    ds_read_b128 a[100:103], v213 offset:3264
    v_mfma_f32_16x16x32_bf16 v[28:31], a[0:3], a[52:55], v[28:31]
    ds_read_b64 a[68:69], v212 offset:704
    ds_read_b64 a[70:71], v212 offset:712
    v_mfma_f32_16x16x32_bf16 v[32:35], a[0:3], a[56:59], v[32:35]
    ds_read_b128 a[104:107], v213 offset:2752
    ds_read_b64 a[72:73], v212 offset:1216
    v_mfma_f32_16x16x32_bf16 v[12:15], a[4:7], a[32:35], v[12:15]
    ds_read_b64 a[74:75], v212 offset:1224
    ds_read_b128 a[108:111], v213 offset:2240
    v_mfma_f32_16x16x32_bf16 v[16:19], a[4:7], a[36:39], v[16:19]
    ds_read_b64 a[76:77], v212 offset:1728
    ds_read_b64 a[78:79], v212 offset:1736
    v_mfma_f32_16x16x32_bf16 v[28:31], a[4:7], a[48:51], v[28:31]
    ds_read_b128 a[112:115], v213 offset:1728
    ds_read_b64 a[80:81], v212 offset:2240
    v_mfma_f32_16x16x32_bf16 v[32:35], a[4:7], a[52:55], v[32:35]
    ds_read_b64 a[82:83], v212 offset:2248
    ds_read_b128 a[116:119], v213 offset:1216
    v_mfma_f32_16x16x32_bf16 v[16:19], a[8:11], a[32:35], v[16:19]
    ds_read_b64 a[84:85], v212 offset:2752
    ds_read_b64 a[86:87], v212 offset:2760
    v_mfma_f32_16x16x32_bf16 v[28:31], a[8:11], a[44:47], v[28:31]
    ds_read_b128 a[120:123], v213 offset:704
    ds_read_b64 a[88:89], v212 offset:3264
    v_mfma_f32_16x16x32_bf16 v[32:35], a[8:11], a[48:51], v[32:35]
    ds_read_b64 a[90:91], v212 offset:3272
    buffer_load_dwordx4 a[232:235], v244, s[36:39], s44 offen offset:0 sc1
    v_mfma_f32_16x16x32_bf16 v[28:31], a[12:15], a[40:43], v[28:31]
    buffer_load_dwordx4 a[236:239], v244, s[36:39], s44 offen offset:1024 sc1
    buffer_load_dwordx4 a[240:243], v244, s[36:39], s44 offen offset:2048 sc1
    buffer_load_dwordx4 a[244:247], v244, s[36:39], s44 offen offset:3072 sc1
    v_mfma_f32_16x16x32_bf16 v[32:35], a[12:15], a[44:47], v[32:35]
    v_mfma_f32_16x16x32_bf16 v[28:31], a[16:19], a[36:39], v[28:31]
    v_mfma_f32_16x16x32_bf16 v[32:35], a[16:19], a[40:43], v[32:35]
    v_mfma_f32_16x16x32_bf16 v[28:31], a[20:23], a[32:35], v[28:31]
    v_mfma_f32_16x16x32_bf16 v[32:35], a[20:23], a[36:39], v[32:35]
    v_mfma_f32_16x16x32_bf16 v[32:35], a[24:27], a[32:35], v[32:35]
    s_waitcnt lgkmcnt(0)
    v_mfma_f32_16x16x32_bf16 v[12:15], a[64:67], a[100:103], v[12:15]
    ds_read_b128 a[32:35], v213 offset:3840
    ds_read_b64 a[0:1], v212 offset:256
    v_mfma_f32_16x16x32_bf16 v[16:19], a[64:67], a[104:107], v[16:19]
    ds_read_b64 a[2:3], v212 offset:264
    ds_read_b128 a[36:39], v213 offset:3328
    v_mfma_f32_16x16x32_bf16 v[28:31], a[64:67], a[116:119], v[28:31]
    ds_read_b64 a[4:5], v212 offset:768
    ds_read_b64 a[6:7], v212 offset:776
    v_mfma_f32_16x16x32_bf16 v[32:35], a[64:67], a[120:123], v[32:35]
    ds_read_b128 a[40:43], v213 offset:2816
    ds_read_b64 a[8:9], v212 offset:1280
    v_mfma_f32_16x16x32_bf16 v[12:15], a[68:71], a[96:99], v[12:15]
    ds_read_b64 a[10:11], v212 offset:1288
    ds_read_b128 a[44:47], v213 offset:2304
    v_mfma_f32_16x16x32_bf16 v[16:19], a[68:71], a[100:103], v[16:19]
    ds_read_b64 a[12:13], v212 offset:1792
    ds_read_b64 a[14:15], v212 offset:1800
    ds_read_b128 a[48:51], v213 offset:1792
    v_mfma_f32_16x16x32_bf16 v[28:31], a[68:71], a[112:115], v[28:31]
    ds_read_b64 a[16:17], v212 offset:2304
    ds_read_b64 a[18:19], v212 offset:2312
    v_mfma_f32_16x16x32_bf16 v[32:35], a[68:71], a[116:119], v[32:35]
    ds_read_b128 a[52:55], v213 offset:1280
    ds_read_b64 a[20:21], v212 offset:2816
    v_mfma_f32_16x16x32_bf16 v[16:19], a[72:75], a[96:99], v[16:19]
    ds_read_b64 a[22:23], v212 offset:2824
    ds_read_b128 a[56:59], v213 offset:768
    v_mfma_f32_16x16x32_bf16 v[28:31], a[72:75], a[108:111], v[28:31]
    ds_read_b64 a[24:25], v212 offset:3328
    ds_read_b64 a[26:27], v212 offset:3336
    v_mfma_f32_16x16x32_bf16 v[32:35], a[72:75], a[112:115], v[32:35]
    buffer_load_dwordx4 a[248:251], v245, s[36:39], s44 offen offset:0 sc1
    s_add_u32 s44, s44, 20480
    v_mfma_f32_16x16x32_bf16 v[28:31], a[76:79], a[104:107], v[28:31]
    buffer_load_dwordx4 v[80:83], v244, s[36:39], s44 offen offset:0 sc1
    buffer_load_dwordx4 v[84:87], v244, s[36:39], s44 offen offset:1024 sc1
    buffer_load_dwordx4 v[88:91], v244, s[36:39], s44 offen offset:2048 sc1
    v_mfma_f32_16x16x32_bf16 v[32:35], a[76:79], a[108:111], v[32:35]
    v_mfma_f32_16x16x32_bf16 v[28:31], a[80:83], a[100:103], v[28:31]
    v_mfma_f32_16x16x32_bf16 v[32:35], a[80:83], a[104:107], v[32:35]
    v_mfma_f32_16x16x32_bf16 v[28:31], a[84:87], a[96:99], v[28:31]
    v_mfma_f32_16x16x32_bf16 v[32:35], a[84:87], a[100:103], v[32:35]
    v_mfma_f32_16x16x32_bf16 v[32:35], a[88:91], a[96:99], v[32:35]
    s_waitcnt lgkmcnt(0)
    v_mfma_f32_16x16x32_bf16 v[12:15], a[0:3], a[36:39], v[12:15]
    ds_read_b128 a[96:99], v213 offset:3904
    ds_read_b64 a[64:65], v212 offset:320
    v_mfma_f32_16x16x32_bf16 v[16:19], a[0:3], a[40:43], v[16:19]
    ds_read_b64 a[66:67], v212 offset:328
    ds_read_b128 a[100:103], v213 offset:3392
    v_mfma_f32_16x16x32_bf16 v[28:31], a[0:3], a[52:55], v[28:31]
    ds_read_b64 a[68:69], v212 offset:832
    ds_read_b64 a[70:71], v212 offset:840
    v_mfma_f32_16x16x32_bf16 v[32:35], a[0:3], a[56:59], v[32:35]
    ds_read_b128 a[104:107], v213 offset:2880
    ds_read_b64 a[72:73], v212 offset:1344
    v_mfma_f32_16x16x32_bf16 v[12:15], a[4:7], a[32:35], v[12:15]
    ds_read_b64 a[74:75], v212 offset:1352
    ds_read_b128 a[108:111], v213 offset:2368
    v_mfma_f32_16x16x32_bf16 v[16:19], a[4:7], a[36:39], v[16:19]
    ds_read_b64 a[76:77], v212 offset:1856
    ds_read_b64 a[78:79], v212 offset:1864
    ds_read_b128 a[112:115], v213 offset:1856
    v_mfma_f32_16x16x32_bf16 v[28:31], a[4:7], a[48:51], v[28:31]
    ds_read_b64 a[80:81], v212 offset:2368
    ds_read_b64 a[82:83], v212 offset:2376
    v_mfma_f32_16x16x32_bf16 v[32:35], a[4:7], a[52:55], v[32:35]
    ds_read_b128 a[116:119], v213 offset:1344
    ds_read_b64 a[84:85], v212 offset:2880
    v_mfma_f32_16x16x32_bf16 v[16:19], a[8:11], a[32:35], v[16:19]
    ds_read_b64 a[86:87], v212 offset:2888
    ds_read_b128 a[120:123], v213 offset:832
    v_mfma_f32_16x16x32_bf16 v[28:31], a[8:11], a[44:47], v[28:31]
    ds_read_b64 a[88:89], v212 offset:3392
    ds_read_b64 a[90:91], v212 offset:3400
    v_mfma_f32_16x16x32_bf16 v[32:35], a[8:11], a[48:51], v[32:35]
    buffer_load_dwordx4 v[92:95], v244, s[36:39], s44 offen offset:3072 sc1
    buffer_load_dwordx4 v[96:99], v245, s[36:39], s44 offen offset:0 sc1
    v_mfma_f32_16x16x32_bf16 v[28:31], a[12:15], a[40:43], v[28:31]
    s_add_u32 s44, s44, 20480
    buffer_load_dwordx4 v[100:103], v244, s[36:39], s44 offen offset:0 sc1
    buffer_load_dwordx4 v[104:107], v244, s[36:39], s44 offen offset:1024 sc1
    v_mfma_f32_16x16x32_bf16 v[32:35], a[12:15], a[44:47], v[32:35]
    v_mfma_f32_16x16x32_bf16 v[28:31], a[16:19], a[36:39], v[28:31]
    v_mfma_f32_16x16x32_bf16 v[32:35], a[16:19], a[40:43], v[32:35]
    v_mfma_f32_16x16x32_bf16 v[28:31], a[20:23], a[32:35], v[28:31]
    v_mfma_f32_16x16x32_bf16 v[32:35], a[20:23], a[36:39], v[32:35]
    v_mfma_f32_16x16x32_bf16 v[32:35], a[24:27], a[32:35], v[32:35]
    s_waitcnt lgkmcnt(0)
    v_mfma_f32_16x16x32_bf16 v[12:15], a[64:67], a[100:103], v[12:15]
    ds_read_b128 a[32:35], v213 offset:3968
    ds_read_b64 a[0:1], v212 offset:384
    v_mfma_f32_16x16x32_bf16 v[16:19], a[64:67], a[104:107], v[16:19]
    ds_read_b64 a[2:3], v212 offset:392
    ds_read_b128 a[36:39], v213 offset:3456
    v_mfma_f32_16x16x32_bf16 v[28:31], a[64:67], a[116:119], v[28:31]
    ds_read_b64 a[4:5], v212 offset:896
    ds_read_b64 a[6:7], v212 offset:904
    v_mfma_f32_16x16x32_bf16 v[32:35], a[64:67], a[120:123], v[32:35]
    ds_read_b128 a[40:43], v213 offset:2944
    ds_read_b64 a[8:9], v212 offset:1408
    v_mfma_f32_16x16x32_bf16 v[12:15], a[68:71], a[96:99], v[12:15]
    ds_read_b64 a[10:11], v212 offset:1416
    ds_read_b128 a[44:47], v213 offset:2432
    v_mfma_f32_16x16x32_bf16 v[16:19], a[68:71], a[100:103], v[16:19]
    ds_read_b64 a[12:13], v212 offset:1920
    ds_read_b64 a[14:15], v212 offset:1928
    ds_read_b128 a[48:51], v213 offset:1920
    v_mfma_f32_16x16x32_bf16 v[28:31], a[68:71], a[112:115], v[28:31]
    ds_read_b64 a[16:17], v212 offset:2432
    ds_read_b64 a[18:19], v212 offset:2440
    v_mfma_f32_16x16x32_bf16 v[32:35], a[68:71], a[116:119], v[32:35]
    ds_read_b128 a[52:55], v213 offset:1408
    ds_read_b64 a[20:21], v212 offset:2944
    v_mfma_f32_16x16x32_bf16 v[16:19], a[72:75], a[96:99], v[16:19]
    ds_read_b64 a[22:23], v212 offset:2952
    ds_read_b128 a[56:59], v213 offset:896
    v_mfma_f32_16x16x32_bf16 v[28:31], a[72:75], a[108:111], v[28:31]
    ds_read_b64 a[24:25], v212 offset:3456
    ds_read_b64 a[26:27], v212 offset:3464
    v_mfma_f32_16x16x32_bf16 v[32:35], a[72:75], a[112:115], v[32:35]
    buffer_load_dwordx4 v[108:111], v244, s[36:39], s44 offen offset:2048 sc1
    buffer_load_dwordx4 v[112:115], v244, s[36:39], s44 offen offset:3072 sc1
    v_mfma_f32_16x16x32_bf16 v[28:31], a[76:79], a[104:107], v[28:31]
    buffer_load_dwordx4 v[116:119], v245, s[36:39], s44 offen offset:0 sc1
    s_add_u32 s44, s44, 20480
    buffer_load_dwordx4 v[168:171], v244, s[36:39], s44 offen offset:0 sc1
    v_mfma_f32_16x16x32_bf16 v[32:35], a[76:79], a[108:111], v[32:35]
    v_mfma_f32_16x16x32_bf16 v[28:31], a[80:83], a[100:103], v[28:31]
    v_mfma_f32_16x16x32_bf16 v[32:35], a[80:83], a[104:107], v[32:35]
    v_mfma_f32_16x16x32_bf16 v[28:31], a[84:87], a[96:99], v[28:31]
    v_mfma_f32_16x16x32_bf16 v[32:35], a[84:87], a[100:103], v[32:35]
    v_mfma_f32_16x16x32_bf16 v[32:35], a[88:91], a[96:99], v[32:35]
    s_waitcnt lgkmcnt(0)
    v_mfma_f32_16x16x32_bf16 v[12:15], a[0:3], a[36:39], v[12:15]
    ds_read_b128 a[96:99], v213 offset:4032
    ds_read_b64 a[64:65], v212 offset:448
    v_mfma_f32_16x16x32_bf16 v[16:19], a[0:3], a[40:43], v[16:19]
    ds_read_b64 a[66:67], v212 offset:456
    ds_read_b128 a[100:103], v213 offset:3520
    v_mfma_f32_16x16x32_bf16 v[28:31], a[0:3], a[52:55], v[28:31]
    ds_read_b64 a[68:69], v212 offset:960
    ds_read_b64 a[70:71], v212 offset:968
    v_mfma_f32_16x16x32_bf16 v[32:35], a[0:3], a[56:59], v[32:35]
    ds_read_b128 a[104:107], v213 offset:3008
    ds_read_b64 a[72:73], v212 offset:1472
    v_mfma_f32_16x16x32_bf16 v[12:15], a[4:7], a[32:35], v[12:15]
    ds_read_b64 a[74:75], v212 offset:1480
    ds_read_b128 a[108:111], v213 offset:2496
    v_mfma_f32_16x16x32_bf16 v[16:19], a[4:7], a[36:39], v[16:19]
    ds_read_b64 a[76:77], v212 offset:1984
    ds_read_b64 a[78:79], v212 offset:1992
    ds_read_b128 a[112:115], v213 offset:1984
    v_mfma_f32_16x16x32_bf16 v[28:31], a[4:7], a[48:51], v[28:31]
    ds_read_b64 a[80:81], v212 offset:2496
    ds_read_b64 a[82:83], v212 offset:2504
    v_mfma_f32_16x16x32_bf16 v[32:35], a[4:7], a[52:55], v[32:35]
    ds_read_b128 a[116:119], v213 offset:1472
    ds_read_b64 a[84:85], v212 offset:3008
    v_mfma_f32_16x16x32_bf16 v[16:19], a[8:11], a[32:35], v[16:19]
    ds_read_b64 a[86:87], v212 offset:3016
    ds_read_b128 a[120:123], v213 offset:960
    v_mfma_f32_16x16x32_bf16 v[28:31], a[8:11], a[44:47], v[28:31]
    ds_read_b64 a[88:89], v212 offset:3520
    ds_read_b64 a[90:91], v212 offset:3528
    v_mfma_f32_16x16x32_bf16 v[32:35], a[8:11], a[48:51], v[32:35]
    buffer_load_dwordx4 v[172:175], v244, s[36:39], s44 offen offset:1024 sc1
    buffer_load_dwordx4 v[176:179], v244, s[36:39], s44 offen offset:2048 sc1
    v_mfma_f32_16x16x32_bf16 v[28:31], a[12:15], a[40:43], v[28:31]
    buffer_load_dwordx4 v[180:183], v244, s[36:39], s44 offen offset:3072 sc1
    buffer_load_dwordx4 v[184:187], v245, s[36:39], s44 offen offset:0 sc1
    s_add_u32 s44, s44, 20480
    v_mfma_f32_16x16x32_bf16 v[32:35], a[12:15], a[44:47], v[32:35]
    v_mfma_f32_16x16x32_bf16 v[28:31], a[16:19], a[36:39], v[28:31]
    v_mfma_f32_16x16x32_bf16 v[32:35], a[16:19], a[40:43], v[32:35]
    v_mfma_f32_16x16x32_bf16 v[28:31], a[20:23], a[32:35], v[28:31]
    v_mfma_f32_16x16x32_bf16 v[32:35], a[20:23], a[36:39], v[32:35]
    v_mfma_f32_16x16x32_bf16 v[32:35], a[24:27], a[32:35], v[32:35]
    s_waitcnt lgkmcnt(0)
    v_mfma_f32_16x16x32_bf16 v[12:15], a[64:67], a[100:103], v[12:15]
    buffer_load_dwordx4 v[188:191], v244, s[36:39], s44 offen offset:0 sc1
    v_mfma_f32_16x16x32_bf16 v[16:19], a[64:67], a[104:107], v[16:19]
    buffer_load_dwordx4 v[192:195], v244, s[36:39], s44 offen offset:1024 sc1
    v_mfma_f32_16x16x32_bf16 v[28:31], a[64:67], a[116:119], v[28:31]
    buffer_load_dwordx4 v[196:199], v244, s[36:39], s44 offen offset:2048 sc1
    v_mfma_f32_16x16x32_bf16 v[32:35], a[64:67], a[120:123], v[32:35]
    buffer_load_dwordx4 v[200:203], v244, s[36:39], s44 offen offset:3072 sc1
    v_mfma_f32_16x16x32_bf16 v[12:15], a[68:71], a[96:99], v[12:15]
    buffer_load_dwordx4 v[204:207], v245, s[36:39], s44 offen offset:0 sc1
    v_mfma_f32_16x16x32_bf16 v[16:19], a[68:71], a[100:103], v[16:19]
    s_add_u32 s44, s44, 20480
    v_mfma_f32_16x16x32_bf16 v[28:31], a[68:71], a[112:115], v[28:31]
    v_mfma_f32_16x16x32_bf16 v[32:35], a[68:71], a[116:119], v[32:35]
    v_mfma_f32_16x16x32_bf16 v[16:19], a[72:75], a[96:99], v[16:19]
    v_mfma_f32_16x16x32_bf16 v[28:31], a[72:75], a[108:111], v[28:31]
    v_mfma_f32_16x16x32_bf16 v[32:35], a[72:75], a[112:115], v[32:35]
    v_mfma_f32_16x16x32_bf16 v[28:31], a[76:79], a[104:107], v[28:31]
    v_mfma_f32_16x16x32_bf16 v[32:35], a[76:79], a[108:111], v[32:35]
    v_mfma_f32_16x16x32_bf16 v[28:31], a[80:83], a[100:103], v[28:31]
    v_mfma_f32_16x16x32_bf16 v[32:35], a[80:83], a[104:107], v[32:35]
    v_mfma_f32_16x16x32_bf16 v[28:31], a[84:87], a[96:99], v[28:31]
    v_mfma_f32_16x16x32_bf16 v[32:35], a[84:87], a[100:103], v[32:35]
    v_mfma_f32_16x16x32_bf16 v[32:35], a[88:91], a[96:99], v[32:35]
    s_nop 7
    v_cvt_pk_bf16_f32 v224, v12, v13
    v_cvt_pk_bf16_f32 v225, v14, v15
    buffer_store_dwordx2 v[224:225], v214, s[88:91], s65 offen offset:512 sc1
    v_cvt_pk_bf16_f32 v226, v16, v17
    v_cvt_pk_bf16_f32 v227, v18, v19
    buffer_store_dwordx2 v[226:227], v214, s[88:91], s65 offen offset:1024 sc1
    v_cvt_pk_bf16_f32 v228, v28, v29
    v_cvt_pk_bf16_f32 v229, v30, v31
    buffer_store_dwordx2 v[228:229], v214, s[88:91], s65 offen offset:2560 sc1
    v_cvt_pk_bf16_f32 v230, v32, v33
    v_cvt_pk_bf16_f32 v231, v34, v35
    buffer_store_dwordx2 v[230:231], v214, s[88:91], s65 offen offset:3072 sc1
cve_11:
    s_barrier
    s_mov_b32 s57, s44
    s_mov_b32 s72, s45
    s_add_u32 s32, s28, 16777216
    s_addc_u32 s33, s29, 0
    s_mov_b32 s34, 2211840
    s_mov_b32 s35, 0x20000
    s_add_u32 s68, s28, 12648448
    s_addc_u32 s69, s29, 0
    s_mov_b32 s70, 278528
    s_mov_b32 s71, 0x20000
    s_mul_i32 s58, s3, 40960
    s_cmp_lt_u32 s3, 2
    s_cselect_b32 s61, 0, 0x40000000
    v_mov_b32 v250, s100
    s_and_b32 s94, s2, 7
    s_lshr_b32 s95, s2, 3
    s_lshr_b32 s30, s95, 3
    s_and_b32 s31, s95, 7
    s_lshr_b32 s96, s94, 0
    s_mul_i32 s96, s96, 4
    s_add_u32 s30, s30, s96
    s_and_b32 s96, s94, 0
    s_lshl_b32 s96, s96, 3
    s_add_u32 s31, s31, s96
    s_mul_i32 s56, s31, 160
    s_add_u32 m0, s58, 15360
    s_nop 0
    buffer_load_dwordx4 v244, s[32:35], s57 offen offset:0 sc1 lds
    buffer_load_dwordx4 v244, s[32:35], s57 offen offset:1024 sc1 lds
    buffer_load_dwordx4 v244, s[32:35], s57 offen offset:2048 sc1 lds
    buffer_load_dwordx4 v244, s[32:35], s57 offen offset:3072 sc1 lds
    s_add_u32 m0, s58, 19456
    s_nop 0
    buffer_load_dwordx4 v245, s[32:35], s57 offen offset:0 sc1 lds
    s_add_u32 s57, s57, 20480
    s_waitcnt vmcnt(5)
    buffer_store_dword v250, v249, s[68:71], 0 offen sc1
f_join:
    s_add_u32 m0, s58, 10240
    s_nop 0
    buffer_load_dwordx4 v244, s[32:35], s57 offen offset:0 sc1 lds
    s_add_u32 s36, s28, 5242880
    s_addc_u32 s37, s29, 0
    s_mov_b32 s38, 7077888
    s_mov_b32 s39, 0x20000
    s_add_u32 s40, s28, 2621440
    s_addc_u32 s41, s29, 0
    s_mov_b32 s42, 2621440
    s_mov_b32 s43, 0x20000
    s_mov_b32 s44, s4
    s_mov_b32 s45, s5
    s_mov_b32 s46, 2621440
    s_mov_b32 s47, 0x20000
    s_add_u32 s48, s28, 12582912
    s_addc_u32 s49, s29, 0
    buffer_load_dwordx4 v244, s[32:35], s57 offen offset:1024 sc1 lds
    s_mov_b32 s50, 16384
    s_mov_b32 s51, 0x20000
    s_mov_b32 s52, s24
    s_mov_b32 s53, s25
    s_mov_b32 s54, 2621440
    s_mov_b32 s55, 0x20000
    v_lshlrev_b32 v8, 4, v0
    s_add_u32 s60, s3, 0
    s_and_b32 s60, s60, 3
    s_mul_i32 s60, s60, 55296
    v_add_u32 v133, s60, v8
    s_add_u32 s60, s3, 1
    buffer_load_dwordx4 v244, s[32:35], s57 offen offset:2048 sc1 lds
    s_and_b32 s60, s60, 3
    s_mul_i32 s60, s60, 55296
    v_add_u32 v134, s60, v8
    s_sub_u32 s60, s3, 1
    s_and_b32 s60, s60, 3
    s_mul_i32 s60, s60, 40960
    v_add_u32 v145, s60, v8
    s_add_u32 s60, s3, 2
    s_and_b32 s60, s60, 3
    s_mul_i32 s60, s60, 55296
    v_add_u32 v135, s60, v8
    s_sub_u32 s60, s3, 2
    buffer_load_dwordx4 v244, s[32:35], s57 offen offset:3072 sc1 lds
    s_and_b32 s60, s60, 3
    s_mul_i32 s60, s60, 40960
    v_add_u32 v146, s60, v8
    s_add_u32 s60, s3, 3
    s_and_b32 s60, s60, 3
    s_mul_i32 s60, s60, 55296
    v_add_u32 v136, s60, v8
    s_sub_u32 s60, s3, 3
    s_and_b32 s60, s60, 3
    s_mul_i32 s60, s60, 40960
    v_add_u32 v147, s60, v8
    s_mul_i32 s59, s30, 221184
    s_add_u32 m0, s58, 14336
    s_nop 0
    buffer_load_dwordx4 v245, s[32:35], s57 offen offset:0 sc1 lds
    s_add_u32 s57, s57, 20480
    s_lshl_b32 s60, s3, 10
    s_add_u32 s59, s59, s60
    v_lshrrev_b32 v2, 4, v0
    v_bfe_u32 v3, v0, 2, 2
    v_and_b32 v4, 3, v0
    v_lshl_add_u32 v5, v2, 2, v3
    v_bfe_u32 v6, v5, 1, 2
    v_lshlrev_b32 v6, 1, v6
    v_lshrrev_b32 v7, 1, v4
    s_lshl_b32 s60, s3, 1
    v_add_u32 v7, s60, v7
    v_xor_b32 v7, v7, v6
    s_add_u32 m0, s58, 5120
    s_nop 0
    buffer_load_dwordx4 v244, s[32:35], s57 offen offset:0 sc1 lds
    v_lshlrev_b32 v7, 4, v7
    v_and_b32 v6, 7, v5
    v_lshl_add_u32 v7, v6, 7, v7
    v_lshrrev_b32 v6, 3, v5
    v_lshl_add_u32 v7, v6, 10, v7
    v_add_u32 v7, 117760, v7
    v_and_b32 v6, 1, v4
    v_lshl_add_u32 v138, v6, 3, v7
    v_lshrrev_b32 v7, 1, v4
    v_add_u32 v7, s60, v7
    v_and_b32 v5, 2, v3
    v_xor_b32 v7, v7, v5
    buffer_load_dwordx4 v244, s[32:35], s57 offen offset:1024 sc1 lds
    v_lshlrev_b32 v7, 4, v7
    v_lshl_add_u32 v7, v3, 7, v7
    v_lshl_add_u32 v7, v6, 3, v7
    v_lshlrev_b32 v5, 10, v2
    v_add_u32 v5, 117760, v5
    v_add_u32 v139, v7, v5
    v_xor_b32 v7, 64, v7
    v_add_u32 v153, v7, v5
    v_add_u32 v140, s58, v8
    s_lshl_b32 s62, s30, 6
    s_lshl_b32 s60, s3, 4
    s_add_u32 s62, s62, s60
    buffer_load_dwordx4 v244, s[32:35], s57 offen offset:2048 sc1 lds
    s_mul_i32 s63, s62, 1280
    s_add_u32 s63, s63, s56
    s_lshl_b32 s62, s62, 3
    v_and_b32 v5, 9, v0
    v_bfe_u32 v6, v0, 1, 1
    v_lshl_add_u32 v5, v6, 2, v5
    v_bfe_u32 v6, v0, 2, 1
    v_lshl_add_u32 v5, v6, 1, v5
    v_lshlrev_b32 v149, 3, v5
    v_mul_u32_u24 v5, 1280, v5
    v_lshl_add_u32 v143, v2, 4, v5
    v_lshl_add_u32 v144, v2, 3, v5
    buffer_load_dwordx4 v244, s[32:35], s57 offen offset:3072 sc1 lds
    v_lshrrev_b32 v2, 3, v0
    v_bfe_u32 v3, v0, 4, 2
    v_lshlrev_b32 v3, 1, v3
    v_and_b32 v4, 7, v0
    v_xor_b32 v4, v4, v3
    v_lshlrev_b32 v4, 4, v4
    v_lshl_add_u32 v152, v2, 12, v4
    s_mul_i32 s64, s31, 327680
    s_lshl_b32 s60, s30, 7
    s_add_u32 s64, s64, s60
    s_and_b32 s65, s3, 1
    s_mul_i32 s60, s65, 163840
    s_add_u32 m0, s58, 9216
    s_nop 0
    buffer_load_dwordx4 v245, s[32:35], s57 offen offset:0 sc1 lds
    s_add_u32 s57, s57, 20480
    s_add_u32 s64, s64, s60
    s_mul_i32 s65, s65, 5120
    s_add_u32 s65, s65, 117760
    v_lshlrev_b32 v154, 2, v0
    v_min_u32 v128, 23, v0
    v_lshlrev_b32 v128, 2, v128
    v_add_u32 v128, 512, v128
    v_max_u32 v129, 128, v154
    s_mov_b32 s74, 0xffffff
    s_mov_b32 s75, 0
    s_mov_b32 s76, 0
    s_mov_b32 s77, -1
    s_cmp_lg_u32 s3, 3
    s_cbranch_scc1 f_hok
    s_mov_b32 s73, 30000
poll_12:
    buffer_load_dword v2, v128, s[68:71], s72 offen sc1
    s_waitcnt vmcnt(0)
    v_cmp_ne_u32 vcc, s100, v2
    s_and_b64 vcc, vcc, s[74:75]
    s_cbranch_vccz polld_13
    s_sub_u32 s73, s73, 1
    s_cbranch_scc0 poll_12
polld_13:
f_hok:
    s_barrier
    s_add_u32 s67, s59, 0
    buffer_load_dwordx4 a[0:3], v133, s[36:39], s67 offen sc1
    buffer_load_dwordx4 a[4:7], v134, s[36:39], s67 offen sc1
    buffer_load_dwordx4 a[8:11], v135, s[36:39], s67 offen sc1
    buffer_load_dwordx4 a[12:15], v136, s[36:39], s67 offen sc1
    s_add_u32 s67, s59, 4096
    buffer_load_dwordx4 a[16:19], v133, s[36:39], s67 offen sc1
    buffer_load_dwordx4 a[20:23], v134, s[36:39], s67 offen sc1
    buffer_load_dwordx4 a[24:27], v135, s[36:39], s67 offen sc1
    buffer_load_dwordx4 a[28:31], v136, s[36:39], s67 offen sc1
    s_add_u32 s67, s59, 8192
    buffer_load_dwordx4 a[32:35], v133, s[36:39], s67 offen sc1
    buffer_load_dwordx4 a[36:39], v134, s[36:39], s67 offen sc1
    buffer_load_dwordx4 a[40:43], v135, s[36:39], s67 offen sc1
    buffer_load_dwordx4 a[44:47], v136, s[36:39], s67 offen sc1
    s_waitcnt vmcnt(8)
    v_mfma_f32_16x16x32_bf16 v[8:11], a[132:135], a[0:3], 0
    s_add_u32 m0, s58, 0
    v_mfma_f32_16x16x32_bf16 v[12:15], a[136:139], a[0:3], 0
    s_add_u32 s57, s57, s61
    v_mfma_f32_16x16x32_bf16 v[16:19], a[140:143], a[0:3], 0
    buffer_load_dwordx4 v244, s[32:35], s57 offen offset:0 sc1 lds
    v_mfma_f32_16x16x32_bf16 v[20:23], a[144:147], a[0:3], 0
    buffer_load_dwordx4 v244, s[32:35], s57 offen offset:1024 sc1 lds
    v_mfma_f32_16x16x32_bf16 v[24:27], a[148:151], a[0:3], 0
    buffer_load_dwordx4 v244, s[32:35], s57 offen offset:2048 sc1 lds
    v_mfma_f32_16x16x32_bf16 v[28:31], a[132:135], a[4:7], 0
    buffer_load_dwordx4 v244, s[32:35], s57 offen offset:3072 sc1 lds
    v_mfma_f32_16x16x32_bf16 v[32:35], a[136:139], a[4:7], 0
    s_add_u32 m0, s58, 4096
    v_mfma_f32_16x16x32_bf16 v[36:39], a[140:143], a[4:7], 0
    s_nop 0
    v_mfma_f32_16x16x32_bf16 v[40:43], a[144:147], a[4:7], 0
    buffer_load_dwordx4 v245, s[32:35], s57 offen offset:0 sc1 lds
    v_mfma_f32_16x16x32_bf16 v[44:47], a[148:151], a[4:7], 0
    s_add_u32 s57, s57, 20480
    v_mfma_f32_16x16x32_bf16 v[48:51], a[132:135], a[8:11], 0
    s_add_u32 s67, s59, 12288
    v_mfma_f32_16x16x32_bf16 v[52:55], a[136:139], a[8:11], 0
    buffer_load_dwordx4 a[48:51], v133, s[36:39], s67 offen sc1
    v_mfma_f32_16x16x32_bf16 v[56:59], a[140:143], a[8:11], 0
    buffer_load_dwordx4 a[52:55], v134, s[36:39], s67 offen sc1
    v_mfma_f32_16x16x32_bf16 v[60:63], a[144:147], a[8:11], 0
    buffer_load_dwordx4 a[56:59], v135, s[36:39], s67 offen sc1
    v_mfma_f32_16x16x32_bf16 v[64:67], a[148:151], a[8:11], 0
    buffer_load_dwordx4 a[60:63], v136, s[36:39], s67 offen sc1
    v_mfma_f32_16x16x32_bf16 v[68:71], a[132:135], a[12:15], 0
    v_mfma_f32_16x16x32_bf16 v[72:75], a[136:139], a[12:15], 0
    v_mfma_f32_16x16x32_bf16 v[76:79], a[140:143], a[12:15], 0
    v_mfma_f32_16x16x32_bf16 v[120:123], a[144:147], a[12:15], 0
    v_mfma_f32_16x16x32_bf16 v[124:127], a[148:151], a[12:15], 0
    s_waitcnt vmcnt(13)
    v_mfma_f32_16x16x32_bf16 v[8:11], a[152:155], a[16:19], v[8:11]
    s_add_u32 s67, s59, 16384
    v_mfma_f32_16x16x32_bf16 v[12:15], a[156:159], a[16:19], v[12:15]
    buffer_load_dwordx4 a[64:67], v133, s[36:39], s67 offen sc1
    v_mfma_f32_16x16x32_bf16 v[16:19], a[160:163], a[16:19], v[16:19]
    buffer_load_dwordx4 a[68:71], v134, s[36:39], s67 offen sc1
    v_mfma_f32_16x16x32_bf16 v[20:23], a[164:167], a[16:19], v[20:23]
    buffer_load_dwordx4 a[72:75], v135, s[36:39], s67 offen sc1
    v_mfma_f32_16x16x32_bf16 v[24:27], a[168:171], a[16:19], v[24:27]
    buffer_load_dwordx4 a[76:79], v136, s[36:39], s67 offen sc1
    v_mfma_f32_16x16x32_bf16 v[28:31], a[152:155], a[20:23], v[28:31]
    v_mfma_f32_16x16x32_bf16 v[32:35], a[156:159], a[20:23], v[32:35]
    v_mfma_f32_16x16x32_bf16 v[36:39], a[160:163], a[20:23], v[36:39]
    v_mfma_f32_16x16x32_bf16 v[40:43], a[164:167], a[20:23], v[40:43]
    v_mfma_f32_16x16x32_bf16 v[44:47], a[168:171], a[20:23], v[44:47]
    v_mfma_f32_16x16x32_bf16 v[48:51], a[152:155], a[24:27], v[48:51]
    v_mfma_f32_16x16x32_bf16 v[52:55], a[156:159], a[24:27], v[52:55]
    v_mfma_f32_16x16x32_bf16 v[56:59], a[160:163], a[24:27], v[56:59]
    v_mfma_f32_16x16x32_bf16 v[60:63], a[164:167], a[24:27], v[60:63]
    v_mfma_f32_16x16x32_bf16 v[64:67], a[168:171], a[24:27], v[64:67]
    v_mfma_f32_16x16x32_bf16 v[68:71], a[152:155], a[28:31], v[68:71]
    v_mfma_f32_16x16x32_bf16 v[72:75], a[156:159], a[28:31], v[72:75]
    v_mfma_f32_16x16x32_bf16 v[76:79], a[160:163], a[28:31], v[76:79]
    v_mfma_f32_16x16x32_bf16 v[120:123], a[164:167], a[28:31], v[120:123]
    v_mfma_f32_16x16x32_bf16 v[124:127], a[168:171], a[28:31], v[124:127]
    s_waitcnt vmcnt(13)
    v_mfma_f32_16x16x32_bf16 v[8:11], a[172:175], a[32:35], v[8:11]
    s_add_u32 s67, s59, 20480
    v_mfma_f32_16x16x32_bf16 v[12:15], a[176:179], a[32:35], v[12:15]
    buffer_load_dwordx4 a[80:83], v133, s[36:39], s67 offen sc1
    v_mfma_f32_16x16x32_bf16 v[16:19], a[180:183], a[32:35], v[16:19]
    buffer_load_dwordx4 a[84:87], v134, s[36:39], s67 offen sc1
    v_mfma_f32_16x16x32_bf16 v[20:23], a[184:187], a[32:35], v[20:23]
    buffer_load_dwordx4 a[88:91], v135, s[36:39], s67 offen sc1
    v_mfma_f32_16x16x32_bf16 v[24:27], a[188:191], a[32:35], v[24:27]
    buffer_load_dwordx4 a[92:95], v136, s[36:39], s67 offen sc1
    v_mfma_f32_16x16x32_bf16 v[28:31], a[172:175], a[36:39], v[28:31]
    v_mfma_f32_16x16x32_bf16 v[32:35], a[176:179], a[36:39], v[32:35]
    v_mfma_f32_16x16x32_bf16 v[36:39], a[180:183], a[36:39], v[36:39]
    v_mfma_f32_16x16x32_bf16 v[40:43], a[184:187], a[36:39], v[40:43]
    v_mfma_f32_16x16x32_bf16 v[44:47], a[188:191], a[36:39], v[44:47]
    v_mfma_f32_16x16x32_bf16 v[48:51], a[172:175], a[40:43], v[48:51]
    v_mfma_f32_16x16x32_bf16 v[52:55], a[176:179], a[40:43], v[52:55]
    v_mfma_f32_16x16x32_bf16 v[56:59], a[180:183], a[40:43], v[56:59]
    v_mfma_f32_16x16x32_bf16 v[60:63], a[184:187], a[40:43], v[60:63]
    v_mfma_f32_16x16x32_bf16 v[64:67], a[188:191], a[40:43], v[64:67]
    v_mfma_f32_16x16x32_bf16 v[68:71], a[172:175], a[44:47], v[68:71]
    v_mfma_f32_16x16x32_bf16 v[72:75], a[176:179], a[44:47], v[72:75]
    v_mfma_f32_16x16x32_bf16 v[76:79], a[180:183], a[44:47], v[76:79]
    v_mfma_f32_16x16x32_bf16 v[120:123], a[184:187], a[44:47], v[120:123]
    v_mfma_f32_16x16x32_bf16 v[124:127], a[188:191], a[44:47], v[124:127]
    s_waitcnt vmcnt(8)
    v_mfma_f32_16x16x32_bf16 v[8:11], a[192:195], a[48:51], v[8:11]
    s_add_u32 s67, s59, 24576
    v_mfma_f32_16x16x32_bf16 v[12:15], a[196:199], a[48:51], v[12:15]
    buffer_load_dwordx4 a[96:99], v133, s[36:39], s67 offen sc1
    v_mfma_f32_16x16x32_bf16 v[16:19], a[200:203], a[48:51], v[16:19]
    buffer_load_dwordx4 a[100:103], v134, s[36:39], s67 offen sc1
    v_mfma_f32_16x16x32_bf16 v[20:23], a[204:207], a[48:51], v[20:23]
    buffer_load_dwordx4 a[104:107], v135, s[36:39], s67 offen sc1
    v_mfma_f32_16x16x32_bf16 v[24:27], a[208:211], a[48:51], v[24:27]
    buffer_load_dwordx4 a[108:111], v136, s[36:39], s67 offen sc1
    v_mfma_f32_16x16x32_bf16 v[28:31], a[192:195], a[52:55], v[28:31]
    v_mfma_f32_16x16x32_bf16 v[32:35], a[196:199], a[52:55], v[32:35]
    v_mfma_f32_16x16x32_bf16 v[36:39], a[200:203], a[52:55], v[36:39]
    v_mfma_f32_16x16x32_bf16 v[40:43], a[204:207], a[52:55], v[40:43]
    v_mfma_f32_16x16x32_bf16 v[44:47], a[208:211], a[52:55], v[44:47]
    v_mfma_f32_16x16x32_bf16 v[48:51], a[192:195], a[56:59], v[48:51]
    v_mfma_f32_16x16x32_bf16 v[52:55], a[196:199], a[56:59], v[52:55]
    v_mfma_f32_16x16x32_bf16 v[56:59], a[200:203], a[56:59], v[56:59]
    v_mfma_f32_16x16x32_bf16 v[60:63], a[204:207], a[56:59], v[60:63]
    v_mfma_f32_16x16x32_bf16 v[64:67], a[208:211], a[56:59], v[64:67]
    v_mfma_f32_16x16x32_bf16 v[68:71], a[192:195], a[60:63], v[68:71]
    v_mfma_f32_16x16x32_bf16 v[72:75], a[196:199], a[60:63], v[72:75]
    v_mfma_f32_16x16x32_bf16 v[76:79], a[200:203], a[60:63], v[76:79]
    v_mfma_f32_16x16x32_bf16 v[120:123], a[204:207], a[60:63], v[120:123]
    v_mfma_f32_16x16x32_bf16 v[124:127], a[208:211], a[60:63], v[124:127]
    s_waitcnt vmcnt(8)
    v_mfma_f32_16x16x32_bf16 v[8:11], a[212:215], a[64:67], v[8:11]
    s_add_u32 s67, s59, 28672
    v_mfma_f32_16x16x32_bf16 v[12:15], a[216:219], a[64:67], v[12:15]
    buffer_load_dwordx4 a[112:115], v133, s[36:39], s67 offen sc1
    v_mfma_f32_16x16x32_bf16 v[16:19], a[220:223], a[64:67], v[16:19]
    buffer_load_dwordx4 a[116:119], v134, s[36:39], s67 offen sc1
    v_mfma_f32_16x16x32_bf16 v[20:23], a[224:227], a[64:67], v[20:23]
    buffer_load_dwordx4 a[120:123], v135, s[36:39], s67 offen sc1
    v_mfma_f32_16x16x32_bf16 v[24:27], a[228:231], a[64:67], v[24:27]
    buffer_load_dwordx4 a[124:127], v136, s[36:39], s67 offen sc1
    v_mfma_f32_16x16x32_bf16 v[28:31], a[212:215], a[68:71], v[28:31]
    v_mfma_f32_16x16x32_bf16 v[32:35], a[216:219], a[68:71], v[32:35]
    v_mfma_f32_16x16x32_bf16 v[36:39], a[220:223], a[68:71], v[36:39]
    v_mfma_f32_16x16x32_bf16 v[40:43], a[224:227], a[68:71], v[40:43]
    v_mfma_f32_16x16x32_bf16 v[44:47], a[228:231], a[68:71], v[44:47]
    v_mfma_f32_16x16x32_bf16 v[48:51], a[212:215], a[72:75], v[48:51]
    v_mfma_f32_16x16x32_bf16 v[52:55], a[216:219], a[72:75], v[52:55]
    v_mfma_f32_16x16x32_bf16 v[56:59], a[220:223], a[72:75], v[56:59]
    v_mfma_f32_16x16x32_bf16 v[60:63], a[224:227], a[72:75], v[60:63]
    v_mfma_f32_16x16x32_bf16 v[64:67], a[228:231], a[72:75], v[64:67]
    v_mfma_f32_16x16x32_bf16 v[68:71], a[212:215], a[76:79], v[68:71]
    v_mfma_f32_16x16x32_bf16 v[72:75], a[216:219], a[76:79], v[72:75]
    v_mfma_f32_16x16x32_bf16 v[76:79], a[220:223], a[76:79], v[76:79]
    v_mfma_f32_16x16x32_bf16 v[120:123], a[224:227], a[76:79], v[120:123]
    v_mfma_f32_16x16x32_bf16 v[124:127], a[228:231], a[76:79], v[124:127]
    s_waitcnt vmcnt(8)
    v_mfma_f32_16x16x32_bf16 v[8:11], a[232:235], a[80:83], v[8:11]
    s_add_u32 s67, s59, 32768
    v_mfma_f32_16x16x32_bf16 v[12:15], a[236:239], a[80:83], v[12:15]
    buffer_load_dwordx4 a[0:3], v133, s[36:39], s67 offen sc1
    v_mfma_f32_16x16x32_bf16 v[16:19], a[240:243], a[80:83], v[16:19]
    buffer_load_dwordx4 a[4:7], v134, s[36:39], s67 offen sc1
    v_mfma_f32_16x16x32_bf16 v[20:23], a[244:247], a[80:83], v[20:23]
    buffer_load_dwordx4 a[8:11], v135, s[36:39], s67 offen sc1
    v_mfma_f32_16x16x32_bf16 v[24:27], a[248:251], a[80:83], v[24:27]
    buffer_load_dwordx4 a[12:15], v136, s[36:39], s67 offen sc1
    v_mfma_f32_16x16x32_bf16 v[28:31], a[232:235], a[84:87], v[28:31]
    v_mfma_f32_16x16x32_bf16 v[32:35], a[236:239], a[84:87], v[32:35]
    v_mfma_f32_16x16x32_bf16 v[36:39], a[240:243], a[84:87], v[36:39]
    v_mfma_f32_16x16x32_bf16 v[40:43], a[244:247], a[84:87], v[40:43]
    v_mfma_f32_16x16x32_bf16 v[44:47], a[248:251], a[84:87], v[44:47]
    v_mfma_f32_16x16x32_bf16 v[48:51], a[232:235], a[88:91], v[48:51]
    v_mfma_f32_16x16x32_bf16 v[52:55], a[236:239], a[88:91], v[52:55]
    v_mfma_f32_16x16x32_bf16 v[56:59], a[240:243], a[88:91], v[56:59]
    v_mfma_f32_16x16x32_bf16 v[60:63], a[244:247], a[88:91], v[60:63]
    v_mfma_f32_16x16x32_bf16 v[64:67], a[248:251], a[88:91], v[64:67]
    v_mfma_f32_16x16x32_bf16 v[68:71], a[232:235], a[92:95], v[68:71]
    v_mfma_f32_16x16x32_bf16 v[72:75], a[236:239], a[92:95], v[72:75]
    v_mfma_f32_16x16x32_bf16 v[76:79], a[240:243], a[92:95], v[76:79]
    v_mfma_f32_16x16x32_bf16 v[120:123], a[244:247], a[92:95], v[120:123]
    v_mfma_f32_16x16x32_bf16 v[124:127], a[248:251], a[92:95], v[124:127]
    s_waitcnt vmcnt(8)
    v_mfma_f32_16x16x32_bf16 v[8:11], v[80:83], a[96:99], v[8:11]
    s_add_u32 s67, s59, 36864
    v_mfma_f32_16x16x32_bf16 v[12:15], v[84:87], a[96:99], v[12:15]
    buffer_load_dwordx4 a[16:19], v133, s[36:39], s67 offen sc1
    v_mfma_f32_16x16x32_bf16 v[16:19], v[88:91], a[96:99], v[16:19]
    buffer_load_dwordx4 a[20:23], v134, s[36:39], s67 offen sc1
    v_mfma_f32_16x16x32_bf16 v[20:23], v[92:95], a[96:99], v[20:23]
    buffer_load_dwordx4 a[24:27], v135, s[36:39], s67 offen sc1
    v_mfma_f32_16x16x32_bf16 v[24:27], v[96:99], a[96:99], v[24:27]
    buffer_load_dwordx4 a[28:31], v136, s[36:39], s67 offen sc1
    v_mfma_f32_16x16x32_bf16 v[28:31], v[80:83], a[100:103], v[28:31]
    v_mfma_f32_16x16x32_bf16 v[32:35], v[84:87], a[100:103], v[32:35]
    v_mfma_f32_16x16x32_bf16 v[36:39], v[88:91], a[100:103], v[36:39]
    v_mfma_f32_16x16x32_bf16 v[40:43], v[92:95], a[100:103], v[40:43]
    v_mfma_f32_16x16x32_bf16 v[44:47], v[96:99], a[100:103], v[44:47]
    v_mfma_f32_16x16x32_bf16 v[48:51], v[80:83], a[104:107], v[48:51]
    v_mfma_f32_16x16x32_bf16 v[52:55], v[84:87], a[104:107], v[52:55]
    v_mfma_f32_16x16x32_bf16 v[56:59], v[88:91], a[104:107], v[56:59]
    v_mfma_f32_16x16x32_bf16 v[60:63], v[92:95], a[104:107], v[60:63]
    v_mfma_f32_16x16x32_bf16 v[64:67], v[96:99], a[104:107], v[64:67]
    v_mfma_f32_16x16x32_bf16 v[68:71], v[80:83], a[108:111], v[68:71]
    v_mfma_f32_16x16x32_bf16 v[72:75], v[84:87], a[108:111], v[72:75]
    v_mfma_f32_16x16x32_bf16 v[76:79], v[88:91], a[108:111], v[76:79]
    v_mfma_f32_16x16x32_bf16 v[120:123], v[92:95], a[108:111], v[120:123]
    v_mfma_f32_16x16x32_bf16 v[124:127], v[96:99], a[108:111], v[124:127]
    s_waitcnt vmcnt(8)
    v_mfma_f32_16x16x32_bf16 v[8:11], v[100:103], a[112:115], v[8:11]
    s_add_u32 s67, s59, 40960
    v_mfma_f32_16x16x32_bf16 v[12:15], v[104:107], a[112:115], v[12:15]
    buffer_load_dwordx4 a[32:35], v133, s[36:39], s67 offen sc1
    v_mfma_f32_16x16x32_bf16 v[16:19], v[108:111], a[112:115], v[16:19]
    buffer_load_dwordx4 a[36:39], v134, s[36:39], s67 offen sc1
    v_mfma_f32_16x16x32_bf16 v[20:23], v[112:115], a[112:115], v[20:23]
    buffer_load_dwordx4 a[40:43], v135, s[36:39], s67 offen sc1
    v_mfma_f32_16x16x32_bf16 v[24:27], v[116:119], a[112:115], v[24:27]
    buffer_load_dwordx4 a[44:47], v136, s[36:39], s67 offen sc1
    v_mfma_f32_16x16x32_bf16 v[28:31], v[100:103], a[116:119], v[28:31]
    v_mfma_f32_16x16x32_bf16 v[32:35], v[104:107], a[116:119], v[32:35]
    v_mfma_f32_16x16x32_bf16 v[36:39], v[108:111], a[116:119], v[36:39]
    v_mfma_f32_16x16x32_bf16 v[40:43], v[112:115], a[116:119], v[40:43]
    v_mfma_f32_16x16x32_bf16 v[44:47], v[116:119], a[116:119], v[44:47]
    v_mfma_f32_16x16x32_bf16 v[48:51], v[100:103], a[120:123], v[48:51]
    v_mfma_f32_16x16x32_bf16 v[52:55], v[104:107], a[120:123], v[52:55]
    v_mfma_f32_16x16x32_bf16 v[56:59], v[108:111], a[120:123], v[56:59]
    v_mfma_f32_16x16x32_bf16 v[60:63], v[112:115], a[120:123], v[60:63]
    v_mfma_f32_16x16x32_bf16 v[64:67], v[116:119], a[120:123], v[64:67]
    v_mfma_f32_16x16x32_bf16 v[68:71], v[100:103], a[124:127], v[68:71]
    v_mfma_f32_16x16x32_bf16 v[72:75], v[104:107], a[124:127], v[72:75]
    v_mfma_f32_16x16x32_bf16 v[76:79], v[108:111], a[124:127], v[76:79]
    v_mfma_f32_16x16x32_bf16 v[120:123], v[112:115], a[124:127], v[120:123]
    v_mfma_f32_16x16x32_bf16 v[124:127], v[116:119], a[124:127], v[124:127]
    s_waitcnt vmcnt(8)
    v_mfma_f32_16x16x32_bf16 v[8:11], v[168:171], a[0:3], v[8:11]
    s_add_u32 s67, s59, 45056
    v_mfma_f32_16x16x32_bf16 v[12:15], v[172:175], a[0:3], v[12:15]
    buffer_load_dwordx4 a[48:51], v133, s[36:39], s67 offen sc1
    v_mfma_f32_16x16x32_bf16 v[16:19], v[176:179], a[0:3], v[16:19]
    buffer_load_dwordx4 a[52:55], v134, s[36:39], s67 offen sc1
    v_mfma_f32_16x16x32_bf16 v[20:23], v[180:183], a[0:3], v[20:23]
    buffer_load_dwordx4 a[56:59], v135, s[36:39], s67 offen sc1
    v_mfma_f32_16x16x32_bf16 v[24:27], v[184:187], a[0:3], v[24:27]
    buffer_load_dwordx4 a[60:63], v136, s[36:39], s67 offen sc1
    v_mfma_f32_16x16x32_bf16 v[28:31], v[168:171], a[4:7], v[28:31]
    buffer_load_dwordx4 v[156:159], v143, s[44:47], s63 offen
    v_mfma_f32_16x16x32_bf16 v[32:35], v[172:175], a[4:7], v[32:35]
    buffer_load_dwordx4 v[160:163], v143, s[44:47], s63 offen offset:64
    v_mfma_f32_16x16x32_bf16 v[36:39], v[176:179], a[4:7], v[36:39]
    buffer_load_dwordx2 v[164:165], v144, s[44:47], s63 offen offset:128
    v_mfma_f32_16x16x32_bf16 v[40:43], v[180:183], a[4:7], v[40:43]
    buffer_load_dwordx2 v[166:167], v149, s[48:51], s62 offen sc1
    v_mfma_f32_16x16x32_bf16 v[44:47], v[184:187], a[4:7], v[44:47]
    v_mfma_f32_16x16x32_bf16 v[48:51], v[168:171], a[8:11], v[48:51]
    v_mfma_f32_16x16x32_bf16 v[52:55], v[172:175], a[8:11], v[52:55]
    v_mfma_f32_16x16x32_bf16 v[56:59], v[176:179], a[8:11], v[56:59]
    v_mfma_f32_16x16x32_bf16 v[60:63], v[180:183], a[8:11], v[60:63]
    v_mfma_f32_16x16x32_bf16 v[64:67], v[184:187], a[8:11], v[64:67]
    v_mfma_f32_16x16x32_bf16 v[68:71], v[168:171], a[12:15], v[68:71]
    v_mfma_f32_16x16x32_bf16 v[72:75], v[172:175], a[12:15], v[72:75]
    v_mfma_f32_16x16x32_bf16 v[76:79], v[176:179], a[12:15], v[76:79]
    v_mfma_f32_16x16x32_bf16 v[120:123], v[180:183], a[12:15], v[120:123]
    v_mfma_f32_16x16x32_bf16 v[124:127], v[184:187], a[12:15], v[124:127]
    s_cmp_lt_u32 s3, 2
    s_cbranch_scc1 f_with13
    s_waitcnt vmcnt(12)
    v_mfma_f32_16x16x32_bf16 v[8:11], v[188:191], a[16:19], v[8:11]
    v_mfma_f32_16x16x32_bf16 v[12:15], v[192:195], a[16:19], v[12:15]
    ds_read_b128 v[80:83], v140 offset:15360
    v_mfma_f32_16x16x32_bf16 v[16:19], v[196:199], a[16:19], v[16:19]
    ds_read_b128 v[84:87], v140 offset:16384
    v_mfma_f32_16x16x32_bf16 v[20:23], v[200:203], a[16:19], v[20:23]
    ds_read_b128 v[88:91], v140 offset:17408
    v_mfma_f32_16x16x32_bf16 v[24:27], v[204:207], a[16:19], v[24:27]
    ds_read_b128 v[92:95], v140 offset:18432
    v_mfma_f32_16x16x32_bf16 v[28:31], v[188:191], a[20:23], v[28:31]
    ds_read_b128 v[96:99], v140 offset:19456
    v_mfma_f32_16x16x32_bf16 v[32:35], v[192:195], a[20:23], v[32:35]
    s_add_u32 s67, s59, 49152
    v_mfma_f32_16x16x32_bf16 v[36:39], v[196:199], a[20:23], v[36:39]
    buffer_load_dwordx4 a[64:67], v133, s[36:39], s67 offen sc1
    v_mfma_f32_16x16x32_bf16 v[40:43], v[200:203], a[20:23], v[40:43]
    buffer_load_dwordx4 a[68:71], v134, s[36:39], s67 offen sc1
    v_mfma_f32_16x16x32_bf16 v[44:47], v[204:207], a[20:23], v[44:47]
    buffer_load_dwordx4 a[72:75], v135, s[36:39], s67 offen sc1
    v_mfma_f32_16x16x32_bf16 v[48:51], v[188:191], a[24:27], v[48:51]
    buffer_load_dwordx4 a[76:79], v136, s[36:39], s67 offen sc1
    v_mfma_f32_16x16x32_bf16 v[52:55], v[192:195], a[24:27], v[52:55]
    buffer_load_dword v155, v129, s[68:71], s72 offen sc1
    v_mfma_f32_16x16x32_bf16 v[56:59], v[196:199], a[24:27], v[56:59]
    v_mfma_f32_16x16x32_bf16 v[60:63], v[200:203], a[24:27], v[60:63]
    v_mfma_f32_16x16x32_bf16 v[64:67], v[204:207], a[24:27], v[64:67]
    v_mfma_f32_16x16x32_bf16 v[68:71], v[188:191], a[28:31], v[68:71]
    v_mfma_f32_16x16x32_bf16 v[72:75], v[192:195], a[28:31], v[72:75]
    v_mfma_f32_16x16x32_bf16 v[76:79], v[196:199], a[28:31], v[76:79]
    v_mfma_f32_16x16x32_bf16 v[120:123], v[200:203], a[28:31], v[120:123]
    v_mfma_f32_16x16x32_bf16 v[124:127], v[204:207], a[28:31], v[124:127]
    s_waitcnt vmcnt(13)
    s_waitcnt lgkmcnt(0)
    v_mfma_f32_16x16x32_bf16 v[8:11], v[80:83], a[32:35], v[8:11]
    v_mfma_f32_16x16x32_bf16 v[12:15], v[84:87], a[32:35], v[12:15]
    ds_read_b128 v[100:103], v140 offset:10240
    v_mfma_f32_16x16x32_bf16 v[16:19], v[88:91], a[32:35], v[16:19]
    ds_read_b128 v[104:107], v140 offset:11264
    v_mfma_f32_16x16x32_bf16 v[20:23], v[92:95], a[32:35], v[20:23]
    ds_read_b128 v[108:111], v140 offset:12288
    v_mfma_f32_16x16x32_bf16 v[24:27], v[96:99], a[32:35], v[24:27]
    ds_read_b128 v[112:115], v140 offset:13312
    v_mfma_f32_16x16x32_bf16 v[28:31], v[80:83], a[36:39], v[28:31]
    ds_read_b128 v[116:119], v140 offset:14336
    v_mfma_f32_16x16x32_bf16 v[32:35], v[84:87], a[36:39], v[32:35]
    v_mfma_f32_16x16x32_bf16 v[36:39], v[88:91], a[36:39], v[36:39]
    v_mfma_f32_16x16x32_bf16 v[40:43], v[92:95], a[36:39], v[40:43]
    v_mfma_f32_16x16x32_bf16 v[44:47], v[96:99], a[36:39], v[44:47]
    v_mfma_f32_16x16x32_bf16 v[48:51], v[80:83], a[40:43], v[48:51]
    v_mfma_f32_16x16x32_bf16 v[52:55], v[84:87], a[40:43], v[52:55]
    v_mfma_f32_16x16x32_bf16 v[56:59], v[88:91], a[40:43], v[56:59]
    v_mfma_f32_16x16x32_bf16 v[60:63], v[92:95], a[40:43], v[60:63]
    v_mfma_f32_16x16x32_bf16 v[64:67], v[96:99], a[40:43], v[64:67]
    v_mfma_f32_16x16x32_bf16 v[68:71], v[80:83], a[44:47], v[68:71]
    v_mfma_f32_16x16x32_bf16 v[72:75], v[84:87], a[44:47], v[72:75]
    v_mfma_f32_16x16x32_bf16 v[76:79], v[88:91], a[44:47], v[76:79]
    v_mfma_f32_16x16x32_bf16 v[120:123], v[92:95], a[44:47], v[120:123]
    v_mfma_f32_16x16x32_bf16 v[124:127], v[96:99], a[44:47], v[124:127]
    s_waitcnt vmcnt(9)
    s_waitcnt lgkmcnt(0)
    v_mfma_f32_16x16x32_bf16 v[8:11], v[100:103], a[48:51], v[8:11]
    v_mfma_f32_16x16x32_bf16 v[12:15], v[104:107], a[48:51], v[12:15]
    ds_read_b128 v[80:83], v140 offset:5120
    v_mfma_f32_16x16x32_bf16 v[16:19], v[108:111], a[48:51], v[16:19]
    ds_read_b128 v[84:87], v140 offset:6144
    v_mfma_f32_16x16x32_bf16 v[20:23], v[112:115], a[48:51], v[20:23]
    ds_read_b128 v[88:91], v140 offset:7168
    v_mfma_f32_16x16x32_bf16 v[24:27], v[116:119], a[48:51], v[24:27]
    ds_read_b128 v[92:95], v140 offset:8192
    v_mfma_f32_16x16x32_bf16 v[28:31], v[100:103], a[52:55], v[28:31]
    ds_read_b128 v[96:99], v140 offset:9216
    v_mfma_f32_16x16x32_bf16 v[32:35], v[104:107], a[52:55], v[32:35]
    s_waitcnt vmcnt(0)
    v_cmp_ne_u32 vcc, s100, v155
    s_and_b64 vcc, vcc, s[76:77]
    s_cbranch_vccz yok_14
    s_mov_b32 s73, 30000
poll_15:
    buffer_load_dword v155, v129, s[68:71], s72 offen sc1
    s_waitcnt vmcnt(0)
    v_cmp_ne_u32 vcc, s100, v155
    s_and_b64 vcc, vcc, s[76:77]
    s_cbranch_vccz polld_16
    s_sub_u32 s73, s73, 1
    s_cbranch_scc0 poll_15
polld_16:
yok_14:
    s_add_u32 m0, s65, 0
    v_mfma_f32_16x16x32_bf16 v[36:39], v[108:111], a[52:55], v[36:39]
    s_add_u32 s66, s64, 0
    v_mfma_f32_16x16x32_bf16 v[40:43], v[112:115], a[52:55], v[40:43]
    s_nop 0
    buffer_load_dwordx4 v152, s[40:43], s66 offen sc1 lds
    v_mfma_f32_16x16x32_bf16 v[44:47], v[116:119], a[52:55], v[44:47]
    s_add_u32 m0, s65, 1024
    v_mfma_f32_16x16x32_bf16 v[48:51], v[100:103], a[56:59], v[48:51]
    s_add_u32 s66, s64, 32768
    v_mfma_f32_16x16x32_bf16 v[52:55], v[104:107], a[56:59], v[52:55]
    s_nop 0
    buffer_load_dwordx4 v152, s[40:43], s66 offen sc1 lds
    v_mfma_f32_16x16x32_bf16 v[56:59], v[108:111], a[56:59], v[56:59]
    s_add_u32 m0, s65, 2048
    s_add_u32 s66, s64, 65536
    v_mfma_f32_16x16x32_bf16 v[60:63], v[112:115], a[56:59], v[60:63]
    s_nop 0
    buffer_load_dwordx4 v152, s[40:43], s66 offen sc1 lds
    v_mfma_f32_16x16x32_bf16 v[64:67], v[116:119], a[56:59], v[64:67]
    s_add_u32 m0, s65, 3072
    v_mfma_f32_16x16x32_bf16 v[68:71], v[100:103], a[60:63], v[68:71]
    s_add_u32 s66, s64, 98304
    v_mfma_f32_16x16x32_bf16 v[72:75], v[104:107], a[60:63], v[72:75]
    s_nop 0
    buffer_load_dwordx4 v152, s[40:43], s66 offen sc1 lds
    v_mfma_f32_16x16x32_bf16 v[76:79], v[108:111], a[60:63], v[76:79]
    s_add_u32 m0, s65, 4096
    v_mfma_f32_16x16x32_bf16 v[120:123], v[112:115], a[60:63], v[120:123]
    s_add_u32 s66, s64, 131072
    s_nop 0
    buffer_load_dwordx4 v152, s[40:43], s66 offen sc1 lds
    v_mfma_f32_16x16x32_bf16 v[124:127], v[116:119], a[60:63], v[124:127]
    s_waitcnt lgkmcnt(0)
    v_mfma_f32_16x16x32_bf16 v[28:31], v[80:83], a[68:71], v[28:31]
    s_mov_b32 s66, 0xffff0000
    v_lshlrev_b32 v176, 16, v156
    v_and_b32 v177, s66, v156
    v_mfma_f32_16x16x32_bf16 v[32:35], v[84:87], a[68:71], v[32:35]
    v_lshlrev_b32 v178, 16, v157
    v_and_b32 v179, s66, v157
    v_lshlrev_b32 v180, 16, v158
    v_mfma_f32_16x16x32_bf16 v[36:39], v[88:91], a[68:71], v[36:39]
    v_and_b32 v181, s66, v158
    v_lshlrev_b32 v182, 16, v159
    v_and_b32 v183, s66, v159
    v_mfma_f32_16x16x32_bf16 v[40:43], v[92:95], a[68:71], v[40:43]
    v_lshlrev_b32 v184, 16, v160
    v_and_b32 v185, s66, v160
    v_lshlrev_b32 v186, 16, v161
    v_mfma_f32_16x16x32_bf16 v[44:47], v[96:99], a[68:71], v[44:47]
    v_and_b32 v187, s66, v161
    v_lshlrev_b32 v188, 16, v162
    v_and_b32 v189, s66, v162
    v_mfma_f32_16x16x32_bf16 v[48:51], v[80:83], a[72:75], v[48:51]
    ds_write_b128 v140, v[28:31] offset:5120
    v_lshlrev_b32 v190, 16, v163
    v_and_b32 v191, s66, v163
    v_mfma_f32_16x16x32_bf16 v[52:55], v[84:87], a[72:75], v[52:55]
    ds_write_b128 v140, v[32:35] offset:6144
    v_lshlrev_b32 v192, 16, v164
    v_and_b32 v193, s66, v164
    v_mfma_f32_16x16x32_bf16 v[56:59], v[88:91], a[72:75], v[56:59]
    ds_write_b128 v140, v[36:39] offset:7168
    v_lshlrev_b32 v194, 16, v165
    v_and_b32 v195, s66, v165
    v_mfma_f32_16x16x32_bf16 v[60:63], v[92:95], a[72:75], v[60:63]
    ds_write_b128 v140, v[40:43] offset:8192
    v_fma_f32 v196, v176, v166, v167
    v_fma_f32 v197, v177, v166, v167
    v_mfma_f32_16x16x32_bf16 v[64:67], v[96:99], a[72:75], v[64:67]
    ds_write_b128 v140, v[44:47] offset:9216
    v_fma_f32 v198, v178, v166, v167
    v_fma_f32 v199, v179, v166, v167
    v_mfma_f32_16x16x32_bf16 v[68:71], v[80:83], a[76:79], v[68:71]
    ds_write_b128 v140, v[48:51] offset:10240
    v_fma_f32 v200, v180, v166, v167
    v_fma_f32 v201, v181, v166, v167
    v_mfma_f32_16x16x32_bf16 v[72:75], v[84:87], a[76:79], v[72:75]
    ds_write_b128 v140, v[52:55] offset:11264
    v_fma_f32 v202, v182, v166, v167
    v_fma_f32 v203, v183, v166, v167
    v_mfma_f32_16x16x32_bf16 v[76:79], v[88:91], a[76:79], v[76:79]
    ds_write_b128 v140, v[56:59] offset:12288
    v_fma_f32 v204, v184, v166, v167
    v_fma_f32 v205, v185, v166, v167
    v_mfma_f32_16x16x32_bf16 v[120:123], v[92:95], a[76:79], v[120:123]
    ds_write_b128 v140, v[60:63] offset:13312
    v_fma_f32 v206, v186, v166, v167
    v_fma_f32 v207, v187, v166, v167
    v_mfma_f32_16x16x32_bf16 v[124:127], v[96:99], a[76:79], v[124:127]
    ds_write_b128 v140, v[64:67] offset:14336
    v_fma_f32 v208, v188, v166, v167
    v_fma_f32 v209, v189, v166, v167
    v_mfma_f32_16x16x32_bf16 v[8:11], v[80:83], a[64:67], v[8:11]
    ds_write_b128 v140, v[68:71] offset:15360
    v_fma_f32 v210, v190, v166, v167
    v_fma_f32 v211, v191, v166, v167
    v_mfma_f32_16x16x32_bf16 v[12:15], v[84:87], a[64:67], v[12:15]
    ds_write_b128 v140, v[72:75] offset:16384
    v_fma_f32 v212, v192, v166, v167
    v_fma_f32 v213, v193, v166, v167
    v_mfma_f32_16x16x32_bf16 v[16:19], v[88:91], a[64:67], v[16:19]
    ds_write_b128 v140, v[76:79] offset:17408
    v_fma_f32 v214, v194, v166, v167
    v_fma_f32 v215, v195, v166, v167
    v_mfma_f32_16x16x32_bf16 v[20:23], v[92:95], a[64:67], v[20:23]
    ds_write_b128 v140, v[120:123] offset:18432
    v_mfma_f32_16x16x32_bf16 v[24:27], v[96:99], a[64:67], v[24:27]
    ds_write_b128 v140, v[124:127] offset:19456
    s_waitcnt vmcnt(0)
    s_branch f_no13
f_with13:
    s_waitcnt vmcnt(12)
    v_mfma_f32_16x16x32_bf16 v[8:11], v[188:191], a[16:19], v[8:11]
    v_mfma_f32_16x16x32_bf16 v[12:15], v[192:195], a[16:19], v[12:15]
    ds_read_b128 v[80:83], v140 offset:15360
    v_mfma_f32_16x16x32_bf16 v[16:19], v[196:199], a[16:19], v[16:19]
    ds_read_b128 v[84:87], v140 offset:16384
    v_mfma_f32_16x16x32_bf16 v[20:23], v[200:203], a[16:19], v[20:23]
    ds_read_b128 v[88:91], v140 offset:17408
    v_mfma_f32_16x16x32_bf16 v[24:27], v[204:207], a[16:19], v[24:27]
    ds_read_b128 v[92:95], v140 offset:18432
    v_mfma_f32_16x16x32_bf16 v[28:31], v[188:191], a[20:23], v[28:31]
    ds_read_b128 v[96:99], v140 offset:19456
    v_mfma_f32_16x16x32_bf16 v[32:35], v[192:195], a[20:23], v[32:35]
    s_add_u32 s67, s59, 49152
    v_mfma_f32_16x16x32_bf16 v[36:39], v[196:199], a[20:23], v[36:39]
    buffer_load_dwordx4 a[64:67], v133, s[36:39], s67 offen sc1
    v_mfma_f32_16x16x32_bf16 v[40:43], v[200:203], a[20:23], v[40:43]
    buffer_load_dwordx4 a[68:71], v134, s[36:39], s67 offen sc1
    v_mfma_f32_16x16x32_bf16 v[44:47], v[204:207], a[20:23], v[44:47]
    buffer_load_dwordx4 a[72:75], v135, s[36:39], s67 offen sc1
    v_mfma_f32_16x16x32_bf16 v[48:51], v[188:191], a[24:27], v[48:51]
    buffer_load_dwordx4 a[76:79], v136, s[36:39], s67 offen sc1
    v_mfma_f32_16x16x32_bf16 v[52:55], v[192:195], a[24:27], v[52:55]
    v_mfma_f32_16x16x32_bf16 v[56:59], v[196:199], a[24:27], v[56:59]
    v_mfma_f32_16x16x32_bf16 v[60:63], v[200:203], a[24:27], v[60:63]
    v_mfma_f32_16x16x32_bf16 v[64:67], v[204:207], a[24:27], v[64:67]
    v_mfma_f32_16x16x32_bf16 v[68:71], v[188:191], a[28:31], v[68:71]
    v_mfma_f32_16x16x32_bf16 v[72:75], v[192:195], a[28:31], v[72:75]
    v_mfma_f32_16x16x32_bf16 v[76:79], v[196:199], a[28:31], v[76:79]
    v_mfma_f32_16x16x32_bf16 v[120:123], v[200:203], a[28:31], v[120:123]
    v_mfma_f32_16x16x32_bf16 v[124:127], v[204:207], a[28:31], v[124:127]
    s_waitcnt vmcnt(12)
    s_waitcnt lgkmcnt(0)
    v_mfma_f32_16x16x32_bf16 v[8:11], v[80:83], a[32:35], v[8:11]
    v_mfma_f32_16x16x32_bf16 v[12:15], v[84:87], a[32:35], v[12:15]
    ds_read_b128 v[100:103], v140 offset:10240
    v_mfma_f32_16x16x32_bf16 v[16:19], v[88:91], a[32:35], v[16:19]
    ds_read_b128 v[104:107], v140 offset:11264
    v_mfma_f32_16x16x32_bf16 v[20:23], v[92:95], a[32:35], v[20:23]
    ds_read_b128 v[108:111], v140 offset:12288
    v_mfma_f32_16x16x32_bf16 v[24:27], v[96:99], a[32:35], v[24:27]
    ds_read_b128 v[112:115], v140 offset:13312
    v_mfma_f32_16x16x32_bf16 v[28:31], v[80:83], a[36:39], v[28:31]
    ds_read_b128 v[116:119], v140 offset:14336
    v_mfma_f32_16x16x32_bf16 v[32:35], v[84:87], a[36:39], v[32:35]
    s_add_u32 s67, s59, 53248
    v_mfma_f32_16x16x32_bf16 v[36:39], v[88:91], a[36:39], v[36:39]
    s_add_u32 s67, s67, s61
    v_mfma_f32_16x16x32_bf16 v[40:43], v[92:95], a[36:39], v[40:43]
    buffer_load_dwordx4 a[80:83], v133, s[36:39], s67 offen sc1
    v_mfma_f32_16x16x32_bf16 v[44:47], v[96:99], a[36:39], v[44:47]
    buffer_load_dwordx4 a[84:87], v134, s[36:39], s67 offen sc1
    v_mfma_f32_16x16x32_bf16 v[48:51], v[80:83], a[40:43], v[48:51]
    buffer_load_dwordx4 a[88:91], v135, s[36:39], s67 offen sc1
    v_mfma_f32_16x16x32_bf16 v[52:55], v[84:87], a[40:43], v[52:55]
    buffer_load_dwordx4 a[92:95], v136, s[36:39], s67 offen sc1
    v_mfma_f32_16x16x32_bf16 v[56:59], v[88:91], a[40:43], v[56:59]
    v_mfma_f32_16x16x32_bf16 v[60:63], v[92:95], a[40:43], v[60:63]
    v_mfma_f32_16x16x32_bf16 v[64:67], v[96:99], a[40:43], v[64:67]
    v_mfma_f32_16x16x32_bf16 v[68:71], v[80:83], a[44:47], v[68:71]
    v_mfma_f32_16x16x32_bf16 v[72:75], v[84:87], a[44:47], v[72:75]
    v_mfma_f32_16x16x32_bf16 v[76:79], v[88:91], a[44:47], v[76:79]
    v_mfma_f32_16x16x32_bf16 v[120:123], v[92:95], a[44:47], v[120:123]
    v_mfma_f32_16x16x32_bf16 v[124:127], v[96:99], a[44:47], v[124:127]
    s_waitcnt vmcnt(12)
    s_waitcnt lgkmcnt(0)
    v_mfma_f32_16x16x32_bf16 v[8:11], v[100:103], a[48:51], v[8:11]
    v_mfma_f32_16x16x32_bf16 v[12:15], v[104:107], a[48:51], v[12:15]
    ds_read_b128 v[80:83], v140 offset:5120
    v_mfma_f32_16x16x32_bf16 v[16:19], v[108:111], a[48:51], v[16:19]
    ds_read_b128 v[84:87], v140 offset:6144
    v_mfma_f32_16x16x32_bf16 v[20:23], v[112:115], a[48:51], v[20:23]
    ds_read_b128 v[88:91], v140 offset:7168
    v_mfma_f32_16x16x32_bf16 v[24:27], v[116:119], a[48:51], v[24:27]
    ds_read_b128 v[92:95], v140 offset:8192
    v_mfma_f32_16x16x32_bf16 v[28:31], v[100:103], a[52:55], v[28:31]
    ds_read_b128 v[96:99], v140 offset:9216
    v_mfma_f32_16x16x32_bf16 v[32:35], v[104:107], a[52:55], v[32:35]
    v_mfma_f32_16x16x32_bf16 v[36:39], v[108:111], a[52:55], v[36:39]
    v_mfma_f32_16x16x32_bf16 v[40:43], v[112:115], a[52:55], v[40:43]
    v_mfma_f32_16x16x32_bf16 v[44:47], v[116:119], a[52:55], v[44:47]
    v_mfma_f32_16x16x32_bf16 v[48:51], v[100:103], a[56:59], v[48:51]
    v_mfma_f32_16x16x32_bf16 v[52:55], v[104:107], a[56:59], v[52:55]
    v_mfma_f32_16x16x32_bf16 v[56:59], v[108:111], a[56:59], v[56:59]
    v_mfma_f32_16x16x32_bf16 v[60:63], v[112:115], a[56:59], v[60:63]
    v_mfma_f32_16x16x32_bf16 v[64:67], v[116:119], a[56:59], v[64:67]
    v_mfma_f32_16x16x32_bf16 v[68:71], v[100:103], a[60:63], v[68:71]
    v_mfma_f32_16x16x32_bf16 v[72:75], v[104:107], a[60:63], v[72:75]
    v_mfma_f32_16x16x32_bf16 v[76:79], v[108:111], a[60:63], v[76:79]
    v_mfma_f32_16x16x32_bf16 v[120:123], v[112:115], a[60:63], v[120:123]
    v_mfma_f32_16x16x32_bf16 v[124:127], v[116:119], a[60:63], v[124:127]
    s_waitcnt vmcnt(4)
    s_waitcnt lgkmcnt(0)
    v_mfma_f32_16x16x32_bf16 v[8:11], v[80:83], a[64:67], v[8:11]
    v_mfma_f32_16x16x32_bf16 v[12:15], v[84:87], a[64:67], v[12:15]
    ds_read_b128 v[100:103], v140 offset:0
    v_mfma_f32_16x16x32_bf16 v[16:19], v[88:91], a[64:67], v[16:19]
    ds_read_b128 v[104:107], v140 offset:1024
    v_mfma_f32_16x16x32_bf16 v[20:23], v[92:95], a[64:67], v[20:23]
    ds_read_b128 v[108:111], v140 offset:2048
    v_mfma_f32_16x16x32_bf16 v[24:27], v[96:99], a[64:67], v[24:27]
    ds_read_b128 v[112:115], v140 offset:3072
    v_mfma_f32_16x16x32_bf16 v[28:31], v[80:83], a[68:71], v[28:31]
    ds_read_b128 v[116:119], v140 offset:4096
    v_mfma_f32_16x16x32_bf16 v[32:35], v[84:87], a[68:71], v[32:35]
    v_mfma_f32_16x16x32_bf16 v[36:39], v[88:91], a[68:71], v[36:39]
    v_mfma_f32_16x16x32_bf16 v[40:43], v[92:95], a[68:71], v[40:43]
    v_mfma_f32_16x16x32_bf16 v[44:47], v[96:99], a[68:71], v[44:47]
    v_mfma_f32_16x16x32_bf16 v[48:51], v[80:83], a[72:75], v[48:51]
    v_mfma_f32_16x16x32_bf16 v[52:55], v[84:87], a[72:75], v[52:55]
    v_mfma_f32_16x16x32_bf16 v[56:59], v[88:91], a[72:75], v[56:59]
    v_mfma_f32_16x16x32_bf16 v[60:63], v[92:95], a[72:75], v[60:63]
    v_mfma_f32_16x16x32_bf16 v[64:67], v[96:99], a[72:75], v[64:67]
    v_mfma_f32_16x16x32_bf16 v[68:71], v[80:83], a[76:79], v[68:71]
    v_mfma_f32_16x16x32_bf16 v[72:75], v[84:87], a[76:79], v[72:75]
    v_mfma_f32_16x16x32_bf16 v[76:79], v[88:91], a[76:79], v[76:79]
    v_mfma_f32_16x16x32_bf16 v[120:123], v[92:95], a[76:79], v[120:123]
    v_mfma_f32_16x16x32_bf16 v[124:127], v[96:99], a[76:79], v[124:127]
    s_waitcnt vmcnt(0)
    s_waitcnt lgkmcnt(0)
    v_mfma_f32_16x16x32_bf16 v[28:31], v[100:103], a[84:87], v[28:31]
    s_mov_b32 s66, 0xffff0000
    v_lshlrev_b32 v176, 16, v156
    v_and_b32 v177, s66, v156
    v_mfma_f32_16x16x32_bf16 v[32:35], v[104:107], a[84:87], v[32:35]
    v_lshlrev_b32 v178, 16, v157
    v_and_b32 v179, s66, v157
    v_lshlrev_b32 v180, 16, v158
    v_mfma_f32_16x16x32_bf16 v[36:39], v[108:111], a[84:87], v[36:39]
    v_and_b32 v181, s66, v158
    v_lshlrev_b32 v182, 16, v159
    v_and_b32 v183, s66, v159
    v_mfma_f32_16x16x32_bf16 v[40:43], v[112:115], a[84:87], v[40:43]
    v_lshlrev_b32 v184, 16, v160
    v_and_b32 v185, s66, v160
    v_lshlrev_b32 v186, 16, v161
    v_mfma_f32_16x16x32_bf16 v[44:47], v[116:119], a[84:87], v[44:47]
    v_and_b32 v187, s66, v161
    v_lshlrev_b32 v188, 16, v162
    v_and_b32 v189, s66, v162
    v_mfma_f32_16x16x32_bf16 v[48:51], v[100:103], a[88:91], v[48:51]
    ds_write_b128 v140, v[28:31] offset:5120
    v_lshlrev_b32 v190, 16, v163
    v_and_b32 v191, s66, v163
    v_mfma_f32_16x16x32_bf16 v[52:55], v[104:107], a[88:91], v[52:55]
    ds_write_b128 v140, v[32:35] offset:6144
    v_lshlrev_b32 v192, 16, v164
    v_and_b32 v193, s66, v164
    v_mfma_f32_16x16x32_bf16 v[56:59], v[108:111], a[88:91], v[56:59]
    ds_write_b128 v140, v[36:39] offset:7168
    v_lshlrev_b32 v194, 16, v165
    v_and_b32 v195, s66, v165
    v_mfma_f32_16x16x32_bf16 v[60:63], v[112:115], a[88:91], v[60:63]
    ds_write_b128 v140, v[40:43] offset:8192
    v_fma_f32 v196, v176, v166, v167
    v_fma_f32 v197, v177, v166, v167
    v_mfma_f32_16x16x32_bf16 v[64:67], v[116:119], a[88:91], v[64:67]
    ds_write_b128 v140, v[44:47] offset:9216
    v_fma_f32 v198, v178, v166, v167
    v_fma_f32 v199, v179, v166, v167
    v_mfma_f32_16x16x32_bf16 v[68:71], v[100:103], a[92:95], v[68:71]
    ds_write_b128 v140, v[48:51] offset:10240
    v_fma_f32 v200, v180, v166, v167
    v_fma_f32 v201, v181, v166, v167
    v_mfma_f32_16x16x32_bf16 v[72:75], v[104:107], a[92:95], v[72:75]
    ds_write_b128 v140, v[52:55] offset:11264
    v_fma_f32 v202, v182, v166, v167
    v_fma_f32 v203, v183, v166, v167
    v_mfma_f32_16x16x32_bf16 v[76:79], v[108:111], a[92:95], v[76:79]
    ds_write_b128 v140, v[56:59] offset:12288
    v_fma_f32 v204, v184, v166, v167
    v_fma_f32 v205, v185, v166, v167
    v_mfma_f32_16x16x32_bf16 v[120:123], v[112:115], a[92:95], v[120:123]
    ds_write_b128 v140, v[60:63] offset:13312
    v_fma_f32 v206, v186, v166, v167
    v_fma_f32 v207, v187, v166, v167
    v_mfma_f32_16x16x32_bf16 v[124:127], v[116:119], a[92:95], v[124:127]
    ds_write_b128 v140, v[64:67] offset:14336
    v_fma_f32 v208, v188, v166, v167
    v_fma_f32 v209, v189, v166, v167
    v_mfma_f32_16x16x32_bf16 v[8:11], v[100:103], a[80:83], v[8:11]
    ds_write_b128 v140, v[68:71] offset:15360
    v_fma_f32 v210, v190, v166, v167
    v_fma_f32 v211, v191, v166, v167
    v_mfma_f32_16x16x32_bf16 v[12:15], v[104:107], a[80:83], v[12:15]
    ds_write_b128 v140, v[72:75] offset:16384
    v_fma_f32 v212, v192, v166, v167
    v_fma_f32 v213, v193, v166, v167
    v_mfma_f32_16x16x32_bf16 v[16:19], v[108:111], a[80:83], v[16:19]
    ds_write_b128 v140, v[76:79] offset:17408
    v_fma_f32 v214, v194, v166, v167
    v_fma_f32 v215, v195, v166, v167
    v_mfma_f32_16x16x32_bf16 v[20:23], v[112:115], a[80:83], v[20:23]
    ds_write_b128 v140, v[120:123] offset:18432
    v_mfma_f32_16x16x32_bf16 v[24:27], v[116:119], a[80:83], v[24:27]
    ds_write_b128 v140, v[124:127] offset:19456
    s_waitcnt vmcnt(0)
f_no13:
    s_waitcnt lgkmcnt(0)
    s_barrier
    ds_read_b128 v[28:31], v145 offset:5120
    ds_read_b128 v[32:35], v145 offset:6144
    ds_read_b128 v[36:39], v145 offset:7168
    ds_read_b128 v[40:43], v145 offset:8192
    ds_read_b128 v[44:47], v145 offset:9216
    ds_read_b128 v[48:51], v146 offset:10240
    ds_read_b128 v[52:55], v146 offset:11264
    ds_read_b128 v[56:59], v146 offset:12288
    ds_read_b128 v[60:63], v146 offset:13312
    ds_read_b128 v[64:67], v146 offset:14336
    ds_read_b128 v[68:71], v147 offset:15360
    ds_read_b128 v[72:75], v147 offset:16384
    ds_read_b128 v[76:79], v147 offset:17408
    ds_read_b128 v[80:83], v147 offset:18432
    ds_read_b128 v[84:87], v147 offset:19456
    ds_read_b64_tr_b16 v[88:89], v139 offset:0
    ds_read_b64_tr_b16 v[90:91], v153 offset:512
    ds_read_b64_tr_b16 v[92:93], v139 offset:4096
    ds_read_b64_tr_b16 v[94:95], v153 offset:4608
    ds_read_b64_tr_b16 v[96:97], v138 offset:8192
    s_lshl_b32 s73, s3, 7
    s_add_u32 s72, s72, s73
    s_cmp_eq_u32 s3, 1
    s_cselect_b32 s72, s99, s72
    s_cmp_lg_u32 s3, 3
    s_cbranch_scc1 f_rst
    v_subrev_u32 v154, 384, v128
f_rst:
    v_mov_b32 v155, s101
    buffer_store_dword v155, v154, s[68:71], s72 offen sc1
    s_waitcnt lgkmcnt(15)
    v_pk_add_f32 v[8:9], v[8:9], v[28:29]
    v_pk_add_f32 v[10:11], v[10:11], v[30:31]
    v_pk_add_f32 v[12:13], v[12:13], v[32:33]
    v_pk_add_f32 v[14:15], v[14:15], v[34:35]
    v_pk_add_f32 v[16:17], v[16:17], v[36:37]
    v_pk_add_f32 v[18:19], v[18:19], v[38:39]
    v_pk_add_f32 v[20:21], v[20:21], v[40:41]
    v_pk_add_f32 v[22:23], v[22:23], v[42:43]
    v_pk_add_f32 v[24:25], v[24:25], v[44:45]
    v_pk_add_f32 v[26:27], v[26:27], v[46:47]
    s_waitcnt lgkmcnt(5)
    v_pk_add_f32 v[48:49], v[48:49], v[68:69]
    v_pk_add_f32 v[50:51], v[50:51], v[70:71]
    v_pk_add_f32 v[52:53], v[52:53], v[72:73]
    v_pk_add_f32 v[54:55], v[54:55], v[74:75]
    v_pk_add_f32 v[56:57], v[56:57], v[76:77]
    v_pk_add_f32 v[58:59], v[58:59], v[78:79]
    v_pk_add_f32 v[60:61], v[60:61], v[80:81]
    v_pk_add_f32 v[62:63], v[62:63], v[82:83]
    v_pk_add_f32 v[64:65], v[64:65], v[84:85]
    v_pk_add_f32 v[66:67], v[66:67], v[86:87]
    v_pk_add_f32 v[8:9], v[8:9], v[48:49]
    v_pk_add_f32 v[10:11], v[10:11], v[50:51]
    v_pk_add_f32 v[12:13], v[12:13], v[52:53]
    v_pk_add_f32 v[14:15], v[14:15], v[54:55]
    v_pk_add_f32 v[16:17], v[16:17], v[56:57]
    v_pk_add_f32 v[18:19], v[18:19], v[58:59]
    v_pk_add_f32 v[20:21], v[20:21], v[60:61]
    v_pk_add_f32 v[22:23], v[22:23], v[62:63]
    v_pk_add_f32 v[24:25], v[24:25], v[64:65]
    v_pk_add_f32 v[26:27], v[26:27], v[66:67]
    v_mul_f32 v28, 0xbfb8aa3b, v8
    v_mul_f32 v29, 0xbfb8aa3b, v9
    v_mul_f32 v30, 0xbfb8aa3b, v10
    v_mul_f32 v31, 0xbfb8aa3b, v11
    v_mul_f32 v32, 0xbfb8aa3b, v12
    v_mul_f32 v33, 0xbfb8aa3b, v13
    v_mul_f32 v34, 0xbfb8aa3b, v14
    v_mul_f32 v35, 0xbfb8aa3b, v15
    v_mul_f32 v36, 0xbfb8aa3b, v16
    v_mul_f32 v37, 0xbfb8aa3b, v17
    v_mul_f32 v38, 0xbfb8aa3b, v18
    v_mul_f32 v39, 0xbfb8aa3b, v19
    v_mul_f32 v40, 0xbfb8aa3b, v20
    v_mul_f32 v41, 0xbfb8aa3b, v21
    v_mul_f32 v42, 0xbfb8aa3b, v22
    v_mul_f32 v43, 0xbfb8aa3b, v23
    v_mul_f32 v44, 0xbfb8aa3b, v24
    v_mul_f32 v45, 0xbfb8aa3b, v25
    v_mul_f32 v46, 0xbfb8aa3b, v26
    v_mul_f32 v47, 0xbfb8aa3b, v27
    v_exp_f32 v28, v28
    v_exp_f32 v29, v29
    v_exp_f32 v30, v30
    v_exp_f32 v31, v31
    v_exp_f32 v32, v32
    v_exp_f32 v33, v33
    v_exp_f32 v34, v34
    v_exp_f32 v35, v35
    v_exp_f32 v36, v36
    v_exp_f32 v37, v37
    v_exp_f32 v38, v38
    v_exp_f32 v39, v39
    v_exp_f32 v40, v40
    v_exp_f32 v41, v41
    v_exp_f32 v42, v42
    v_exp_f32 v43, v43
    v_exp_f32 v44, v44
    v_exp_f32 v45, v45
    v_exp_f32 v46, v46
    v_exp_f32 v47, v47
    s_waitcnt lgkmcnt(0)
    v_lshlrev_b32 v48, 16, v88
    v_and_b32 v49, s66, v88
    v_lshlrev_b32 v50, 16, v89
    v_and_b32 v51, s66, v89
    v_lshlrev_b32 v52, 16, v90
    v_and_b32 v53, s66, v90
    v_lshlrev_b32 v54, 16, v91
    v_and_b32 v55, s66, v91
    v_lshlrev_b32 v56, 16, v92
    v_and_b32 v57, s66, v92
    v_lshlrev_b32 v58, 16, v93
    v_and_b32 v59, s66, v93
    v_lshlrev_b32 v60, 16, v94
    v_and_b32 v61, s66, v94
    v_lshlrev_b32 v62, 16, v95
    v_and_b32 v63, s66, v95
    v_lshlrev_b32 v64, 16, v96
    v_and_b32 v65, s66, v96
    v_lshlrev_b32 v66, 16, v97
    v_and_b32 v67, s66, v97
    v_pk_add_f32 v[28:29], v[28:29], 1.0 op_sel_hi:[1,0]
    v_pk_add_f32 v[30:31], v[30:31], 1.0 op_sel_hi:[1,0]
    v_pk_add_f32 v[32:33], v[32:33], 1.0 op_sel_hi:[1,0]
    v_pk_add_f32 v[34:35], v[34:35], 1.0 op_sel_hi:[1,0]
    v_pk_add_f32 v[36:37], v[36:37], 1.0 op_sel_hi:[1,0]
    v_pk_add_f32 v[38:39], v[38:39], 1.0 op_sel_hi:[1,0]
    v_pk_add_f32 v[40:41], v[40:41], 1.0 op_sel_hi:[1,0]
    v_pk_add_f32 v[42:43], v[42:43], 1.0 op_sel_hi:[1,0]
    v_pk_add_f32 v[44:45], v[44:45], 1.0 op_sel_hi:[1,0]
    v_pk_add_f32 v[46:47], v[46:47], 1.0 op_sel_hi:[1,0]
    v_pk_mul_f32 v[48:49], v[48:49], v[196:197]
    v_pk_mul_f32 v[50:51], v[50:51], v[198:199]
    v_pk_mul_f32 v[52:53], v[52:53], v[200:201]
    v_pk_mul_f32 v[54:55], v[54:55], v[202:203]
    v_pk_mul_f32 v[56:57], v[56:57], v[204:205]
    v_pk_mul_f32 v[58:59], v[58:59], v[206:207]
    v_pk_mul_f32 v[60:61], v[60:61], v[208:209]
    v_pk_mul_f32 v[62:63], v[62:63], v[210:211]
    v_pk_mul_f32 v[64:65], v[64:65], v[212:213]
    v_pk_mul_f32 v[66:67], v[66:67], v[214:215]
    v_rcp_f32 v28, v28
    v_rcp_f32 v29, v29
    v_rcp_f32 v30, v30
    v_rcp_f32 v31, v31
    v_rcp_f32 v32, v32
    v_rcp_f32 v33, v33
    v_rcp_f32 v34, v34
    v_rcp_f32 v35, v35
    v_pk_mul_f32 v[8:9], v[8:9], v[48:49]
    v_pk_mul_f32 v[10:11], v[10:11], v[50:51]
    v_pk_mul_f32 v[12:13], v[12:13], v[52:53]
    v_pk_mul_f32 v[14:15], v[14:15], v[54:55]
    v_pk_fma_f32 v[8:9], v[8:9], v[28:29], v[176:177]
    v_pk_fma_f32 v[10:11], v[10:11], v[30:31], v[178:179]
    v_pk_fma_f32 v[12:13], v[12:13], v[32:33], v[180:181]
    v_pk_fma_f32 v[14:15], v[14:15], v[34:35], v[182:183]
    v_cvt_pk_bf16_f32 v156, v8, v9
    v_cvt_pk_bf16_f32 v157, v10, v11
    v_cvt_pk_bf16_f32 v158, v12, v13
    v_cvt_pk_bf16_f32 v159, v14, v15
    buffer_store_dwordx4 v[156:159], v143, s[52:55], s63 offen
    v_rcp_f32 v36, v36
    v_rcp_f32 v37, v37
    v_rcp_f32 v38, v38
    v_rcp_f32 v39, v39
    v_rcp_f32 v40, v40
    v_rcp_f32 v41, v41
    v_rcp_f32 v42, v42
    v_rcp_f32 v43, v43
    v_pk_mul_f32 v[16:17], v[16:17], v[56:57]
    v_pk_mul_f32 v[18:19], v[18:19], v[58:59]
    v_pk_mul_f32 v[20:21], v[20:21], v[60:61]
    v_pk_mul_f32 v[22:23], v[22:23], v[62:63]
    v_pk_fma_f32 v[16:17], v[16:17], v[36:37], v[184:185]
    v_pk_fma_f32 v[18:19], v[18:19], v[38:39], v[186:187]
    v_pk_fma_f32 v[20:21], v[20:21], v[40:41], v[188:189]
    v_pk_fma_f32 v[22:23], v[22:23], v[42:43], v[190:191]
    v_cvt_pk_bf16_f32 v160, v16, v17
    v_cvt_pk_bf16_f32 v161, v18, v19
    v_cvt_pk_bf16_f32 v162, v20, v21
    v_cvt_pk_bf16_f32 v163, v22, v23
    buffer_store_dwordx4 v[160:163], v143, s[52:55], s63 offen offset:64
    v_rcp_f32 v44, v44
    v_rcp_f32 v45, v45
    v_rcp_f32 v46, v46
    v_rcp_f32 v47, v47
    v_pk_mul_f32 v[24:25], v[24:25], v[64:65]
    v_pk_mul_f32 v[26:27], v[26:27], v[66:67]
    v_pk_fma_f32 v[24:25], v[24:25], v[44:45], v[192:193]
    v_pk_fma_f32 v[26:27], v[26:27], v[46:47], v[194:195]
    v_cvt_pk_bf16_f32 v164, v24, v25
    v_cvt_pk_bf16_f32 v165, v26, v27
    buffer_store_dwordx2 v[164:165], v144, s[52:55], s63 offen offset:128
recurrent_scan__ssm_conv_h3__glu_gated_glu__prompt_kernel_end:
    s_endpgm
.section .rodata,"a"
.p2align 6
.amdhsa_kernel recurrent_scan__ssm_conv_h3__glu_gated_glu__prompt_kernel
  .amdhsa_next_free_vgpr 512
  .amdhsa_next_free_sgpr 102
  .amdhsa_accum_offset 256
  .amdhsa_group_segment_fixed_size 0
  .amdhsa_kernarg_size 104
  .amdhsa_user_sgpr_count 2
  .amdhsa_user_sgpr_kernarg_segment_ptr 1
  .amdhsa_system_sgpr_workgroup_id_x 1
.end_amdhsa_kernel
```
